```python
import torch

def _softmax(x, axis=-1):
    return torch.softmax(x, dim=axis)
def _gelu(x):
    return torch.nn.functional.gelu(x, approximate="tanh")
def _silu(x):
    return torch.nn.functional.silu(x)
def _sigmoid(x):
    return torch.sigmoid(x)
def _layernorm(x, axis=-1, eps=1e-5):
    m = x.mean(dim=axis, keepdim=True)
    v = x.var(dim=axis, keepdim=True, unbiased=False)
    return (x - m) / torch.sqrt(v + eps)
def _scatter_add(tgt, idx, src, axis=0):
    return tgt.clone().index_add_(axis, idx, src)
def _segment_sum(src, seg, n):
    out = torch.zeros((n,) + src.shape[1:], dtype=src.dtype)
    return out.index_add_(0, seg, src)
def _pad(x, pw):
    flat = tuple(v for pair in reversed(pw) for v in pair)
    return torch.nn.functional.pad(x, flat)

kernel_name = 'parallel_sum__sliding_block__glu_gated_geglu__prompt'

def setup_inputs():

    _w = (lambda a: (lambda t: t.to(torch.bfloat16) if t.is_floating_point() else t)(torch.as_tensor(a)))
    def _A_setup():
        B, S, D = 1, 2048, 1024
        return {
            "x": _w((lambda *s: torch.randn(*s, dtype=torch.bfloat16) * 0.05)(B, S, D)),
            "wqkv": _w((lambda *s: torch.randn(*s, dtype=torch.bfloat16) * 0.05)(D, 3 * D)),
            "wo": _w((lambda *s: torch.randn(*s, dtype=torch.bfloat16) * 0.05)(D, D)),
        }
    _A_in = _A_setup()

    def _B_setup():
        B, S, Dm, Df = 1, 2048, 1024, 3584
        return {
            "x": _w((lambda *s: torch.randn(*s, dtype=torch.bfloat16) * 0.05)(B, S, Dm)),
            "w_gate": _w((lambda *s: torch.randn(*s, dtype=torch.bfloat16) * 0.8)(Dm, Df) * (Dm ** -0.5)),
            "w_up": _w((lambda *s: torch.randn(*s, dtype=torch.bfloat16) * 0.8)(Dm, Df) * (Dm ** -0.5)),
            "w_down": _w((lambda *s: torch.randn(*s, dtype=torch.bfloat16) * 0.8)(Df, Dm) * (Df ** -0.5)),
        }
    _B_in = _B_setup()

    return {
        "A_x": _A_in["x"],
        "A_wqkv": _A_in["wqkv"],
        "A_wo": _A_in["wo"],
        "B_x": _B_in["x"],
        "B_w_gate": _B_in["w_gate"],
        "B_w_up": _B_in["w_up"],
        "B_w_down": _B_in["w_down"],
    }

def reference(A_x, A_wqkv, A_wo, B_x, B_w_gate, B_w_up, B_w_down):
    def _A_ref(x, wqkv, wo):
        B, S, D = x.shape
        H = 32; Dh = D // H; W = 256
        qkv = (lambda x, *d: x.permute(*d))((x @ wqkv).reshape(B, S, 3, H, Dh), 2, 0, 3, 1, 4)
        q, k, v = qkv[0], qkv[1], qkv[2]
        scores = torch.einsum("bhqd,bhkd->bhqk", q, k) * (Dh ** -0.5)
        idx = torch.arange(S)
        mask = (idx[:, None] - idx[None, :] >= 0) & (idx[:, None] - idx[None, :] < W)
        scores = torch.where(mask[None, None], scores, -1e9)
        p = _softmax(scores, axis=-1)
        o = torch.einsum("bhqk,bhkd->bhqd", p, v)
        return (lambda x, *d: x.permute(*d))(o, 0, 2, 1, 3).reshape(B, S, D) @ wo

    def _B_ref(x, w_gate, w_up, w_down):
        g = torch.einsum("bsd,df->bsf", x, w_gate)
        u = torch.einsum("bsd,df->bsf", x, w_up)
        h = _gelu(g) * u
        return torch.einsum("bsf,fd->bsd", h, w_down)

    x = A_x
    xn = _layernorm(x, axis=-1)
    return x + _A_ref(xn, A_wqkv, A_wo) + _B_ref(xn, B_w_gate, B_w_up, B_w_down)
```

```asm
; @launch grid=(256,1,1) block=(256,1,1) lds=163840
.amdgcn_target "amdgcn-amd-amdhsa--gfx950"
.text
.globl parallel_sum__sliding_block__glu_gated_geglu__prompt_kernel
.p2align 8
.type parallel_sum__sliding_block__glu_gated_geglu__prompt_kernel,@function
parallel_sum__sliding_block__glu_gated_geglu__prompt_kernel:
s_cmp_ge_u32 s2, 256
s_cbranch_scc1 L_end
s_load_dwordx16 s[48:63], s[0:1], 0
s_load_dwordx4 s[64:67], s[0:1], 64
s_getpc_b64 s[70:71]
L_pc:
v_lshrrev_b32 v14, 6, v0
v_and_b32 v19, 15, v0
v_lshl_add_u32 v20, v14, 4, v19
v_lshlrev_b32_e64 v20, 7, v20
s_mov_b64 exec, 0xffff
global_load_dword v30, v20, s[70:71]
s_mov_b64 exec, -1
v_and_b32_e64 v1, 63, v0
v_readfirstlane_b32 s3, v14
s_and_b32 s5, s2, 7
s_lshl_b32 s5, s5, 2
s_bfe_u32 s6, s2, 0x20003
s_add_u32 s5, s5, s6
s_lshr_b32 s4, s2, 5
s_lshl_b32 s69, s4, 5
s_add_u32 s69, s69, s5
v_lshrrev_b32 v18, 5, v0
v_and_b32 v17, 31, v0
v_lshlrev_b32 v21, 11, v18
v_lshl_add_u32 v144, v17, 4, v21
s_lshl_b32 s36, s69, 14
v_mov_b32_e64 v8, 0
s_waitcnt lgkmcnt(0)
s_mov_b32 s16, s48
s_and_b32 s17, s49, 0xffff
s_mov_b32 s18, 4194304
s_mov_b32 s19, 0x20000
buffer_load_dwordx4 v[96:99], v144, s[16:19], s36 offen offset:0
buffer_load_dwordx4 v[100:103], v144, s[16:19], s36 offen offset:512
buffer_load_dwordx4 v[104:107], v144, s[16:19], s36 offen offset:1024
buffer_load_dwordx4 v[108:111], v144, s[16:19], s36 offen offset:1536
buffer_load_ushort v148, v21, s[16:19], s36 offen
s_add_u32 s32, s66, 33554432
s_addc_u32 s33, s67, 0
s_and_b32 s33, s33, 0xffff
s_mov_b32 s34, 65536
s_mov_b32 s35, 0x20000
s_mov_b32 s7, 32768
buffer_load_dword v26, v8, s[32:35], s7 offen sc0 sc1
s_lshl_b32 s7, s69, 7
buffer_load_dword v30, v8, s[32:35], s7 offen sc1
s_and_b32 s6, s2, 7
s_lshr_b32 s7, s2, 3
s_cmp_eq_u32 s3, 0
s_cbranch_scc1 L_t0
s_cmp_eq_u32 s3, 3
s_cbranch_scc1 L_t3
s_cmp_eq_u32 s3, 1
s_cselect_b32 s72, s56, s58
s_cselect_b32 s73, s57, s59
s_mov_b32 s74, 7340032
s_mul_i32 s76, s6, 896
s_mul_i32 s7, s7, 14336
s_add_u32 s76, s76, s7
s_mov_b32 s77, 458752
s_mov_b32 s37, 7
s_movk_i32 s38, 7168
s_movk_i32 s39, 256
s_branch L_tj
L_t0:
s_mov_b32 s72, s50
s_mov_b32 s73, s51
s_mov_b32 s74, 6291456
s_lshl_b32 s76, s6, 8
s_mul_i32 s7, s7, 12288
s_add_u32 s76, s76, s7
s_mov_b32 s77, 393216
s_mov_b32 s37, 6
s_movk_i32 s38, 6144
s_movk_i32 s39, 2048
s_branch L_tj
L_t3:
s_mov_b32 s72, s60
s_mov_b32 s73, s61
s_mov_b32 s74, 7340032
s_mul_i32 s76, s2, 28672
s_movk_i32 s77, 1792
s_mov_b32 s37, 7
s_movk_i32 s38, 896
s_movk_i32 s39, 256
L_tj:
s_and_b32 s73, s73, 0xffff
s_mov_b32 s75, 0x20000
v_cmp_le_u32 vcc, s37, v19
v_subrev_u32 v20, s37, v19
v_mov_b32 v22, s38
v_cndmask_b32 v21, v19, v20, vcc
v_cndmask_b32 v22, v8, v22, vcc
v_lshrrev_b32 v23, 1, v21
v_mul_lo_u32 v23, v23, s39
v_and_b32 v24, 1, v21
v_lshl_add_u32 v23, v24, 7, v23
v_cmp_le_u32 vcc, s37, v21
v_add_u32 v22, v22, v23
v_mov_b32 v23, 1073741824
v_cndmask_b32 v22, v22, v23, vcc
v_lshrrev_b32 v24, 4, v1
v_mul_lo_u32 v24, v24, s77
v_cmp_gt_u32 vcc, 16, v1
v_add_u32 v24, v24, v22
s_lshl_b32 s7, s77, 2
v_cndmask_b32 v15, v23, v22, vcc
s_cmp_eq_u32 s3, 3
s_cselect_b32 s78, 0, s7
s_cselect_b64 vcc, -1, 0
v_cndmask_b32 v24, v24, v23, vcc
s_lshr_b32 s7, s2, 3
s_lshl_b32 s7, s7, 2
s_add_u32 s7, s7, s3
s_lshl_b32 s7, s7, 2
s_add_u32 s7, s7, 64
v_and_b32 v25, 3, v1
v_add_u32 v25, s7, v25
v_lshlrev_b32 v25, 7, v25
v_min_u32 v25, L_end-L_pc, v25
v_mul_u32_u24 v146, 2080, v18
v_lshl_add_u32 v146, v17, 4, v146
v_add_u32 v146, 122880, v146
v_and_b32 v16, 7, v0
v_bfe_u32 v17, v0, 3, 2
v_lshlrev_b32 v145, 10, v18
v_lshl_add_u32 v145, v17, 8, v145
v_lshl_add_u32 v145, v16, 4, v145
v_mul_u32_u24 v147, 2080, v16
v_lshl_add_u32 v147, v18, 6, v147
v_lshl_add_u32 v147, v17, 3, v147
v_add_u32 v147, 122880, v147
s_mov_b32 s28, s66
s_and_b32 s29, s67, 0xffff
s_mov_b32 s30, 4194304
s_mov_b32 s31, 0x20000
s_lshr_b32 s46, s69, 1
s_lshl_b32 s46, s46, 15
s_and_b32 s7, s69, 1
s_lshl_b32 s7, s7, 7
s_add_u32 s46, s46, s7
s_mov_b32 s24, 0xffff0000
s_waitcnt vmcnt(2)
s_mov_b32 exec_hi, 0
buffer_load_dword v30, v24, s[72:75], s76 offen
s_mov_b64 exec, 15
global_load_dword v30, v25, s[70:71]
s_mov_b64 exec, -1
s_lshl_b32 s70, s69, 7
s_lshl_b32 s6, s3, 2
s_add_u32 s70, s70, s6
v_lshlrev_b32 v112, 16, v96
v_and_b32 v113, s24, v96
v_lshlrev_b32 v114, 16, v97
v_and_b32 v115, s24, v97
v_lshlrev_b32 v116, 16, v98
v_and_b32 v117, s24, v98
v_lshlrev_b32 v118, 16, v99
v_and_b32 v119, s24, v99
v_lshlrev_b32 v120, 16, v100
v_and_b32 v121, s24, v100
v_lshlrev_b32 v122, 16, v101
v_and_b32 v123, s24, v101
v_lshlrev_b32 v124, 16, v102
v_and_b32 v125, s24, v102
v_lshlrev_b32 v126, 16, v103
v_and_b32 v127, s24, v103
v_lshlrev_b32 v128, 16, v104
v_and_b32 v129, s24, v104
v_lshlrev_b32 v130, 16, v105
v_and_b32 v131, s24, v105
v_lshlrev_b32 v132, 16, v106
v_and_b32 v133, s24, v106
v_lshlrev_b32 v134, 16, v107
v_and_b32 v135, s24, v107
v_lshlrev_b32 v136, 16, v108
v_and_b32 v137, s24, v108
v_lshlrev_b32 v138, 16, v109
v_and_b32 v139, s24, v109
v_lshlrev_b32 v140, 16, v110
v_and_b32 v141, s24, v110
v_lshlrev_b32 v142, 16, v111
v_and_b32 v143, s24, v111
v_lshlrev_b32 v148, 16, v148
v_pk_add_f32 v[162:163], v[112:113], v[148:149] op_sel_hi:[1,0] neg_lo:[0,1] neg_hi:[0,1]
v_pk_mul_f32 v[158:159], v[162:163], v[162:163]
v_pk_add_f32 v[154:155], v[162:163], 0 op_sel_hi:[1,0]
v_pk_add_f32 v[164:165], v[114:115], v[148:149] op_sel_hi:[1,0] neg_lo:[0,1] neg_hi:[0,1]
v_pk_mul_f32 v[160:161], v[164:165], v[164:165]
v_pk_add_f32 v[156:157], v[164:165], 0 op_sel_hi:[1,0]
v_pk_add_f32 v[166:167], v[116:117], v[148:149] op_sel_hi:[1,0] neg_lo:[0,1] neg_hi:[0,1]
v_pk_fma_f32 v[158:159], v[166:167], v[166:167], v[158:159]
v_pk_add_f32 v[154:155], v[154:155], v[166:167]
v_pk_add_f32 v[168:169], v[118:119], v[148:149] op_sel_hi:[1,0] neg_lo:[0,1] neg_hi:[0,1]
v_pk_fma_f32 v[160:161], v[168:169], v[168:169], v[160:161]
v_pk_add_f32 v[156:157], v[156:157], v[168:169]
v_pk_add_f32 v[162:163], v[120:121], v[148:149] op_sel_hi:[1,0] neg_lo:[0,1] neg_hi:[0,1]
v_pk_fma_f32 v[158:159], v[162:163], v[162:163], v[158:159]
v_pk_add_f32 v[154:155], v[154:155], v[162:163]
v_pk_add_f32 v[164:165], v[122:123], v[148:149] op_sel_hi:[1,0] neg_lo:[0,1] neg_hi:[0,1]
v_pk_fma_f32 v[160:161], v[164:165], v[164:165], v[160:161]
v_pk_add_f32 v[156:157], v[156:157], v[164:165]
v_pk_add_f32 v[166:167], v[124:125], v[148:149] op_sel_hi:[1,0] neg_lo:[0,1] neg_hi:[0,1]
v_pk_fma_f32 v[158:159], v[166:167], v[166:167], v[158:159]
v_pk_add_f32 v[154:155], v[154:155], v[166:167]
v_pk_add_f32 v[168:169], v[126:127], v[148:149] op_sel_hi:[1,0] neg_lo:[0,1] neg_hi:[0,1]
v_pk_fma_f32 v[160:161], v[168:169], v[168:169], v[160:161]
v_pk_add_f32 v[156:157], v[156:157], v[168:169]
v_pk_add_f32 v[162:163], v[128:129], v[148:149] op_sel_hi:[1,0] neg_lo:[0,1] neg_hi:[0,1]
v_pk_fma_f32 v[158:159], v[162:163], v[162:163], v[158:159]
v_pk_add_f32 v[154:155], v[154:155], v[162:163]
v_pk_add_f32 v[164:165], v[130:131], v[148:149] op_sel_hi:[1,0] neg_lo:[0,1] neg_hi:[0,1]
v_pk_fma_f32 v[160:161], v[164:165], v[164:165], v[160:161]
v_pk_add_f32 v[156:157], v[156:157], v[164:165]
v_pk_add_f32 v[166:167], v[132:133], v[148:149] op_sel_hi:[1,0] neg_lo:[0,1] neg_hi:[0,1]
v_pk_fma_f32 v[158:159], v[166:167], v[166:167], v[158:159]
v_pk_add_f32 v[154:155], v[154:155], v[166:167]
v_pk_add_f32 v[168:169], v[134:135], v[148:149] op_sel_hi:[1,0] neg_lo:[0,1] neg_hi:[0,1]
v_pk_fma_f32 v[160:161], v[168:169], v[168:169], v[160:161]
v_pk_add_f32 v[156:157], v[156:157], v[168:169]
v_pk_add_f32 v[162:163], v[136:137], v[148:149] op_sel_hi:[1,0] neg_lo:[0,1] neg_hi:[0,1]
v_pk_fma_f32 v[158:159], v[162:163], v[162:163], v[158:159]
v_pk_add_f32 v[154:155], v[154:155], v[162:163]
v_pk_add_f32 v[164:165], v[138:139], v[148:149] op_sel_hi:[1,0] neg_lo:[0,1] neg_hi:[0,1]
v_pk_fma_f32 v[160:161], v[164:165], v[164:165], v[160:161]
v_pk_add_f32 v[156:157], v[156:157], v[164:165]
v_pk_add_f32 v[166:167], v[140:141], v[148:149] op_sel_hi:[1,0] neg_lo:[0,1] neg_hi:[0,1]
v_pk_fma_f32 v[158:159], v[166:167], v[166:167], v[158:159]
v_pk_add_f32 v[154:155], v[154:155], v[166:167]
v_pk_add_f32 v[168:169], v[142:143], v[148:149] op_sel_hi:[1,0] neg_lo:[0,1] neg_hi:[0,1]
v_pk_fma_f32 v[160:161], v[168:169], v[168:169], v[160:161]
v_pk_add_f32 v[156:157], v[156:157], v[168:169]
v_pk_add_f32 v[154:155], v[154:155], v[156:157]
v_pk_add_f32 v[158:159], v[158:159], v[160:161]
v_add_f32 v150, v154, v155
v_add_f32_e64 v151, v158, v159
s_nop 0
v_add_f32_dpp v150, v150, v150 row_ror:8 row_mask:0xf bank_mask:0xf
v_add_f32_dpp v151, v151, v151 row_ror:8 row_mask:0xf bank_mask:0xf
s_nop 0
v_add_f32_dpp v150, v150, v150 row_ror:4 row_mask:0xf bank_mask:0xf
v_add_f32_dpp v151, v151, v151 row_ror:4 row_mask:0xf bank_mask:0xf
s_nop 0
v_add_f32_dpp v150, v150, v150 row_ror:2 row_mask:0xf bank_mask:0xf
v_add_f32_dpp v151, v151, v151 row_ror:2 row_mask:0xf bank_mask:0xf
s_nop 0
v_add_f32_dpp v150, v150, v150 row_ror:1 row_mask:0xf bank_mask:0xf
v_add_f32_dpp v151, v151, v151 row_ror:1 row_mask:0xf bank_mask:0xf
v_mov_b32 v152, v150
v_mov_b32 v153, v151
s_nop 0
v_permlane16_swap_b32 v152, v150
v_permlane16_swap_b32 v153, v151
v_add_f32 v150, v150, v152
v_add_f32 v151, v151, v153
v_mul_f32 v150, 0x3a800000, v150
v_mul_f32 v151, 0x3a800000, v151
v_add_f32_e64 v152, v150, v148
v_fma_f32 v151, -v150, v150, v151
v_cvt_pk_bf16_f32 v152, v152, v152
v_max_f32 v151, 0, v151
v_and_b32 v152, s24, v152
v_cvt_pk_bf16_f32 v151, v151, v151
v_and_b32_e64 v151, s24, v151
v_add_f32 v151, 0x3727c5ac, v151
v_cvt_pk_bf16_f32 v151, v151, v151
v_and_b32 v151, s24, v151
v_sqrt_f32_e64 v151, v151
s_nop 0
v_cvt_pk_bf16_f32 v151, v151, v151
v_and_b32 v151, s24, v151
v_rcp_f32 v150, v151
v_pk_add_f32 v[162:163], v[112:113], v[152:153] op_sel_hi:[1,0] neg_lo:[0,1] neg_hi:[0,1]
v_cvt_pk_bf16_f32 v163, v162, v163
v_lshlrev_b32 v162, 16, v163
v_and_b32 v163, s24, v163
v_pk_mul_f32 v[162:163], v[162:163], v[150:151] op_sel_hi:[1,0]
v_cvt_pk_bf16_f32 v96, v162, v163
v_pk_add_f32 v[164:165], v[114:115], v[152:153] op_sel_hi:[1,0] neg_lo:[0,1] neg_hi:[0,1]
v_cvt_pk_bf16_f32 v165, v164, v165
v_lshlrev_b32 v164, 16, v165
v_and_b32 v165, s24, v165
v_pk_mul_f32 v[164:165], v[164:165], v[150:151] op_sel_hi:[1,0]
v_cvt_pk_bf16_f32 v97, v164, v165
v_pk_add_f32 v[166:167], v[116:117], v[152:153] op_sel_hi:[1,0] neg_lo:[0,1] neg_hi:[0,1]
v_cvt_pk_bf16_f32 v167, v166, v167
v_lshlrev_b32 v166, 16, v167
v_and_b32 v167, s24, v167
v_pk_mul_f32 v[166:167], v[166:167], v[150:151] op_sel_hi:[1,0]
v_cvt_pk_bf16_f32 v98, v166, v167
v_pk_add_f32 v[168:169], v[118:119], v[152:153] op_sel_hi:[1,0] neg_lo:[0,1] neg_hi:[0,1]
v_cvt_pk_bf16_f32 v169, v168, v169
v_lshlrev_b32 v168, 16, v169
v_and_b32 v169, s24, v169
v_pk_mul_f32 v[168:169], v[168:169], v[150:151] op_sel_hi:[1,0]
v_cvt_pk_bf16_f32 v99, v168, v169
ds_write_b128 v146, v[96:99] offset:0
v_pk_add_f32 v[162:163], v[120:121], v[152:153] op_sel_hi:[1,0] neg_lo:[0,1] neg_hi:[0,1]
v_cvt_pk_bf16_f32 v163, v162, v163
v_lshlrev_b32 v162, 16, v163
v_and_b32 v163, s24, v163
v_pk_mul_f32 v[162:163], v[162:163], v[150:151] op_sel_hi:[1,0]
v_cvt_pk_bf16_f32 v100, v162, v163
v_pk_add_f32 v[164:165], v[122:123], v[152:153] op_sel_hi:[1,0] neg_lo:[0,1] neg_hi:[0,1]
v_cvt_pk_bf16_f32 v165, v164, v165
v_lshlrev_b32 v164, 16, v165
v_and_b32 v165, s24, v165
v_pk_mul_f32 v[164:165], v[164:165], v[150:151] op_sel_hi:[1,0]
v_cvt_pk_bf16_f32 v101, v164, v165
v_pk_add_f32 v[166:167], v[124:125], v[152:153] op_sel_hi:[1,0] neg_lo:[0,1] neg_hi:[0,1]
v_cvt_pk_bf16_f32 v167, v166, v167
v_lshlrev_b32 v166, 16, v167
v_and_b32 v167, s24, v167
v_pk_mul_f32 v[166:167], v[166:167], v[150:151] op_sel_hi:[1,0]
v_cvt_pk_bf16_f32 v102, v166, v167
v_pk_add_f32 v[168:169], v[126:127], v[152:153] op_sel_hi:[1,0] neg_lo:[0,1] neg_hi:[0,1]
v_cvt_pk_bf16_f32 v169, v168, v169
v_lshlrev_b32 v168, 16, v169
v_and_b32 v169, s24, v169
v_pk_mul_f32 v[168:169], v[168:169], v[150:151] op_sel_hi:[1,0]
v_cvt_pk_bf16_f32 v103, v168, v169
ds_write_b128 v146, v[100:103] offset:512
v_pk_add_f32 v[162:163], v[128:129], v[152:153] op_sel_hi:[1,0] neg_lo:[0,1] neg_hi:[0,1]
v_cvt_pk_bf16_f32 v163, v162, v163
v_lshlrev_b32 v162, 16, v163
v_and_b32 v163, s24, v163
v_pk_mul_f32 v[162:163], v[162:163], v[150:151] op_sel_hi:[1,0]
v_cvt_pk_bf16_f32 v104, v162, v163
v_pk_add_f32 v[164:165], v[130:131], v[152:153] op_sel_hi:[1,0] neg_lo:[0,1] neg_hi:[0,1]
v_cvt_pk_bf16_f32 v165, v164, v165
v_lshlrev_b32 v164, 16, v165
v_and_b32 v165, s24, v165
v_pk_mul_f32 v[164:165], v[164:165], v[150:151] op_sel_hi:[1,0]
v_cvt_pk_bf16_f32 v105, v164, v165
v_pk_add_f32 v[166:167], v[132:133], v[152:153] op_sel_hi:[1,0] neg_lo:[0,1] neg_hi:[0,1]
v_cvt_pk_bf16_f32 v167, v166, v167
v_lshlrev_b32 v166, 16, v167
v_and_b32 v167, s24, v167
v_pk_mul_f32 v[166:167], v[166:167], v[150:151] op_sel_hi:[1,0]
v_cvt_pk_bf16_f32 v106, v166, v167
v_pk_add_f32 v[168:169], v[134:135], v[152:153] op_sel_hi:[1,0] neg_lo:[0,1] neg_hi:[0,1]
v_cvt_pk_bf16_f32 v169, v168, v169
v_lshlrev_b32 v168, 16, v169
v_and_b32 v169, s24, v169
v_pk_mul_f32 v[168:169], v[168:169], v[150:151] op_sel_hi:[1,0]
v_cvt_pk_bf16_f32 v107, v168, v169
ds_write_b128 v146, v[104:107] offset:1024
v_pk_add_f32 v[162:163], v[136:137], v[152:153] op_sel_hi:[1,0] neg_lo:[0,1] neg_hi:[0,1]
v_cvt_pk_bf16_f32 v163, v162, v163
v_lshlrev_b32 v162, 16, v163
v_and_b32 v163, s24, v163
v_pk_mul_f32 v[162:163], v[162:163], v[150:151] op_sel_hi:[1,0]
v_cvt_pk_bf16_f32 v108, v162, v163
v_pk_add_f32 v[164:165], v[138:139], v[152:153] op_sel_hi:[1,0] neg_lo:[0,1] neg_hi:[0,1]
v_cvt_pk_bf16_f32 v165, v164, v165
v_lshlrev_b32 v164, 16, v165
v_and_b32 v165, s24, v165
v_pk_mul_f32 v[164:165], v[164:165], v[150:151] op_sel_hi:[1,0]
v_cvt_pk_bf16_f32 v109, v164, v165
v_pk_add_f32 v[166:167], v[140:141], v[152:153] op_sel_hi:[1,0] neg_lo:[0,1] neg_hi:[0,1]
v_cvt_pk_bf16_f32 v167, v166, v167
v_lshlrev_b32 v166, 16, v167
v_and_b32 v167, s24, v167
v_pk_mul_f32 v[166:167], v[166:167], v[150:151] op_sel_hi:[1,0]
v_cvt_pk_bf16_f32 v110, v166, v167
v_pk_add_f32 v[168:169], v[142:143], v[152:153] op_sel_hi:[1,0] neg_lo:[0,1] neg_hi:[0,1]
v_cvt_pk_bf16_f32 v169, v168, v169
v_lshlrev_b32 v168, 16, v169
v_and_b32 v169, s24, v169
v_pk_mul_f32 v[168:169], v[168:169], v[150:151] op_sel_hi:[1,0]
v_cvt_pk_bf16_f32 v111, v168, v169
ds_write_b128 v146, v[108:111] offset:1536
s_waitcnt lgkmcnt(0)
s_barrier
ds_read2_b64 v[112:115], v147 offset0:0 offset1:4
ds_read2_b64 v[116:119], v147 offset0:64 offset1:68
ds_read2_b64 v[120:123], v147 offset0:128 offset1:132
ds_read2_b64 v[124:127], v147 offset0:192 offset1:196
s_waitcnt lgkmcnt(3)
buffer_store_dwordx4 v[112:115], v145, s[28:31], s46 offen sc1
s_add_u32 s46, s46, 8192
s_waitcnt lgkmcnt(2)
buffer_store_dwordx4 v[116:119], v145, s[28:31], s46 offen sc1
s_add_u32 s46, s46, 8192
s_waitcnt lgkmcnt(1)
buffer_store_dwordx4 v[120:123], v145, s[28:31], s46 offen sc1
s_add_u32 s46, s46, 8192
s_waitcnt lgkmcnt(0)
buffer_store_dwordx4 v[124:127], v145, s[28:31], s46 offen sc1
s_waitcnt vmcnt(7)
v_readfirstlane_b32 s68, v26
s_nop 1
s_mul_i32 s68, s68, 1664525
s_add_u32 s68, s68, 1013904223
v_mov_b32 v28, s68
v_mov_b32 v14, 1073741824
v_cmp_eq_u32 vcc, 0, v1
v_lshlrev_b32 v2, 4, v1
v_mov_b32 v31, 0
v_cndmask_b32 v29, v14, v8, vcc
v_lshrrev_b32 v14, 2, v1
v_mul_u32_u24 v3, 6144, v14
v_bfe_u32 v19, v1, 4, 1
v_and_b32 v16, 3, v1
v_lshlrev_b32 v17, 1, v19
v_xor_b32 v17, v17, v16
v_lshl_add_u32 v3, v17, 4, v3
v_lshlrev_b32 v11, 6, v14
v_lshl_add_u32 v11, v16, 3, v11
v_lshl_add_u32 v11, v19, 5, v11
v_xor_b32_e64 v12, 32, v11
v_mul_u32_u24 v13, 224, v14
v_lshl_add_u32 v13, v16, 3, v13
v_and_b32 v27, 7, v14
v_lshlrev_b32 v27, 7, v27
v_lshl_add_u32 v27, v16, 2, v27
s_and_b32 s6, s5, 1
s_lshl_b32 s6, s6, 1
v_add_u32 v14, 0, v1
v_mul_u32_u24 v19, 4682, v14
v_lshrrev_b32 v19, 16, v19
v_mad_i32_i24 v16, v19, -14, v14
v_add_u32 v16, s6, v16
v_subrev_u32 v17, 14, v16
v_min_u32 v16, v16, v17
v_mul_u32_u24 v19, 7168, v19
v_lshl_add_u32 v4, v16, 4, v19
v_add_u32 v14, 64, v1
v_mul_u32_u24 v19, 4682, v14
v_lshrrev_b32 v19, 16, v19
v_mad_i32_i24 v16, v19, -14, v14
v_add_u32 v16, s6, v16
v_subrev_u32 v17, 14, v16
v_min_u32 v16, v16, v17
v_mul_u32_u24 v19, 7168, v19
v_lshl_add_u32 v5, v16, 4, v19
v_add_u32 v14, 128, v1
v_mul_u32_u24 v19, 4682, v14
v_lshrrev_b32_e64 v19, 16, v19
v_mad_i32_i24 v16, v19, -14, v14
v_add_u32 v16, s6, v16
v_subrev_u32 v17, 14, v16
v_min_u32_e64 v16, v16, v17
v_mul_u32_u24 v19, 7168, v19
v_lshl_add_u32 v6, v16, 4, v19
v_add_u32 v14, 192, v1
v_mul_u32_u24 v19, 4682, v14
v_lshrrev_b32_e64 v19, 16, v19
v_mad_i32_i24 v16, v19, -14, v14
v_add_u32 v16, s6, v16
v_subrev_u32 v17, 14, v16
v_min_u32_e64 v16, v16, v17
v_mul_u32_u24 v19, 7168, v19
v_lshl_add_u32 v7, v16, 4, v19
v_add_u32 v14, 256, v1
v_mul_u32_u24 v19, 4682, v14
v_lshrrev_b32_e64 v19, 16, v19
v_mad_i32_i24 v16, v19, -14, v14
v_add_u32 v16, s6, v16
v_subrev_u32 v17, 14, v16
v_min_u32_e64 v16, v16, v17
v_mul_u32_u24 v19, 7168, v19
v_lshl_add_u32 v8, v16, 4, v19
v_add_u32 v14, 320, v1
v_mul_u32_u24 v19, 4682, v14
v_lshrrev_b32_e64 v19, 16, v19
v_mad_i32_i24 v16, v19, -14, v14
v_add_u32 v16, s6, v16
v_subrev_u32 v17, 14, v16
v_min_u32_e64 v16, v16, v17
v_mul_u32_u24 v19, 7168, v19
v_lshl_add_u32 v9, v16, 4, v19
v_add_u32 v14, 384, v1
v_mul_u32_u24 v19, 4682, v14
v_lshrrev_b32_e64 v19, 16, v19
v_mad_i32_i24 v16, v19, -14, v14
v_add_u32 v16, s6, v16
v_subrev_u32 v17, 14, v16
v_min_u32_e64 v16, v16, v17
v_mul_u32_u24 v19, 7168, v19
v_lshl_add_u32 v10, v16, 4, v19
s_lshl_b32 s6, s5, 6
s_sub_u32 s7, 6291456, s6
s_add_u32 s8, s50, s6
s_addc_u32 s9, s51, 0
s_and_b32 s9, s9, 0xffff
s_mov_b32 s10, s7
s_mov_b32 s11, 0x20000
s_cmp_lt_u32 s3, 2
s_cselect_b32 s12, s56, s58
s_cselect_b32 s13, s57, s59
s_mul_i32 s6, s5, 224
s_sub_u32 s7, 7340032, s6
s_add_u32 s12, s12, s6
s_addc_u32 s13, s13, 0
s_and_b32 s13, s13, 0xffff
s_mov_b32 s14, s7
s_mov_b32 s15, 0x20000
s_lshl_b32 s6, s4, 2
s_add_u32 s6, s6, s3
s_lshl_b32 s47, s6, 2
s_lshl_b32 s6, s6, 17
s_add_u32 s16, s66, s6
s_addc_u32 s17, s67, 0
s_and_b32 s17, s17, 0xffff
s_mov_b32 s18, 131072
s_mov_b32 s19, 0x20000
s_mul_i32 s36, s3, 98304
s_add_u32 s37, s36, 2048
s_add_u32 s38, s36, 4096
s_and_b32 s39, s3, 1
s_mul_i32 s39, s39, 229376
s_mov_b32 s40, 0
s_mov_b32 s41, 0x8000
s_mov_b32 s42, 0x10000
s_mov_b32 s43, 0x18000
s_lshl_b32 s44, s3, 10
s_mul_i32 s45, s3, 7168
s_add_u32 s45, s45, 12288
s_lshl_b32 s71, s47, 8
s_add_u32 m0, s44, 0
s_nop 0
buffer_load_dwordx4 v3, s[8:11], s36 offen lds
s_add_u32 m0, s44, 4096
s_nop 0
buffer_load_dwordx4 v3, s[8:11], s37 offen lds
s_add_u32 m0, s44, 8192
s_nop 0
buffer_load_dwordx4 v3, s[8:11], s38 offen lds
s_add_u32 m0, s45, 0
s_nop 0
buffer_load_dwordx4 v4, s[12:15], s39 offen lds
s_add_u32 m0, s45, 1024
s_nop 0
buffer_load_dwordx4 v5, s[12:15], s39 offen lds
s_waitcnt vmcnt(5)
buffer_store_dword v28, v29, s[32:35], s70 offen sc1
s_add_u32 m0, s45, 2048
s_nop 0
buffer_load_dwordx4 v6, s[12:15], s39 offen lds
s_add_u32 m0, s45, 3072
s_nop 0
buffer_load_dwordx4 v7, s[12:15], s39 offen lds
s_add_u32 m0, s45, 4096
s_nop 0
buffer_load_dwordx4 v8, s[12:15], s39 offen lds
s_add_u32 m0, s45, 5120
s_nop 0
buffer_load_dwordx4 v9, s[12:15], s39 offen lds
s_add_u32 m0, s45, 6144
s_nop 0
buffer_load_dwordx4 v10, s[12:15], s39 offen lds
s_add_u32 s36, s36, 393216
s_add_u32 s37, s37, 393216
s_add_u32 s38, s38, 393216
s_add_u32 s39, s39, 458752
s_add_u32 m0, s44, 40960
s_nop 0
buffer_load_dwordx4 v3, s[8:11], s36 offen lds
s_add_u32 m0, s44, 45056
s_nop 0
buffer_load_dwordx4 v3, s[8:11], s37 offen lds
s_add_u32 m0, s44, 49152
s_nop 0
buffer_load_dwordx4 v3, s[8:11], s38 offen lds
s_add_u32 m0, s45, 40960
s_nop 0
buffer_load_dwordx4 v4, s[12:15], s39 offen lds
s_add_u32 m0, s45, 41984
s_nop 0
buffer_load_dwordx4 v5, s[12:15], s39 offen lds
s_add_u32 m0, s45, 43008
s_nop 0
buffer_load_dwordx4 v6, s[12:15], s39 offen lds
s_add_u32 m0, s45, 44032
s_nop 0
buffer_load_dwordx4 v7, s[12:15], s39 offen lds
s_add_u32 m0, s45, 45056
s_nop 0
buffer_load_dwordx4 v8, s[12:15], s39 offen lds
s_add_u32 m0, s45, 46080
s_nop 0
buffer_load_dwordx4 v9, s[12:15], s39 offen lds
s_add_u32 m0, s45, 47104
s_nop 0
buffer_load_dwordx4 v10, s[12:15], s39 offen lds
s_add_u32 s36, s36, 393216
s_add_u32 s37, s37, 393216
s_add_u32 s38, s38, 393216
s_add_u32 s39, s39, 458752
buffer_load_dword v18, v27, s[32:35], s71 offen sc1
s_waitcnt vmcnt(0)
v_cmp_ne_u32 vcc, s68, v18
s_nop 4
s_cbranch_vccz L_pln_ok
s_mov_b32 s6, 0
L_pln_chk:
buffer_load_dword v0, v27, s[32:35], s71 offen sc1
s_add_u32 s6, s6, 1
s_waitcnt vmcnt(0)
v_cmp_ne_u32 vcc, s68, v0
s_nop 4
s_cbranch_vccz L_pln_ok
s_cmp_lt_u32 s6, 0x20000
s_cbranch_scc1 L_pln_chk
L_pln_ok:
buffer_load_dwordx4 a[96:99], v2, s[16:19], s40 offen offset:0 sc1
buffer_load_dwordx4 a[100:103], v2, s[16:19], s41 offen offset:0 sc1
buffer_load_dwordx4 a[104:107], v2, s[16:19], s42 offen offset:0 sc1
buffer_load_dwordx4 a[108:111], v2, s[16:19], s43 offen offset:0 sc1
buffer_load_dwordx4 a[112:115], v2, s[16:19], s40 offen offset:1024 sc1
buffer_load_dwordx4 a[116:119], v2, s[16:19], s41 offen offset:1024 sc1
buffer_load_dwordx4 a[120:123], v2, s[16:19], s42 offen offset:1024 sc1
buffer_load_dwordx4 a[124:127], v2, s[16:19], s43 offen offset:1024 sc1
s_barrier
ds_read_b64_tr_b16 a[160:161], v11 offset:0
ds_read_b64_tr_b16 a[162:163], v11 offset:1024
ds_read_b64_tr_b16 a[164:165], v12 offset:0
ds_read_b64_tr_b16 a[166:167], v12 offset:1024
ds_read_b64_tr_b16 a[168:169], v11 offset:4096
ds_read_b64_tr_b16 a[170:171], v11 offset:5120
ds_read_b64_tr_b16 a[172:173], v12 offset:4096
ds_read_b64_tr_b16 a[174:175], v12 offset:5120
s_mov_b32 s46, 3
s_waitcnt vmcnt(4) lgkmcnt(4)
v_mfma_f32_16x16x32_bf16 a[0:3], a[160:163], a[96:99], 0
ds_read_b64_tr_b16 a[176:177], v11 offset:8192
v_mfma_f32_16x16x32_bf16 a[16:19], a[164:167], a[96:99], 0
ds_read_b64_tr_b16 a[178:179], v11 offset:9216
v_mfma_f32_16x16x32_bf16 a[20:23], a[164:167], a[100:103], 0
s_mov_b32 exec_lo, 0
buffer_load_dword v30, v24, s[72:75], s76 offen
s_mov_b32 exec_lo, -1
s_add_u32 s76, s76, s78
v_mfma_f32_16x16x32_bf16 a[4:7], a[160:163], a[100:103], 0
v_mfma_f32_16x16x32_bf16 a[8:11], a[160:163], a[104:107], 0
ds_read_b64_tr_b16 a[180:181], v12 offset:8192
v_mfma_f32_16x16x32_bf16 a[24:27], a[164:167], a[104:107], 0
ds_read_b64_tr_b16 a[182:183], v12 offset:9216
v_mfma_f32_16x16x32_bf16 a[28:31], a[164:167], a[108:111], 0
buffer_load_dwordx4 a[128:131], v2, s[16:19], s40 offen offset:2048 sc1
v_mfma_f32_16x16x32_bf16 a[12:15], a[160:163], a[108:111], 0
s_waitcnt lgkmcnt(4)
v_mfma_f32_16x16x32_bf16 a[44:47], a[168:171], a[108:111], 0
ds_read_b64_tr_b16 a[184:185], v13 offset:12288
v_mfma_f32_16x16x32_bf16 a[60:63], a[172:175], a[108:111], 0
ds_read_b64_tr_b16 a[186:187], v13 offset:15872
v_mfma_f32_16x16x32_bf16 a[56:59], a[172:175], a[104:107], 0
v_mfma_f32_16x16x32_bf16 a[40:43], a[168:171], a[104:107], 0
v_mfma_f32_16x16x32_bf16 a[36:39], a[168:171], a[100:103], 0
ds_read_b64_tr_b16 a[188:189], v13 offset:12320
v_mfma_f32_16x16x32_bf16 a[52:55], a[172:175], a[100:103], 0
ds_read_b64_tr_b16 a[190:191], v13 offset:15904
v_mfma_f32_16x16x32_bf16 a[48:51], a[172:175], a[96:99], 0
buffer_load_dwordx4 a[132:135], v2, s[16:19], s41 offen offset:2048 sc1
v_mfma_f32_16x16x32_bf16 a[32:35], a[168:171], a[96:99], 0
s_waitcnt lgkmcnt(4)
v_mfma_f32_16x16x32_bf16 a[64:67], a[96:99], a[176:179], 0
ds_read_b64_tr_b16 a[160:161], v13 offset:12352
v_mfma_f32_16x16x32_bf16 a[80:83], a[96:99], a[180:183], 0
ds_read_b64_tr_b16 a[162:163], v13 offset:15936
v_mfma_f32_16x16x32_bf16 a[84:87], a[100:103], a[180:183], 0
v_mfma_f32_16x16x32_bf16 a[68:71], a[100:103], a[176:179], 0
v_mfma_f32_16x16x32_bf16 a[72:75], a[104:107], a[176:179], 0
ds_read_b64_tr_b16 a[164:165], v13 offset:12384
v_mfma_f32_16x16x32_bf16 a[88:91], a[104:107], a[180:183], 0
ds_read_b64_tr_b16 a[166:167], v13 offset:15968
v_mfma_f32_16x16x32_bf16 a[92:95], a[108:111], a[180:183], 0
buffer_load_dwordx4 a[136:139], v2, s[16:19], s42 offen offset:2048 sc1
v_mfma_f32_16x16x32_bf16 a[76:79], a[108:111], a[176:179], 0
s_waitcnt lgkmcnt(4)
v_mfma_f32_16x16x32_bf16 v[44:47], a[184:187], a[108:111], 0
ds_read_b64_tr_b16 a[168:169], v13 offset:12416
v_mfma_f32_16x16x32_bf16 v[60:63], a[188:191], a[108:111], 0
ds_read_b64_tr_b16 a[170:171], v13 offset:16000
v_mfma_f32_16x16x32_bf16 v[56:59], a[188:191], a[104:107], 0
v_mfma_f32_16x16x32_bf16 v[40:43], a[184:187], a[104:107], 0
v_mfma_f32_16x16x32_bf16 v[36:39], a[184:187], a[100:103], 0
ds_read_b64_tr_b16 a[172:173], v13 offset:12448
v_mfma_f32_16x16x32_bf16 v[52:55], a[188:191], a[100:103], 0
ds_read_b64_tr_b16 a[174:175], v13 offset:16032
v_mfma_f32_16x16x32_bf16 v[48:51], a[188:191], a[96:99], 0
buffer_load_dwordx4 a[140:143], v2, s[16:19], s43 offen offset:2048 sc1
v_mfma_f32_16x16x32_bf16 v[32:35], a[184:187], a[96:99], 0
s_waitcnt lgkmcnt(4)
v_mfma_f32_16x16x32_bf16 v[64:67], a[160:163], a[96:99], 0
ds_read_b64_tr_b16 a[176:177], v13 offset:12480
v_mfma_f32_16x16x32_bf16 v[80:83], a[164:167], a[96:99], 0
ds_read_b64_tr_b16 a[178:179], v13 offset:16064
v_mfma_f32_16x16x32_bf16 v[84:87], a[164:167], a[100:103], 0
v_mfma_f32_16x16x32_bf16 v[68:71], a[160:163], a[100:103], 0
v_mfma_f32_16x16x32_bf16 v[72:75], a[160:163], a[104:107], 0
ds_read_b64_tr_b16 a[180:181], v13 offset:26624
v_mfma_f32_16x16x32_bf16 v[88:91], a[164:167], a[104:107], 0
ds_read_b64_tr_b16 a[182:183], v13 offset:30208
v_mfma_f32_16x16x32_bf16 v[92:95], a[164:167], a[108:111], 0
buffer_load_dwordx4 a[144:147], v2, s[16:19], s40 offen offset:3072 sc1
v_mfma_f32_16x16x32_bf16 v[76:79], a[160:163], a[108:111], 0
s_waitcnt lgkmcnt(4)
v_mfma_f32_16x16x32_bf16 v[108:111], a[168:171], a[108:111], 0
ds_read_b64_tr_b16 a[184:185], v13 offset:26656
v_mfma_f32_16x16x32_bf16 v[124:127], a[172:175], a[108:111], 0
ds_read_b64_tr_b16 a[186:187], v13 offset:30240
v_mfma_f32_16x16x32_bf16 v[120:123], a[172:175], a[104:107], 0
v_mfma_f32_16x16x32_bf16 v[104:107], a[168:171], a[104:107], 0
v_mfma_f32_16x16x32_bf16 v[100:103], a[168:171], a[100:103], 0
ds_read_b64_tr_b16 a[188:189], v13 offset:26688
v_mfma_f32_16x16x32_bf16 v[116:119], a[172:175], a[100:103], 0
ds_read_b64_tr_b16 a[190:191], v13 offset:30272
v_mfma_f32_16x16x32_bf16 v[112:115], a[172:175], a[96:99], 0
buffer_load_dwordx4 a[148:151], v2, s[16:19], s41 offen offset:3072 sc1
v_mfma_f32_16x16x32_bf16 v[96:99], a[168:171], a[96:99], 0
s_waitcnt lgkmcnt(4)
v_mfma_f32_16x16x32_bf16 v[128:131], a[176:179], a[96:99], 0
ds_read_b64_tr_b16 a[160:161], v13 offset:26720
v_mfma_f32_16x16x32_bf16 v[144:147], a[180:183], a[96:99], 0
ds_read_b64_tr_b16 a[162:163], v13 offset:30304
v_mfma_f32_16x16x32_bf16 v[148:151], a[180:183], a[100:103], 0
v_mfma_f32_16x16x32_bf16 v[132:135], a[176:179], a[100:103], 0
v_mfma_f32_16x16x32_bf16 v[136:139], a[176:179], a[104:107], 0
ds_read_b64_tr_b16 a[164:165], v13 offset:26752
v_mfma_f32_16x16x32_bf16 v[152:155], a[180:183], a[104:107], 0
ds_read_b64_tr_b16 a[166:167], v13 offset:30336
v_mfma_f32_16x16x32_bf16 v[156:159], a[180:183], a[108:111], 0
buffer_load_dwordx4 a[152:155], v2, s[16:19], s42 offen offset:3072 sc1
v_mfma_f32_16x16x32_bf16 v[140:143], a[176:179], a[108:111], 0
s_waitcnt lgkmcnt(4)
v_mfma_f32_16x16x32_bf16 v[172:175], a[184:187], a[108:111], 0
ds_read_b64_tr_b16 a[168:169], v13 offset:26784
v_mfma_f32_16x16x32_bf16 v[188:191], a[188:191], a[108:111], 0
ds_read_b64_tr_b16 a[170:171], v13 offset:30368
v_mfma_f32_16x16x32_bf16 v[184:187], a[188:191], a[104:107], 0
v_mfma_f32_16x16x32_bf16 v[168:171], a[184:187], a[104:107], 0
v_mfma_f32_16x16x32_bf16 v[164:167], a[184:187], a[100:103], 0
ds_read_b64_tr_b16 a[172:173], v13 offset:26816
v_mfma_f32_16x16x32_bf16 v[180:183], a[188:191], a[100:103], 0
ds_read_b64_tr_b16 a[174:175], v13 offset:30400
v_mfma_f32_16x16x32_bf16 v[176:179], a[188:191], a[96:99], 0
buffer_load_dwordx4 a[156:159], v2, s[16:19], s43 offen offset:3072 sc1
v_mfma_f32_16x16x32_bf16 v[160:163], a[184:187], a[96:99], 0
s_waitcnt lgkmcnt(4)
v_mfma_f32_16x16x32_bf16 v[192:195], a[160:163], a[96:99], 0
ds_read_b64_tr_b16 a[176:177], v11 offset:2048
v_mfma_f32_16x16x32_bf16 v[208:211], a[164:167], a[96:99], 0
ds_read_b64_tr_b16 a[178:179], v11 offset:3072
v_mfma_f32_16x16x32_bf16 v[212:215], a[164:167], a[100:103], 0
v_mfma_f32_16x16x32_bf16 v[196:199], a[160:163], a[100:103], 0
v_mfma_f32_16x16x32_bf16 v[200:203], a[160:163], a[104:107], 0
ds_read_b64_tr_b16 a[180:181], v12 offset:2048
v_mfma_f32_16x16x32_bf16 v[216:219], a[164:167], a[104:107], 0
ds_read_b64_tr_b16 a[182:183], v12 offset:3072
v_mfma_f32_16x16x32_bf16 v[220:223], a[164:167], a[108:111], 0
v_mfma_f32_16x16x32_bf16 v[204:207], a[160:163], a[108:111], 0
s_waitcnt lgkmcnt(4)
v_mfma_f32_16x16x32_bf16 v[236:239], a[168:171], a[108:111], 0
ds_read_b64_tr_b16 a[184:185], v11 offset:6144
v_mfma_f32_16x16x32_bf16 v[252:255], a[172:175], a[108:111], 0
ds_read_b64_tr_b16 a[186:187], v11 offset:7168
v_mfma_f32_16x16x32_bf16 v[248:251], a[172:175], a[104:107], 0
v_mfma_f32_16x16x32_bf16 v[232:235], a[168:171], a[104:107], 0
v_mfma_f32_16x16x32_bf16 v[228:231], a[168:171], a[100:103], 0
ds_read_b64_tr_b16 a[188:189], v12 offset:6144
v_mfma_f32_16x16x32_bf16 v[244:247], a[172:175], a[100:103], 0
ds_read_b64_tr_b16 a[190:191], v12 offset:7168
v_mfma_f32_16x16x32_bf16 v[240:243], a[172:175], a[96:99], 0
v_mfma_f32_16x16x32_bf16 v[224:227], a[168:171], a[96:99], 0
s_add_u32 s40, s40, 4096
s_add_u32 s41, s41, 4096
s_add_u32 s42, s42, 4096
s_add_u32 s43, s43, 4096
s_waitcnt vmcnt(9) lgkmcnt(4)
v_mfma_f32_16x16x32_bf16 a[0:3], a[176:179], a[112:115], a[0:3]
ds_read_b64_tr_b16 a[160:161], v11 offset:10240
v_mfma_f32_16x16x32_bf16 a[16:19], a[180:183], a[112:115], a[16:19]
ds_read_b64_tr_b16 a[162:163], v11 offset:11264
v_mfma_f32_16x16x32_bf16 a[20:23], a[180:183], a[116:119], a[20:23]
buffer_load_dwordx4 a[96:99], v2, s[16:19], s40 offen offset:0 sc1
v_mfma_f32_16x16x32_bf16 a[4:7], a[176:179], a[116:119], a[4:7]
v_mfma_f32_16x16x32_bf16 a[8:11], a[176:179], a[120:123], a[8:11]
ds_read_b64_tr_b16 a[164:165], v12 offset:10240
v_mfma_f32_16x16x32_bf16 a[24:27], a[180:183], a[120:123], a[24:27]
ds_read_b64_tr_b16 a[166:167], v12 offset:11264
v_mfma_f32_16x16x32_bf16 a[28:31], a[180:183], a[124:127], a[28:31]
buffer_load_dwordx4 a[100:103], v2, s[16:19], s41 offen offset:0 sc1
v_mfma_f32_16x16x32_bf16 a[12:15], a[176:179], a[124:127], a[12:15]
s_waitcnt lgkmcnt(4)
v_mfma_f32_16x16x32_bf16 a[44:47], a[184:187], a[124:127], a[44:47]
ds_read_b64_tr_b16 a[168:169], v13 offset:19456
v_mfma_f32_16x16x32_bf16 a[60:63], a[188:191], a[124:127], a[60:63]
ds_read_b64_tr_b16 a[170:171], v13 offset:23040
v_mfma_f32_16x16x32_bf16 a[56:59], a[188:191], a[120:123], a[56:59]
buffer_load_dwordx4 a[104:107], v2, s[16:19], s42 offen offset:0 sc1
v_mfma_f32_16x16x32_bf16 a[40:43], a[184:187], a[120:123], a[40:43]
v_mfma_f32_16x16x32_bf16 a[36:39], a[184:187], a[116:119], a[36:39]
ds_read_b64_tr_b16 a[172:173], v13 offset:19488
v_mfma_f32_16x16x32_bf16 a[52:55], a[188:191], a[116:119], a[52:55]
ds_read_b64_tr_b16 a[174:175], v13 offset:23072
v_mfma_f32_16x16x32_bf16 a[48:51], a[188:191], a[112:115], a[48:51]
buffer_load_dwordx4 a[108:111], v2, s[16:19], s43 offen offset:0 sc1
v_mfma_f32_16x16x32_bf16 a[32:35], a[184:187], a[112:115], a[32:35]
s_waitcnt lgkmcnt(4)
v_mfma_f32_16x16x32_bf16 a[64:67], a[112:115], a[160:163], a[64:67]
ds_read_b64_tr_b16 a[176:177], v13 offset:19520
v_mfma_f32_16x16x32_bf16 a[80:83], a[112:115], a[164:167], a[80:83]
ds_read_b64_tr_b16 a[178:179], v13 offset:23104
v_mfma_f32_16x16x32_bf16 a[84:87], a[116:119], a[164:167], a[84:87]
buffer_load_dword v30, v15, s[72:75], s76 offen
s_add_u32 s76, s76, s77
v_mfma_f32_16x16x32_bf16 a[68:71], a[116:119], a[160:163], a[68:71]
s_add_u32 m0, s44, 81920
v_mfma_f32_16x16x32_bf16 a[72:75], a[120:123], a[160:163], a[72:75]
ds_read_b64_tr_b16 a[180:181], v13 offset:19552
v_mfma_f32_16x16x32_bf16 a[88:91], a[120:123], a[164:167], a[88:91]
ds_read_b64_tr_b16 a[182:183], v13 offset:23136
v_mfma_f32_16x16x32_bf16 a[92:95], a[124:127], a[164:167], a[92:95]
buffer_load_dwordx4 v3, s[8:11], s36 offen lds
v_mfma_f32_16x16x32_bf16 a[76:79], a[124:127], a[160:163], a[76:79]
s_add_u32 m0, s44, 86016
s_waitcnt lgkmcnt(4)
v_mfma_f32_16x16x32_bf16 v[44:47], a[168:171], a[124:127], v[44:47]
ds_read_b64_tr_b16 a[184:185], v13 offset:19584
v_mfma_f32_16x16x32_bf16 v[60:63], a[172:175], a[124:127], v[60:63]
ds_read_b64_tr_b16 a[186:187], v13 offset:23168
v_mfma_f32_16x16x32_bf16 v[56:59], a[172:175], a[120:123], v[56:59]
buffer_load_dwordx4 v3, s[8:11], s37 offen lds
v_mfma_f32_16x16x32_bf16 v[40:43], a[168:171], a[120:123], v[40:43]
s_add_u32 m0, s44, 90112
v_mfma_f32_16x16x32_bf16 v[36:39], a[168:171], a[116:119], v[36:39]
ds_read_b64_tr_b16 a[188:189], v13 offset:19616
v_mfma_f32_16x16x32_bf16 v[52:55], a[172:175], a[116:119], v[52:55]
ds_read_b64_tr_b16 a[190:191], v13 offset:23200
v_mfma_f32_16x16x32_bf16 v[48:51], a[172:175], a[112:115], v[48:51]
buffer_load_dwordx4 v3, s[8:11], s38 offen lds
v_mfma_f32_16x16x32_bf16 v[32:35], a[168:171], a[112:115], v[32:35]
s_add_u32 m0, s45, 81920
s_waitcnt lgkmcnt(4)
v_mfma_f32_16x16x32_bf16 v[64:67], a[176:179], a[112:115], v[64:67]
ds_read_b64_tr_b16 a[160:161], v13 offset:19648
v_mfma_f32_16x16x32_bf16 v[80:83], a[180:183], a[112:115], v[80:83]
ds_read_b64_tr_b16 a[162:163], v13 offset:23232
v_mfma_f32_16x16x32_bf16 v[84:87], a[180:183], a[116:119], v[84:87]
buffer_load_dwordx4 v4, s[12:15], s39 offen lds
v_mfma_f32_16x16x32_bf16 v[68:71], a[176:179], a[116:119], v[68:71]
s_add_u32 m0, s45, 82944
v_mfma_f32_16x16x32_bf16 v[72:75], a[176:179], a[120:123], v[72:75]
ds_read_b64_tr_b16 a[164:165], v13 offset:33792
v_mfma_f32_16x16x32_bf16 v[88:91], a[180:183], a[120:123], v[88:91]
ds_read_b64_tr_b16 a[166:167], v13 offset:37376
v_mfma_f32_16x16x32_bf16 v[92:95], a[180:183], a[124:127], v[92:95]
buffer_load_dwordx4 v5, s[12:15], s39 offen lds
v_mfma_f32_16x16x32_bf16 v[76:79], a[176:179], a[124:127], v[76:79]
s_add_u32 m0, s45, 83968
s_waitcnt lgkmcnt(4)
v_mfma_f32_16x16x32_bf16 v[108:111], a[184:187], a[124:127], v[108:111]
ds_read_b64_tr_b16 a[168:169], v13 offset:33824
v_mfma_f32_16x16x32_bf16 v[124:127], a[188:191], a[124:127], v[124:127]
ds_read_b64_tr_b16 a[170:171], v13 offset:37408
v_mfma_f32_16x16x32_bf16 v[120:123], a[188:191], a[120:123], v[120:123]
buffer_load_dwordx4 v6, s[12:15], s39 offen lds
v_mfma_f32_16x16x32_bf16 v[104:107], a[184:187], a[120:123], v[104:107]
s_add_u32 m0, s45, 84992
v_mfma_f32_16x16x32_bf16 v[100:103], a[184:187], a[116:119], v[100:103]
ds_read_b64_tr_b16 a[172:173], v13 offset:33856
v_mfma_f32_16x16x32_bf16 v[116:119], a[188:191], a[116:119], v[116:119]
ds_read_b64_tr_b16 a[174:175], v13 offset:37440
v_mfma_f32_16x16x32_bf16 v[112:115], a[188:191], a[112:115], v[112:115]
buffer_load_dwordx4 v7, s[12:15], s39 offen lds
v_mfma_f32_16x16x32_bf16 v[96:99], a[184:187], a[112:115], v[96:99]
s_add_u32 m0, s45, 86016
s_waitcnt lgkmcnt(4)
v_mfma_f32_16x16x32_bf16 v[128:131], a[160:163], a[112:115], v[128:131]
ds_read_b64_tr_b16 a[176:177], v13 offset:33888
v_mfma_f32_16x16x32_bf16 v[144:147], a[164:167], a[112:115], v[144:147]
ds_read_b64_tr_b16 a[178:179], v13 offset:37472
v_mfma_f32_16x16x32_bf16 v[148:151], a[164:167], a[116:119], v[148:151]
buffer_load_dwordx4 v8, s[12:15], s39 offen lds
v_mfma_f32_16x16x32_bf16 v[132:135], a[160:163], a[116:119], v[132:135]
s_add_u32 m0, s45, 87040
v_mfma_f32_16x16x32_bf16 v[136:139], a[160:163], a[120:123], v[136:139]
ds_read_b64_tr_b16 a[180:181], v13 offset:33920
v_mfma_f32_16x16x32_bf16 v[152:155], a[164:167], a[120:123], v[152:155]
ds_read_b64_tr_b16 a[182:183], v13 offset:37504
v_mfma_f32_16x16x32_bf16 v[156:159], a[164:167], a[124:127], v[156:159]
buffer_load_dwordx4 v9, s[12:15], s39 offen lds
v_mfma_f32_16x16x32_bf16 v[140:143], a[160:163], a[124:127], v[140:143]
s_add_u32 m0, s45, 88064
s_waitcnt lgkmcnt(4)
v_mfma_f32_16x16x32_bf16 v[172:175], a[168:171], a[124:127], v[172:175]
ds_read_b64_tr_b16 a[184:185], v13 offset:33952
v_mfma_f32_16x16x32_bf16 v[188:191], a[172:175], a[124:127], v[188:191]
ds_read_b64_tr_b16 a[186:187], v13 offset:37536
v_mfma_f32_16x16x32_bf16 v[184:187], a[172:175], a[120:123], v[184:187]
buffer_load_dwordx4 v10, s[12:15], s39 offen lds
s_add_u32 s36, s36, 393216
s_add_u32 s37, s37, 393216
s_add_u32 s38, s38, 393216
s_add_u32 s39, s39, 458752
v_mfma_f32_16x16x32_bf16 v[168:171], a[168:171], a[120:123], v[168:171]
v_mfma_f32_16x16x32_bf16 v[164:167], a[168:171], a[116:119], v[164:167]
ds_read_b64_tr_b16 a[188:189], v13 offset:33984
v_mfma_f32_16x16x32_bf16 v[180:183], a[172:175], a[116:119], v[180:183]
ds_read_b64_tr_b16 a[190:191], v13 offset:37568
v_mfma_f32_16x16x32_bf16 v[176:179], a[172:175], a[112:115], v[176:179]
v_mfma_f32_16x16x32_bf16 v[160:163], a[168:171], a[112:115], v[160:163]
v_add_u32 v11, 40960, v11
v_add_u32 v12, 40960, v12
v_add_u32 v13, 40960, v13
s_waitcnt lgkmcnt(4)
v_mfma_f32_16x16x32_bf16 v[192:195], a[176:179], a[112:115], v[192:195]
s_waitcnt vmcnt(33)
s_barrier
ds_read_b64_tr_b16 a[160:161], v11 offset:0
v_mfma_f32_16x16x32_bf16 v[208:211], a[180:183], a[112:115], v[208:211]
ds_read_b64_tr_b16 a[162:163], v11 offset:1024
v_mfma_f32_16x16x32_bf16 v[212:215], a[180:183], a[116:119], v[212:215]
v_mfma_f32_16x16x32_bf16 v[196:199], a[176:179], a[116:119], v[196:199]
v_mfma_f32_16x16x32_bf16 v[200:203], a[176:179], a[120:123], v[200:203]
ds_read_b64_tr_b16 a[164:165], v12 offset:0
v_mfma_f32_16x16x32_bf16 v[216:219], a[180:183], a[120:123], v[216:219]
ds_read_b64_tr_b16 a[166:167], v12 offset:1024
v_mfma_f32_16x16x32_bf16 v[220:223], a[180:183], a[124:127], v[220:223]
v_mfma_f32_16x16x32_bf16 v[204:207], a[176:179], a[124:127], v[204:207]
s_waitcnt lgkmcnt(4)
v_mfma_f32_16x16x32_bf16 v[236:239], a[184:187], a[124:127], v[236:239]
ds_read_b64_tr_b16 a[168:169], v11 offset:4096
v_mfma_f32_16x16x32_bf16 v[252:255], a[188:191], a[124:127], v[252:255]
ds_read_b64_tr_b16 a[170:171], v11 offset:5120
v_mfma_f32_16x16x32_bf16 v[248:251], a[188:191], a[120:123], v[248:251]
v_mfma_f32_16x16x32_bf16 v[232:235], a[184:187], a[120:123], v[232:235]
v_mfma_f32_16x16x32_bf16 v[228:231], a[184:187], a[116:119], v[228:231]
ds_read_b64_tr_b16 a[172:173], v12 offset:4096
v_mfma_f32_16x16x32_bf16 v[244:247], a[188:191], a[116:119], v[244:247]
ds_read_b64_tr_b16 a[174:175], v12 offset:5120
v_mfma_f32_16x16x32_bf16 v[240:243], a[188:191], a[112:115], v[240:243]
v_mfma_f32_16x16x32_bf16 v[224:227], a[184:187], a[112:115], v[224:227]
s_branch L_g1m
.p2align 6
L_g1:
s_waitcnt vmcnt(24) lgkmcnt(4)
v_mfma_f32_16x16x32_bf16 a[0:3], a[160:163], a[96:99], a[0:3]
ds_read_b64_tr_b16 a[176:177], v11 offset:8192
v_mfma_f32_16x16x32_bf16 a[16:19], a[164:167], a[96:99], a[16:19]
ds_read_b64_tr_b16 a[178:179], v11 offset:9216
v_mfma_f32_16x16x32_bf16 a[20:23], a[164:167], a[100:103], a[20:23]
buffer_load_dwordx4 a[144:147], v2, s[16:19], s40 offen offset:3072 sc1
v_mfma_f32_16x16x32_bf16 a[4:7], a[160:163], a[100:103], a[4:7]
v_mfma_f32_16x16x32_bf16 a[8:11], a[160:163], a[104:107], a[8:11]
ds_read_b64_tr_b16 a[180:181], v12 offset:8192
v_mfma_f32_16x16x32_bf16 a[24:27], a[164:167], a[104:107], a[24:27]
ds_read_b64_tr_b16 a[182:183], v12 offset:9216
v_mfma_f32_16x16x32_bf16 a[28:31], a[164:167], a[108:111], a[28:31]
v_mfma_f32_16x16x32_bf16 a[12:15], a[160:163], a[108:111], a[12:15]
s_waitcnt lgkmcnt(4)
v_mfma_f32_16x16x32_bf16 a[44:47], a[168:171], a[108:111], a[44:47]
ds_read_b64_tr_b16 a[184:185], v13 offset:12288
v_mfma_f32_16x16x32_bf16 a[60:63], a[172:175], a[108:111], a[60:63]
ds_read_b64_tr_b16 a[186:187], v13 offset:15872
v_mfma_f32_16x16x32_bf16 a[56:59], a[172:175], a[104:107], a[56:59]
buffer_load_dwordx4 a[148:151], v2, s[16:19], s41 offen offset:3072 sc1
v_mfma_f32_16x16x32_bf16 a[40:43], a[168:171], a[104:107], a[40:43]
v_mfma_f32_16x16x32_bf16 a[36:39], a[168:171], a[100:103], a[36:39]
ds_read_b64_tr_b16 a[188:189], v13 offset:12320
v_mfma_f32_16x16x32_bf16 a[52:55], a[172:175], a[100:103], a[52:55]
ds_read_b64_tr_b16 a[190:191], v13 offset:15904
v_mfma_f32_16x16x32_bf16 a[48:51], a[172:175], a[96:99], a[48:51]
v_mfma_f32_16x16x32_bf16 a[32:35], a[168:171], a[96:99], a[32:35]
s_waitcnt lgkmcnt(4)
v_mfma_f32_16x16x32_bf16 a[64:67], a[96:99], a[176:179], a[64:67]
ds_read_b64_tr_b16 a[160:161], v13 offset:12352
v_mfma_f32_16x16x32_bf16 a[80:83], a[96:99], a[180:183], a[80:83]
ds_read_b64_tr_b16 a[162:163], v13 offset:15936
v_mfma_f32_16x16x32_bf16 a[84:87], a[100:103], a[180:183], a[84:87]
buffer_load_dwordx4 a[152:155], v2, s[16:19], s42 offen offset:3072 sc1
v_mfma_f32_16x16x32_bf16 a[68:71], a[100:103], a[176:179], a[68:71]
v_mfma_f32_16x16x32_bf16 a[72:75], a[104:107], a[176:179], a[72:75]
ds_read_b64_tr_b16 a[164:165], v13 offset:12384
v_mfma_f32_16x16x32_bf16 a[88:91], a[104:107], a[180:183], a[88:91]
ds_read_b64_tr_b16 a[166:167], v13 offset:15968
v_mfma_f32_16x16x32_bf16 a[92:95], a[108:111], a[180:183], a[92:95]
v_mfma_f32_16x16x32_bf16 a[76:79], a[108:111], a[176:179], a[76:79]
s_waitcnt lgkmcnt(4)
v_mfma_f32_16x16x32_bf16 v[44:47], a[184:187], a[108:111], v[44:47]
ds_read_b64_tr_b16 a[168:169], v13 offset:12416
v_mfma_f32_16x16x32_bf16 v[60:63], a[188:191], a[108:111], v[60:63]
ds_read_b64_tr_b16 a[170:171], v13 offset:16000
v_mfma_f32_16x16x32_bf16 v[56:59], a[188:191], a[104:107], v[56:59]
buffer_load_dwordx4 a[156:159], v2, s[16:19], s43 offen offset:3072 sc1
v_mfma_f32_16x16x32_bf16 v[40:43], a[184:187], a[104:107], v[40:43]
v_mfma_f32_16x16x32_bf16 v[36:39], a[184:187], a[100:103], v[36:39]
ds_read_b64_tr_b16 a[172:173], v13 offset:12448
v_mfma_f32_16x16x32_bf16 v[52:55], a[188:191], a[100:103], v[52:55]
ds_read_b64_tr_b16 a[174:175], v13 offset:16032
v_mfma_f32_16x16x32_bf16 v[48:51], a[188:191], a[96:99], v[48:51]
v_mfma_f32_16x16x32_bf16 v[32:35], a[184:187], a[96:99], v[32:35]
s_add_u32 m0, s44, 81920
s_waitcnt lgkmcnt(4)
v_mfma_f32_16x16x32_bf16 v[64:67], a[160:163], a[96:99], v[64:67]
ds_read_b64_tr_b16 a[176:177], v13 offset:12480
v_mfma_f32_16x16x32_bf16 v[80:83], a[164:167], a[96:99], v[80:83]
ds_read_b64_tr_b16 a[178:179], v13 offset:16064
v_mfma_f32_16x16x32_bf16 v[84:87], a[164:167], a[100:103], v[84:87]
buffer_load_dwordx4 v3, s[8:11], s36 offen lds
v_mfma_f32_16x16x32_bf16 v[68:71], a[160:163], a[100:103], v[68:71]
v_mfma_f32_16x16x32_bf16 v[72:75], a[160:163], a[104:107], v[72:75]
ds_read_b64_tr_b16 a[180:181], v13 offset:26624
v_mfma_f32_16x16x32_bf16 v[88:91], a[164:167], a[104:107], v[88:91]
ds_read_b64_tr_b16 a[182:183], v13 offset:30208
v_mfma_f32_16x16x32_bf16 v[92:95], a[164:167], a[108:111], v[92:95]
v_mfma_f32_16x16x32_bf16 v[76:79], a[160:163], a[108:111], v[76:79]
s_add_u32 m0, s44, 86016
s_waitcnt lgkmcnt(4)
v_mfma_f32_16x16x32_bf16 v[108:111], a[168:171], a[108:111], v[108:111]
ds_read_b64_tr_b16 a[184:185], v13 offset:26656
v_mfma_f32_16x16x32_bf16 v[124:127], a[172:175], a[108:111], v[124:127]
ds_read_b64_tr_b16 a[186:187], v13 offset:30240
v_mfma_f32_16x16x32_bf16 v[120:123], a[172:175], a[104:107], v[120:123]
buffer_load_dwordx4 v3, s[8:11], s37 offen lds
v_mfma_f32_16x16x32_bf16 v[104:107], a[168:171], a[104:107], v[104:107]
v_mfma_f32_16x16x32_bf16 v[100:103], a[168:171], a[100:103], v[100:103]
ds_read_b64_tr_b16 a[188:189], v13 offset:26688
v_mfma_f32_16x16x32_bf16 v[116:119], a[172:175], a[100:103], v[116:119]
ds_read_b64_tr_b16 a[190:191], v13 offset:30272
v_mfma_f32_16x16x32_bf16 v[112:115], a[172:175], a[96:99], v[112:115]
v_mfma_f32_16x16x32_bf16 v[96:99], a[168:171], a[96:99], v[96:99]
s_add_u32 m0, s44, 90112
s_waitcnt lgkmcnt(4)
v_mfma_f32_16x16x32_bf16 v[128:131], a[176:179], a[96:99], v[128:131]
ds_read_b64_tr_b16 a[160:161], v13 offset:26720
v_mfma_f32_16x16x32_bf16 v[144:147], a[180:183], a[96:99], v[144:147]
ds_read_b64_tr_b16 a[162:163], v13 offset:30304
v_mfma_f32_16x16x32_bf16 v[148:151], a[180:183], a[100:103], v[148:151]
buffer_load_dwordx4 v3, s[8:11], s38 offen lds
v_mfma_f32_16x16x32_bf16 v[132:135], a[176:179], a[100:103], v[132:135]
v_mfma_f32_16x16x32_bf16 v[136:139], a[176:179], a[104:107], v[136:139]
ds_read_b64_tr_b16 a[164:165], v13 offset:26752
v_mfma_f32_16x16x32_bf16 v[152:155], a[180:183], a[104:107], v[152:155]
ds_read_b64_tr_b16 a[166:167], v13 offset:30336
v_mfma_f32_16x16x32_bf16 v[156:159], a[180:183], a[108:111], v[156:159]
v_mfma_f32_16x16x32_bf16 v[140:143], a[176:179], a[108:111], v[140:143]
s_add_u32 m0, s45, 81920
s_waitcnt lgkmcnt(4)
v_mfma_f32_16x16x32_bf16 v[172:175], a[184:187], a[108:111], v[172:175]
ds_read_b64_tr_b16 a[168:169], v13 offset:26784
v_mfma_f32_16x16x32_bf16 v[188:191], a[188:191], a[108:111], v[188:191]
ds_read_b64_tr_b16 a[170:171], v13 offset:30368
v_mfma_f32_16x16x32_bf16 v[184:187], a[188:191], a[104:107], v[184:187]
buffer_load_dwordx4 v4, s[12:15], s39 offen lds
v_mfma_f32_16x16x32_bf16 v[168:171], a[184:187], a[104:107], v[168:171]
v_mfma_f32_16x16x32_bf16 v[164:167], a[184:187], a[100:103], v[164:167]
ds_read_b64_tr_b16 a[172:173], v13 offset:26816
v_mfma_f32_16x16x32_bf16 v[180:183], a[188:191], a[100:103], v[180:183]
ds_read_b64_tr_b16 a[174:175], v13 offset:30400
v_mfma_f32_16x16x32_bf16 v[176:179], a[188:191], a[96:99], v[176:179]
v_mfma_f32_16x16x32_bf16 v[160:163], a[184:187], a[96:99], v[160:163]
s_add_u32 m0, s45, 82944
s_waitcnt lgkmcnt(4)
v_mfma_f32_16x16x32_bf16 v[192:195], a[160:163], a[96:99], v[192:195]
ds_read_b64_tr_b16 a[176:177], v11 offset:2048
v_mfma_f32_16x16x32_bf16 v[208:211], a[164:167], a[96:99], v[208:211]
ds_read_b64_tr_b16 a[178:179], v11 offset:3072
v_mfma_f32_16x16x32_bf16 v[212:215], a[164:167], a[100:103], v[212:215]
buffer_load_dwordx4 v5, s[12:15], s39 offen lds
v_mfma_f32_16x16x32_bf16 v[196:199], a[160:163], a[100:103], v[196:199]
v_mfma_f32_16x16x32_bf16 v[200:203], a[160:163], a[104:107], v[200:203]
ds_read_b64_tr_b16 a[180:181], v12 offset:2048
v_mfma_f32_16x16x32_bf16 v[216:219], a[164:167], a[104:107], v[216:219]
ds_read_b64_tr_b16 a[182:183], v12 offset:3072
v_mfma_f32_16x16x32_bf16 v[220:223], a[164:167], a[108:111], v[220:223]
v_mfma_f32_16x16x32_bf16 v[204:207], a[160:163], a[108:111], v[204:207]
s_waitcnt lgkmcnt(4)
v_mfma_f32_16x16x32_bf16 v[236:239], a[168:171], a[108:111], v[236:239]
ds_read_b64_tr_b16 a[184:185], v11 offset:6144
v_mfma_f32_16x16x32_bf16 v[252:255], a[172:175], a[108:111], v[252:255]
ds_read_b64_tr_b16 a[186:187], v11 offset:7168
v_mfma_f32_16x16x32_bf16 v[248:251], a[172:175], a[104:107], v[248:251]
buffer_load_dword v30, v15, s[72:75], s76 offen
s_add_u32 s76, s76, s77
v_mfma_f32_16x16x32_bf16 v[232:235], a[168:171], a[104:107], v[232:235]
v_mfma_f32_16x16x32_bf16 v[228:231], a[168:171], a[100:103], v[228:231]
ds_read_b64_tr_b16 a[188:189], v12 offset:6144
v_mfma_f32_16x16x32_bf16 v[244:247], a[172:175], a[100:103], v[244:247]
ds_read_b64_tr_b16 a[190:191], v12 offset:7168
v_mfma_f32_16x16x32_bf16 v[240:243], a[172:175], a[96:99], v[240:243]
v_mfma_f32_16x16x32_bf16 v[224:227], a[168:171], a[96:99], v[224:227]
s_add_u32 s40, s40, 4096
s_add_u32 s41, s41, 4096
s_add_u32 s42, s42, 4096
s_add_u32 s43, s43, 4096
s_waitcnt vmcnt(25) lgkmcnt(4)
v_mfma_f32_16x16x32_bf16 a[0:3], a[176:179], a[112:115], a[0:3]
ds_read_b64_tr_b16 a[160:161], v11 offset:10240
v_mfma_f32_16x16x32_bf16 a[16:19], a[180:183], a[112:115], a[16:19]
ds_read_b64_tr_b16 a[162:163], v11 offset:11264
v_mfma_f32_16x16x32_bf16 a[20:23], a[180:183], a[116:119], a[20:23]
buffer_load_dwordx4 a[96:99], v2, s[16:19], s40 offen offset:0 sc1
v_mfma_f32_16x16x32_bf16 a[4:7], a[176:179], a[116:119], a[4:7]
v_mfma_f32_16x16x32_bf16 a[8:11], a[176:179], a[120:123], a[8:11]
ds_read_b64_tr_b16 a[164:165], v12 offset:10240
v_mfma_f32_16x16x32_bf16 a[24:27], a[180:183], a[120:123], a[24:27]
ds_read_b64_tr_b16 a[166:167], v12 offset:11264
v_mfma_f32_16x16x32_bf16 a[28:31], a[180:183], a[124:127], a[28:31]
v_mfma_f32_16x16x32_bf16 a[12:15], a[176:179], a[124:127], a[12:15]
s_waitcnt lgkmcnt(4)
v_mfma_f32_16x16x32_bf16 a[44:47], a[184:187], a[124:127], a[44:47]
ds_read_b64_tr_b16 a[168:169], v13 offset:19456
v_mfma_f32_16x16x32_bf16 a[60:63], a[188:191], a[124:127], a[60:63]
ds_read_b64_tr_b16 a[170:171], v13 offset:23040
v_mfma_f32_16x16x32_bf16 a[56:59], a[188:191], a[120:123], a[56:59]
buffer_load_dwordx4 a[100:103], v2, s[16:19], s41 offen offset:0 sc1
v_mfma_f32_16x16x32_bf16 a[40:43], a[184:187], a[120:123], a[40:43]
v_mfma_f32_16x16x32_bf16 a[36:39], a[184:187], a[116:119], a[36:39]
ds_read_b64_tr_b16 a[172:173], v13 offset:19488
v_mfma_f32_16x16x32_bf16 a[52:55], a[188:191], a[116:119], a[52:55]
ds_read_b64_tr_b16 a[174:175], v13 offset:23072
v_mfma_f32_16x16x32_bf16 a[48:51], a[188:191], a[112:115], a[48:51]
v_mfma_f32_16x16x32_bf16 a[32:35], a[184:187], a[112:115], a[32:35]
s_waitcnt lgkmcnt(4)
v_mfma_f32_16x16x32_bf16 a[64:67], a[112:115], a[160:163], a[64:67]
ds_read_b64_tr_b16 a[176:177], v13 offset:19520
v_mfma_f32_16x16x32_bf16 a[80:83], a[112:115], a[164:167], a[80:83]
ds_read_b64_tr_b16 a[178:179], v13 offset:23104
v_mfma_f32_16x16x32_bf16 a[84:87], a[116:119], a[164:167], a[84:87]
buffer_load_dwordx4 a[104:107], v2, s[16:19], s42 offen offset:0 sc1
v_mfma_f32_16x16x32_bf16 a[68:71], a[116:119], a[160:163], a[68:71]
v_mfma_f32_16x16x32_bf16 a[72:75], a[120:123], a[160:163], a[72:75]
ds_read_b64_tr_b16 a[180:181], v13 offset:19552
v_mfma_f32_16x16x32_bf16 a[88:91], a[120:123], a[164:167], a[88:91]
ds_read_b64_tr_b16 a[182:183], v13 offset:23136
v_mfma_f32_16x16x32_bf16 a[92:95], a[124:127], a[164:167], a[92:95]
v_mfma_f32_16x16x32_bf16 a[76:79], a[124:127], a[160:163], a[76:79]
s_waitcnt lgkmcnt(4)
v_mfma_f32_16x16x32_bf16 v[44:47], a[168:171], a[124:127], v[44:47]
ds_read_b64_tr_b16 a[184:185], v13 offset:19584
v_mfma_f32_16x16x32_bf16 v[60:63], a[172:175], a[124:127], v[60:63]
ds_read_b64_tr_b16 a[186:187], v13 offset:23168
v_mfma_f32_16x16x32_bf16 v[56:59], a[172:175], a[120:123], v[56:59]
buffer_load_dwordx4 a[108:111], v2, s[16:19], s43 offen offset:0 sc1
v_mfma_f32_16x16x32_bf16 v[40:43], a[168:171], a[120:123], v[40:43]
v_mfma_f32_16x16x32_bf16 v[36:39], a[168:171], a[116:119], v[36:39]
ds_read_b64_tr_b16 a[188:189], v13 offset:19616
v_mfma_f32_16x16x32_bf16 v[52:55], a[172:175], a[116:119], v[52:55]
ds_read_b64_tr_b16 a[190:191], v13 offset:23200
v_mfma_f32_16x16x32_bf16 v[48:51], a[172:175], a[112:115], v[48:51]
v_mfma_f32_16x16x32_bf16 v[32:35], a[168:171], a[112:115], v[32:35]
s_add_u32 m0, s45, 83968
s_waitcnt lgkmcnt(4)
v_mfma_f32_16x16x32_bf16 v[64:67], a[176:179], a[112:115], v[64:67]
ds_read_b64_tr_b16 a[160:161], v13 offset:19648
v_mfma_f32_16x16x32_bf16 v[80:83], a[180:183], a[112:115], v[80:83]
ds_read_b64_tr_b16 a[162:163], v13 offset:23232
v_mfma_f32_16x16x32_bf16 v[84:87], a[180:183], a[116:119], v[84:87]
buffer_load_dwordx4 v6, s[12:15], s39 offen lds
v_mfma_f32_16x16x32_bf16 v[68:71], a[176:179], a[116:119], v[68:71]
v_mfma_f32_16x16x32_bf16 v[72:75], a[176:179], a[120:123], v[72:75]
ds_read_b64_tr_b16 a[164:165], v13 offset:33792
v_mfma_f32_16x16x32_bf16 v[88:91], a[180:183], a[120:123], v[88:91]
ds_read_b64_tr_b16 a[166:167], v13 offset:37376
v_mfma_f32_16x16x32_bf16 v[92:95], a[180:183], a[124:127], v[92:95]
v_mfma_f32_16x16x32_bf16 v[76:79], a[176:179], a[124:127], v[76:79]
s_add_u32 m0, s45, 84992
s_waitcnt lgkmcnt(4)
v_mfma_f32_16x16x32_bf16 v[108:111], a[184:187], a[124:127], v[108:111]
ds_read_b64_tr_b16 a[168:169], v13 offset:33824
v_mfma_f32_16x16x32_bf16 v[124:127], a[188:191], a[124:127], v[124:127]
ds_read_b64_tr_b16 a[170:171], v13 offset:37408
v_mfma_f32_16x16x32_bf16 v[120:123], a[188:191], a[120:123], v[120:123]
buffer_load_dwordx4 v7, s[12:15], s39 offen lds
v_mfma_f32_16x16x32_bf16 v[104:107], a[184:187], a[120:123], v[104:107]
v_mfma_f32_16x16x32_bf16 v[100:103], a[184:187], a[116:119], v[100:103]
ds_read_b64_tr_b16 a[172:173], v13 offset:33856
v_mfma_f32_16x16x32_bf16 v[116:119], a[188:191], a[116:119], v[116:119]
ds_read_b64_tr_b16 a[174:175], v13 offset:37440
v_mfma_f32_16x16x32_bf16 v[112:115], a[188:191], a[112:115], v[112:115]
v_mfma_f32_16x16x32_bf16 v[96:99], a[184:187], a[112:115], v[96:99]
s_add_u32 m0, s45, 86016
s_waitcnt lgkmcnt(4)
v_mfma_f32_16x16x32_bf16 v[128:131], a[160:163], a[112:115], v[128:131]
ds_read_b64_tr_b16 a[176:177], v13 offset:33888
v_mfma_f32_16x16x32_bf16 v[144:147], a[164:167], a[112:115], v[144:147]
ds_read_b64_tr_b16 a[178:179], v13 offset:37472
v_mfma_f32_16x16x32_bf16 v[148:151], a[164:167], a[116:119], v[148:151]
buffer_load_dwordx4 v8, s[12:15], s39 offen lds
v_mfma_f32_16x16x32_bf16 v[132:135], a[160:163], a[116:119], v[132:135]
v_mfma_f32_16x16x32_bf16 v[136:139], a[160:163], a[120:123], v[136:139]
ds_read_b64_tr_b16 a[180:181], v13 offset:33920
v_mfma_f32_16x16x32_bf16 v[152:155], a[164:167], a[120:123], v[152:155]
ds_read_b64_tr_b16 a[182:183], v13 offset:37504
v_mfma_f32_16x16x32_bf16 v[156:159], a[164:167], a[124:127], v[156:159]
v_mfma_f32_16x16x32_bf16 v[140:143], a[160:163], a[124:127], v[140:143]
s_add_u32 m0, s45, 87040
s_waitcnt lgkmcnt(4)
v_mfma_f32_16x16x32_bf16 v[172:175], a[168:171], a[124:127], v[172:175]
ds_read_b64_tr_b16 a[184:185], v13 offset:33952
v_mfma_f32_16x16x32_bf16 v[188:191], a[172:175], a[124:127], v[188:191]
ds_read_b64_tr_b16 a[186:187], v13 offset:37536
v_mfma_f32_16x16x32_bf16 v[184:187], a[172:175], a[120:123], v[184:187]
buffer_load_dwordx4 v9, s[12:15], s39 offen lds
v_mfma_f32_16x16x32_bf16 v[168:171], a[168:171], a[120:123], v[168:171]
v_mfma_f32_16x16x32_bf16 v[164:167], a[168:171], a[116:119], v[164:167]
ds_read_b64_tr_b16 a[188:189], v13 offset:33984
v_mfma_f32_16x16x32_bf16 v[180:183], a[172:175], a[116:119], v[180:183]
ds_read_b64_tr_b16 a[190:191], v13 offset:37568
v_mfma_f32_16x16x32_bf16 v[176:179], a[172:175], a[112:115], v[176:179]
v_mfma_f32_16x16x32_bf16 v[160:163], a[168:171], a[112:115], v[160:163]
v_add_u32 v11, 40960, v11
v_add_u32 v12, 40960, v12
v_add_u32 v13, 40960, v13
s_add_u32 m0, s45, 88064
s_waitcnt lgkmcnt(4)
v_mfma_f32_16x16x32_bf16 v[192:195], a[176:179], a[112:115], v[192:195]
s_waitcnt vmcnt(18)
s_barrier
ds_read_b64_tr_b16 a[160:161], v11 offset:0
v_mfma_f32_16x16x32_bf16 v[208:211], a[180:183], a[112:115], v[208:211]
ds_read_b64_tr_b16 a[162:163], v11 offset:1024
v_mfma_f32_16x16x32_bf16 v[212:215], a[180:183], a[116:119], v[212:215]
buffer_load_dwordx4 v10, s[12:15], s39 offen lds
v_mfma_f32_16x16x32_bf16 v[196:199], a[176:179], a[116:119], v[196:199]
v_mfma_f32_16x16x32_bf16 v[200:203], a[176:179], a[120:123], v[200:203]
ds_read_b64_tr_b16 a[164:165], v12 offset:0
v_mfma_f32_16x16x32_bf16 v[216:219], a[180:183], a[120:123], v[216:219]
ds_read_b64_tr_b16 a[166:167], v12 offset:1024
v_mfma_f32_16x16x32_bf16 v[220:223], a[180:183], a[124:127], v[220:223]
v_mfma_f32_16x16x32_bf16 v[204:207], a[176:179], a[124:127], v[204:207]
s_waitcnt lgkmcnt(4)
v_mfma_f32_16x16x32_bf16 v[236:239], a[184:187], a[124:127], v[236:239]
ds_read_b64_tr_b16 a[168:169], v11 offset:4096
v_mfma_f32_16x16x32_bf16 v[252:255], a[188:191], a[124:127], v[252:255]
ds_read_b64_tr_b16 a[170:171], v11 offset:5120
v_mfma_f32_16x16x32_bf16 v[248:251], a[188:191], a[120:123], v[248:251]
s_add_u32 s36, s36, 393216
s_add_u32 s37, s37, 393216
s_add_u32 s38, s38, 393216
s_add_u32 s39, s39, 458752
v_mfma_f32_16x16x32_bf16 v[232:235], a[184:187], a[120:123], v[232:235]
v_mfma_f32_16x16x32_bf16 v[228:231], a[184:187], a[116:119], v[228:231]
ds_read_b64_tr_b16 a[172:173], v12 offset:4096
v_mfma_f32_16x16x32_bf16 v[244:247], a[188:191], a[116:119], v[244:247]
ds_read_b64_tr_b16 a[174:175], v12 offset:5120
v_mfma_f32_16x16x32_bf16 v[240:243], a[188:191], a[112:115], v[240:243]
v_mfma_f32_16x16x32_bf16 v[224:227], a[184:187], a[112:115], v[224:227]
L_g1m:
s_waitcnt vmcnt(19) lgkmcnt(4)
v_mfma_f32_16x16x32_bf16 a[0:3], a[160:163], a[128:131], a[0:3]
ds_read_b64_tr_b16 a[176:177], v11 offset:8192
v_mfma_f32_16x16x32_bf16 a[16:19], a[164:167], a[128:131], a[16:19]
ds_read_b64_tr_b16 a[178:179], v11 offset:9216
v_mfma_f32_16x16x32_bf16 a[20:23], a[164:167], a[132:135], a[20:23]
buffer_load_dwordx4 a[112:115], v2, s[16:19], s40 offen offset:1024 sc1
v_mfma_f32_16x16x32_bf16 a[4:7], a[160:163], a[132:135], a[4:7]
v_mfma_f32_16x16x32_bf16 a[8:11], a[160:163], a[136:139], a[8:11]
ds_read_b64_tr_b16 a[180:181], v12 offset:8192
v_mfma_f32_16x16x32_bf16 a[24:27], a[164:167], a[136:139], a[24:27]
ds_read_b64_tr_b16 a[182:183], v12 offset:9216
v_mfma_f32_16x16x32_bf16 a[28:31], a[164:167], a[140:143], a[28:31]
v_mfma_f32_16x16x32_bf16 a[12:15], a[160:163], a[140:143], a[12:15]
s_waitcnt lgkmcnt(4)
v_mfma_f32_16x16x32_bf16 a[44:47], a[168:171], a[140:143], a[44:47]
ds_read_b64_tr_b16 a[184:185], v13 offset:12288
v_mfma_f32_16x16x32_bf16 a[60:63], a[172:175], a[140:143], a[60:63]
ds_read_b64_tr_b16 a[186:187], v13 offset:15872
v_mfma_f32_16x16x32_bf16 a[56:59], a[172:175], a[136:139], a[56:59]
buffer_load_dwordx4 a[116:119], v2, s[16:19], s41 offen offset:1024 sc1
v_mfma_f32_16x16x32_bf16 a[40:43], a[168:171], a[136:139], a[40:43]
v_mfma_f32_16x16x32_bf16 a[36:39], a[168:171], a[132:135], a[36:39]
ds_read_b64_tr_b16 a[188:189], v13 offset:12320
v_mfma_f32_16x16x32_bf16 a[52:55], a[172:175], a[132:135], a[52:55]
ds_read_b64_tr_b16 a[190:191], v13 offset:15904
v_mfma_f32_16x16x32_bf16 a[48:51], a[172:175], a[128:131], a[48:51]
v_mfma_f32_16x16x32_bf16 a[32:35], a[168:171], a[128:131], a[32:35]
s_waitcnt lgkmcnt(4)
v_mfma_f32_16x16x32_bf16 a[64:67], a[128:131], a[176:179], a[64:67]
ds_read_b64_tr_b16 a[160:161], v13 offset:12352
v_mfma_f32_16x16x32_bf16 a[80:83], a[128:131], a[180:183], a[80:83]
ds_read_b64_tr_b16 a[162:163], v13 offset:15936
v_mfma_f32_16x16x32_bf16 a[84:87], a[132:135], a[180:183], a[84:87]
buffer_load_dwordx4 a[120:123], v2, s[16:19], s42 offen offset:1024 sc1
v_mfma_f32_16x16x32_bf16 a[68:71], a[132:135], a[176:179], a[68:71]
v_mfma_f32_16x16x32_bf16 a[72:75], a[136:139], a[176:179], a[72:75]
ds_read_b64_tr_b16 a[164:165], v13 offset:12384
v_mfma_f32_16x16x32_bf16 a[88:91], a[136:139], a[180:183], a[88:91]
ds_read_b64_tr_b16 a[166:167], v13 offset:15968
v_mfma_f32_16x16x32_bf16 a[92:95], a[140:143], a[180:183], a[92:95]
v_mfma_f32_16x16x32_bf16 a[76:79], a[140:143], a[176:179], a[76:79]
s_waitcnt lgkmcnt(4)
v_mfma_f32_16x16x32_bf16 v[44:47], a[184:187], a[140:143], v[44:47]
ds_read_b64_tr_b16 a[168:169], v13 offset:12416
v_mfma_f32_16x16x32_bf16 v[60:63], a[188:191], a[140:143], v[60:63]
ds_read_b64_tr_b16 a[170:171], v13 offset:16000
v_mfma_f32_16x16x32_bf16 v[56:59], a[188:191], a[136:139], v[56:59]
buffer_load_dwordx4 a[124:127], v2, s[16:19], s43 offen offset:1024 sc1
v_mfma_f32_16x16x32_bf16 v[40:43], a[184:187], a[136:139], v[40:43]
v_mfma_f32_16x16x32_bf16 v[36:39], a[184:187], a[132:135], v[36:39]
ds_read_b64_tr_b16 a[172:173], v13 offset:12448
v_mfma_f32_16x16x32_bf16 v[52:55], a[188:191], a[132:135], v[52:55]
ds_read_b64_tr_b16 a[174:175], v13 offset:16032
v_mfma_f32_16x16x32_bf16 v[48:51], a[188:191], a[128:131], v[48:51]
v_mfma_f32_16x16x32_bf16 v[32:35], a[184:187], a[128:131], v[32:35]
s_add_u32 m0, s44, 122880
s_waitcnt lgkmcnt(4)
v_mfma_f32_16x16x32_bf16 v[64:67], a[160:163], a[128:131], v[64:67]
ds_read_b64_tr_b16 a[176:177], v13 offset:12480
v_mfma_f32_16x16x32_bf16 v[80:83], a[164:167], a[128:131], v[80:83]
ds_read_b64_tr_b16 a[178:179], v13 offset:16064
v_mfma_f32_16x16x32_bf16 v[84:87], a[164:167], a[132:135], v[84:87]
buffer_load_dwordx4 v3, s[8:11], s36 offen lds
v_mfma_f32_16x16x32_bf16 v[68:71], a[160:163], a[132:135], v[68:71]
v_mfma_f32_16x16x32_bf16 v[72:75], a[160:163], a[136:139], v[72:75]
ds_read_b64_tr_b16 a[180:181], v13 offset:26624
v_mfma_f32_16x16x32_bf16 v[88:91], a[164:167], a[136:139], v[88:91]
ds_read_b64_tr_b16 a[182:183], v13 offset:30208
v_mfma_f32_16x16x32_bf16 v[92:95], a[164:167], a[140:143], v[92:95]
v_mfma_f32_16x16x32_bf16 v[76:79], a[160:163], a[140:143], v[76:79]
s_add_u32 m0, s44, 126976
s_waitcnt lgkmcnt(4)
v_mfma_f32_16x16x32_bf16 v[108:111], a[168:171], a[140:143], v[108:111]
ds_read_b64_tr_b16 a[184:185], v13 offset:26656
v_mfma_f32_16x16x32_bf16 v[124:127], a[172:175], a[140:143], v[124:127]
ds_read_b64_tr_b16 a[186:187], v13 offset:30240
v_mfma_f32_16x16x32_bf16 v[120:123], a[172:175], a[136:139], v[120:123]
buffer_load_dwordx4 v3, s[8:11], s37 offen lds
v_mfma_f32_16x16x32_bf16 v[104:107], a[168:171], a[136:139], v[104:107]
v_mfma_f32_16x16x32_bf16 v[100:103], a[168:171], a[132:135], v[100:103]
ds_read_b64_tr_b16 a[188:189], v13 offset:26688
v_mfma_f32_16x16x32_bf16 v[116:119], a[172:175], a[132:135], v[116:119]
ds_read_b64_tr_b16 a[190:191], v13 offset:30272
v_mfma_f32_16x16x32_bf16 v[112:115], a[172:175], a[128:131], v[112:115]
v_mfma_f32_16x16x32_bf16 v[96:99], a[168:171], a[128:131], v[96:99]
s_add_u32 m0, s44, 131072
s_waitcnt lgkmcnt(4)
v_mfma_f32_16x16x32_bf16 v[128:131], a[176:179], a[128:131], v[128:131]
ds_read_b64_tr_b16 a[160:161], v13 offset:26720
v_mfma_f32_16x16x32_bf16 v[144:147], a[180:183], a[128:131], v[144:147]
ds_read_b64_tr_b16 a[162:163], v13 offset:30304
v_mfma_f32_16x16x32_bf16 v[148:151], a[180:183], a[132:135], v[148:151]
buffer_load_dwordx4 v3, s[8:11], s38 offen lds
v_mfma_f32_16x16x32_bf16 v[132:135], a[176:179], a[132:135], v[132:135]
v_mfma_f32_16x16x32_bf16 v[136:139], a[176:179], a[136:139], v[136:139]
ds_read_b64_tr_b16 a[164:165], v13 offset:26752
v_mfma_f32_16x16x32_bf16 v[152:155], a[180:183], a[136:139], v[152:155]
ds_read_b64_tr_b16 a[166:167], v13 offset:30336
v_mfma_f32_16x16x32_bf16 v[156:159], a[180:183], a[140:143], v[156:159]
v_mfma_f32_16x16x32_bf16 v[140:143], a[176:179], a[140:143], v[140:143]
s_add_u32 m0, s45, 122880
s_waitcnt lgkmcnt(4)
v_mfma_f32_16x16x32_bf16 v[172:175], a[184:187], a[140:143], v[172:175]
ds_read_b64_tr_b16 a[168:169], v13 offset:26784
v_mfma_f32_16x16x32_bf16 v[188:191], a[188:191], a[140:143], v[188:191]
ds_read_b64_tr_b16 a[170:171], v13 offset:30368
v_mfma_f32_16x16x32_bf16 v[184:187], a[188:191], a[136:139], v[184:187]
buffer_load_dwordx4 v4, s[12:15], s39 offen lds
v_mfma_f32_16x16x32_bf16 v[168:171], a[184:187], a[136:139], v[168:171]
v_mfma_f32_16x16x32_bf16 v[164:167], a[184:187], a[132:135], v[164:167]
ds_read_b64_tr_b16 a[172:173], v13 offset:26816
v_mfma_f32_16x16x32_bf16 v[180:183], a[188:191], a[132:135], v[180:183]
ds_read_b64_tr_b16 a[174:175], v13 offset:30400
v_mfma_f32_16x16x32_bf16 v[176:179], a[188:191], a[128:131], v[176:179]
v_mfma_f32_16x16x32_bf16 v[160:163], a[184:187], a[128:131], v[160:163]
s_add_u32 m0, s45, 123904
s_waitcnt lgkmcnt(4)
v_mfma_f32_16x16x32_bf16 v[192:195], a[160:163], a[128:131], v[192:195]
ds_read_b64_tr_b16 a[176:177], v11 offset:2048
v_mfma_f32_16x16x32_bf16 v[208:211], a[164:167], a[128:131], v[208:211]
ds_read_b64_tr_b16 a[178:179], v11 offset:3072
v_mfma_f32_16x16x32_bf16 v[212:215], a[164:167], a[132:135], v[212:215]
buffer_load_dwordx4 v5, s[12:15], s39 offen lds
v_mfma_f32_16x16x32_bf16 v[196:199], a[160:163], a[132:135], v[196:199]
v_mfma_f32_16x16x32_bf16 v[200:203], a[160:163], a[136:139], v[200:203]
ds_read_b64_tr_b16 a[180:181], v12 offset:2048
v_mfma_f32_16x16x32_bf16 v[216:219], a[164:167], a[136:139], v[216:219]
ds_read_b64_tr_b16 a[182:183], v12 offset:3072
v_mfma_f32_16x16x32_bf16 v[220:223], a[164:167], a[140:143], v[220:223]
v_mfma_f32_16x16x32_bf16 v[204:207], a[160:163], a[140:143], v[204:207]
s_waitcnt lgkmcnt(4)
v_mfma_f32_16x16x32_bf16 v[236:239], a[168:171], a[140:143], v[236:239]
ds_read_b64_tr_b16 a[184:185], v11 offset:6144
v_mfma_f32_16x16x32_bf16 v[252:255], a[172:175], a[140:143], v[252:255]
ds_read_b64_tr_b16 a[186:187], v11 offset:7168
v_mfma_f32_16x16x32_bf16 v[248:251], a[172:175], a[136:139], v[248:251]
buffer_load_dword v30, v15, s[72:75], s76 offen
s_add_u32 s76, s76, s77
v_mfma_f32_16x16x32_bf16 v[232:235], a[168:171], a[136:139], v[232:235]
v_mfma_f32_16x16x32_bf16 v[228:231], a[168:171], a[132:135], v[228:231]
ds_read_b64_tr_b16 a[188:189], v12 offset:6144
v_mfma_f32_16x16x32_bf16 v[244:247], a[172:175], a[132:135], v[244:247]
ds_read_b64_tr_b16 a[190:191], v12 offset:7168
v_mfma_f32_16x16x32_bf16 v[240:243], a[172:175], a[128:131], v[240:243]
v_mfma_f32_16x16x32_bf16 v[224:227], a[168:171], a[128:131], v[224:227]
s_waitcnt vmcnt(25) lgkmcnt(4)
v_mfma_f32_16x16x32_bf16 a[0:3], a[176:179], a[144:147], a[0:3]
ds_read_b64_tr_b16 a[160:161], v11 offset:10240
v_mfma_f32_16x16x32_bf16 a[16:19], a[180:183], a[144:147], a[16:19]
ds_read_b64_tr_b16 a[162:163], v11 offset:11264
v_mfma_f32_16x16x32_bf16 a[20:23], a[180:183], a[148:151], a[20:23]
buffer_load_dwordx4 a[128:131], v2, s[16:19], s40 offen offset:2048 sc1
v_mfma_f32_16x16x32_bf16 a[4:7], a[176:179], a[148:151], a[4:7]
v_mfma_f32_16x16x32_bf16 a[8:11], a[176:179], a[152:155], a[8:11]
ds_read_b64_tr_b16 a[164:165], v12 offset:10240
v_mfma_f32_16x16x32_bf16 a[24:27], a[180:183], a[152:155], a[24:27]
ds_read_b64_tr_b16 a[166:167], v12 offset:11264
v_mfma_f32_16x16x32_bf16 a[28:31], a[180:183], a[156:159], a[28:31]
v_mfma_f32_16x16x32_bf16 a[12:15], a[176:179], a[156:159], a[12:15]
s_waitcnt lgkmcnt(4)
v_mfma_f32_16x16x32_bf16 a[44:47], a[184:187], a[156:159], a[44:47]
ds_read_b64_tr_b16 a[168:169], v13 offset:19456
v_mfma_f32_16x16x32_bf16 a[60:63], a[188:191], a[156:159], a[60:63]
ds_read_b64_tr_b16 a[170:171], v13 offset:23040
v_mfma_f32_16x16x32_bf16 a[56:59], a[188:191], a[152:155], a[56:59]
buffer_load_dwordx4 a[132:135], v2, s[16:19], s41 offen offset:2048 sc1
v_mfma_f32_16x16x32_bf16 a[40:43], a[184:187], a[152:155], a[40:43]
v_mfma_f32_16x16x32_bf16 a[36:39], a[184:187], a[148:151], a[36:39]
ds_read_b64_tr_b16 a[172:173], v13 offset:19488
v_mfma_f32_16x16x32_bf16 a[52:55], a[188:191], a[148:151], a[52:55]
ds_read_b64_tr_b16 a[174:175], v13 offset:23072
v_mfma_f32_16x16x32_bf16 a[48:51], a[188:191], a[144:147], a[48:51]
v_mfma_f32_16x16x32_bf16 a[32:35], a[184:187], a[144:147], a[32:35]
s_waitcnt lgkmcnt(4)
v_mfma_f32_16x16x32_bf16 a[64:67], a[144:147], a[160:163], a[64:67]
ds_read_b64_tr_b16 a[176:177], v13 offset:19520
v_mfma_f32_16x16x32_bf16 a[80:83], a[144:147], a[164:167], a[80:83]
ds_read_b64_tr_b16 a[178:179], v13 offset:23104
v_mfma_f32_16x16x32_bf16 a[84:87], a[148:151], a[164:167], a[84:87]
buffer_load_dwordx4 a[136:139], v2, s[16:19], s42 offen offset:2048 sc1
v_mfma_f32_16x16x32_bf16 a[68:71], a[148:151], a[160:163], a[68:71]
v_mfma_f32_16x16x32_bf16 a[72:75], a[152:155], a[160:163], a[72:75]
ds_read_b64_tr_b16 a[180:181], v13 offset:19552
v_mfma_f32_16x16x32_bf16 a[88:91], a[152:155], a[164:167], a[88:91]
ds_read_b64_tr_b16 a[182:183], v13 offset:23136
v_mfma_f32_16x16x32_bf16 a[92:95], a[156:159], a[164:167], a[92:95]
v_mfma_f32_16x16x32_bf16 a[76:79], a[156:159], a[160:163], a[76:79]
s_waitcnt lgkmcnt(4)
v_mfma_f32_16x16x32_bf16 v[44:47], a[168:171], a[156:159], v[44:47]
ds_read_b64_tr_b16 a[184:185], v13 offset:19584
v_mfma_f32_16x16x32_bf16 v[60:63], a[172:175], a[156:159], v[60:63]
ds_read_b64_tr_b16 a[186:187], v13 offset:23168
v_mfma_f32_16x16x32_bf16 v[56:59], a[172:175], a[152:155], v[56:59]
buffer_load_dwordx4 a[140:143], v2, s[16:19], s43 offen offset:2048 sc1
v_mfma_f32_16x16x32_bf16 v[40:43], a[168:171], a[152:155], v[40:43]
v_mfma_f32_16x16x32_bf16 v[36:39], a[168:171], a[148:151], v[36:39]
ds_read_b64_tr_b16 a[188:189], v13 offset:19616
v_mfma_f32_16x16x32_bf16 v[52:55], a[172:175], a[148:151], v[52:55]
ds_read_b64_tr_b16 a[190:191], v13 offset:23200
v_mfma_f32_16x16x32_bf16 v[48:51], a[172:175], a[144:147], v[48:51]
v_mfma_f32_16x16x32_bf16 v[32:35], a[168:171], a[144:147], v[32:35]
s_add_u32 m0, s45, 124928
s_waitcnt lgkmcnt(4)
v_mfma_f32_16x16x32_bf16 v[64:67], a[176:179], a[144:147], v[64:67]
ds_read_b64_tr_b16 a[160:161], v13 offset:19648
v_mfma_f32_16x16x32_bf16 v[80:83], a[180:183], a[144:147], v[80:83]
ds_read_b64_tr_b16 a[162:163], v13 offset:23232
v_mfma_f32_16x16x32_bf16 v[84:87], a[180:183], a[148:151], v[84:87]
buffer_load_dwordx4 v6, s[12:15], s39 offen lds
v_mfma_f32_16x16x32_bf16 v[68:71], a[176:179], a[148:151], v[68:71]
v_mfma_f32_16x16x32_bf16 v[72:75], a[176:179], a[152:155], v[72:75]
ds_read_b64_tr_b16 a[164:165], v13 offset:33792
v_mfma_f32_16x16x32_bf16 v[88:91], a[180:183], a[152:155], v[88:91]
ds_read_b64_tr_b16 a[166:167], v13 offset:37376
v_mfma_f32_16x16x32_bf16 v[92:95], a[180:183], a[156:159], v[92:95]
v_mfma_f32_16x16x32_bf16 v[76:79], a[176:179], a[156:159], v[76:79]
s_add_u32 m0, s45, 125952
s_waitcnt lgkmcnt(4)
v_mfma_f32_16x16x32_bf16 v[108:111], a[184:187], a[156:159], v[108:111]
ds_read_b64_tr_b16 a[168:169], v13 offset:33824
v_mfma_f32_16x16x32_bf16 v[124:127], a[188:191], a[156:159], v[124:127]
ds_read_b64_tr_b16 a[170:171], v13 offset:37408
v_mfma_f32_16x16x32_bf16 v[120:123], a[188:191], a[152:155], v[120:123]
buffer_load_dwordx4 v7, s[12:15], s39 offen lds
v_mfma_f32_16x16x32_bf16 v[104:107], a[184:187], a[152:155], v[104:107]
v_mfma_f32_16x16x32_bf16 v[100:103], a[184:187], a[148:151], v[100:103]
ds_read_b64_tr_b16 a[172:173], v13 offset:33856
v_mfma_f32_16x16x32_bf16 v[116:119], a[188:191], a[148:151], v[116:119]
ds_read_b64_tr_b16 a[174:175], v13 offset:37440
v_mfma_f32_16x16x32_bf16 v[112:115], a[188:191], a[144:147], v[112:115]
v_mfma_f32_16x16x32_bf16 v[96:99], a[184:187], a[144:147], v[96:99]
s_add_u32 m0, s45, 126976
s_waitcnt lgkmcnt(4)
v_mfma_f32_16x16x32_bf16 v[128:131], a[160:163], a[144:147], v[128:131]
ds_read_b64_tr_b16 a[176:177], v13 offset:33888
v_mfma_f32_16x16x32_bf16 v[144:147], a[164:167], a[144:147], v[144:147]
ds_read_b64_tr_b16 a[178:179], v13 offset:37472
v_mfma_f32_16x16x32_bf16 v[148:151], a[164:167], a[148:151], v[148:151]
buffer_load_dwordx4 v8, s[12:15], s39 offen lds
v_mfma_f32_16x16x32_bf16 v[132:135], a[160:163], a[148:151], v[132:135]
v_mfma_f32_16x16x32_bf16 v[136:139], a[160:163], a[152:155], v[136:139]
ds_read_b64_tr_b16 a[180:181], v13 offset:33920
v_mfma_f32_16x16x32_bf16 v[152:155], a[164:167], a[152:155], v[152:155]
ds_read_b64_tr_b16 a[182:183], v13 offset:37504
v_mfma_f32_16x16x32_bf16 v[156:159], a[164:167], a[156:159], v[156:159]
v_mfma_f32_16x16x32_bf16 v[140:143], a[160:163], a[156:159], v[140:143]
s_add_u32 m0, s45, 128000
s_waitcnt lgkmcnt(4)
v_mfma_f32_16x16x32_bf16 v[172:175], a[168:171], a[156:159], v[172:175]
ds_read_b64_tr_b16 a[184:185], v13 offset:33952
v_mfma_f32_16x16x32_bf16 v[188:191], a[172:175], a[156:159], v[188:191]
ds_read_b64_tr_b16 a[186:187], v13 offset:37536
v_mfma_f32_16x16x32_bf16 v[184:187], a[172:175], a[152:155], v[184:187]
buffer_load_dwordx4 v9, s[12:15], s39 offen lds
v_mfma_f32_16x16x32_bf16 v[168:171], a[168:171], a[152:155], v[168:171]
v_mfma_f32_16x16x32_bf16 v[164:167], a[168:171], a[148:151], v[164:167]
ds_read_b64_tr_b16 a[188:189], v13 offset:33984
v_mfma_f32_16x16x32_bf16 v[180:183], a[172:175], a[148:151], v[180:183]
ds_read_b64_tr_b16 a[190:191], v13 offset:37568
v_mfma_f32_16x16x32_bf16 v[176:179], a[172:175], a[144:147], v[176:179]
v_mfma_f32_16x16x32_bf16 v[160:163], a[168:171], a[144:147], v[160:163]
v_add_u32 v11, 40960, v11
v_add_u32 v12, 40960, v12
v_add_u32 v13, 40960, v13
s_add_u32 m0, s45, 129024
s_waitcnt lgkmcnt(4)
v_mfma_f32_16x16x32_bf16 v[192:195], a[176:179], a[144:147], v[192:195]
s_waitcnt vmcnt(18)
s_barrier
ds_read_b64_tr_b16 a[160:161], v11 offset:0
v_mfma_f32_16x16x32_bf16 v[208:211], a[180:183], a[144:147], v[208:211]
ds_read_b64_tr_b16 a[162:163], v11 offset:1024
v_mfma_f32_16x16x32_bf16 v[212:215], a[180:183], a[148:151], v[212:215]
buffer_load_dwordx4 v10, s[12:15], s39 offen lds
v_mfma_f32_16x16x32_bf16 v[196:199], a[176:179], a[148:151], v[196:199]
v_mfma_f32_16x16x32_bf16 v[200:203], a[176:179], a[152:155], v[200:203]
ds_read_b64_tr_b16 a[164:165], v12 offset:0
v_mfma_f32_16x16x32_bf16 v[216:219], a[180:183], a[152:155], v[216:219]
ds_read_b64_tr_b16 a[166:167], v12 offset:1024
v_mfma_f32_16x16x32_bf16 v[220:223], a[180:183], a[156:159], v[220:223]
v_mfma_f32_16x16x32_bf16 v[204:207], a[176:179], a[156:159], v[204:207]
s_waitcnt lgkmcnt(4)
v_mfma_f32_16x16x32_bf16 v[236:239], a[184:187], a[156:159], v[236:239]
ds_read_b64_tr_b16 a[168:169], v11 offset:4096
v_mfma_f32_16x16x32_bf16 v[252:255], a[188:191], a[156:159], v[252:255]
ds_read_b64_tr_b16 a[170:171], v11 offset:5120
v_mfma_f32_16x16x32_bf16 v[248:251], a[188:191], a[152:155], v[248:251]
s_add_u32 s36, s36, 393216
s_add_u32 s37, s37, 393216
s_add_u32 s38, s38, 393216
s_add_u32 s39, s39, 458752
v_mfma_f32_16x16x32_bf16 v[232:235], a[184:187], a[152:155], v[232:235]
v_mfma_f32_16x16x32_bf16 v[228:231], a[184:187], a[148:151], v[228:231]
ds_read_b64_tr_b16 a[172:173], v12 offset:4096
v_mfma_f32_16x16x32_bf16 v[244:247], a[188:191], a[148:151], v[244:247]
ds_read_b64_tr_b16 a[174:175], v12 offset:5120
v_mfma_f32_16x16x32_bf16 v[240:243], a[188:191], a[144:147], v[240:243]
v_mfma_f32_16x16x32_bf16 v[224:227], a[184:187], a[144:147], v[224:227]
s_waitcnt vmcnt(24) lgkmcnt(4)
v_mfma_f32_16x16x32_bf16 a[0:3], a[160:163], a[96:99], a[0:3]
ds_read_b64_tr_b16 a[176:177], v11 offset:8192
v_mfma_f32_16x16x32_bf16 a[16:19], a[164:167], a[96:99], a[16:19]
ds_read_b64_tr_b16 a[178:179], v11 offset:9216
v_mfma_f32_16x16x32_bf16 a[20:23], a[164:167], a[100:103], a[20:23]
buffer_load_dwordx4 a[144:147], v2, s[16:19], s40 offen offset:3072 sc1
v_mfma_f32_16x16x32_bf16 a[4:7], a[160:163], a[100:103], a[4:7]
v_mfma_f32_16x16x32_bf16 a[8:11], a[160:163], a[104:107], a[8:11]
ds_read_b64_tr_b16 a[180:181], v12 offset:8192
v_mfma_f32_16x16x32_bf16 a[24:27], a[164:167], a[104:107], a[24:27]
ds_read_b64_tr_b16 a[182:183], v12 offset:9216
v_mfma_f32_16x16x32_bf16 a[28:31], a[164:167], a[108:111], a[28:31]
v_mfma_f32_16x16x32_bf16 a[12:15], a[160:163], a[108:111], a[12:15]
s_waitcnt lgkmcnt(4)
v_mfma_f32_16x16x32_bf16 a[44:47], a[168:171], a[108:111], a[44:47]
ds_read_b64_tr_b16 a[184:185], v13 offset:12288
v_mfma_f32_16x16x32_bf16 a[60:63], a[172:175], a[108:111], a[60:63]
ds_read_b64_tr_b16 a[186:187], v13 offset:15872
v_mfma_f32_16x16x32_bf16 a[56:59], a[172:175], a[104:107], a[56:59]
buffer_load_dwordx4 a[148:151], v2, s[16:19], s41 offen offset:3072 sc1
v_mfma_f32_16x16x32_bf16 a[40:43], a[168:171], a[104:107], a[40:43]
v_mfma_f32_16x16x32_bf16 a[36:39], a[168:171], a[100:103], a[36:39]
ds_read_b64_tr_b16 a[188:189], v13 offset:12320
v_mfma_f32_16x16x32_bf16 a[52:55], a[172:175], a[100:103], a[52:55]
ds_read_b64_tr_b16 a[190:191], v13 offset:15904
v_mfma_f32_16x16x32_bf16 a[48:51], a[172:175], a[96:99], a[48:51]
v_mfma_f32_16x16x32_bf16 a[32:35], a[168:171], a[96:99], a[32:35]
s_waitcnt lgkmcnt(4)
v_mfma_f32_16x16x32_bf16 a[64:67], a[96:99], a[176:179], a[64:67]
ds_read_b64_tr_b16 a[160:161], v13 offset:12352
v_mfma_f32_16x16x32_bf16 a[80:83], a[96:99], a[180:183], a[80:83]
ds_read_b64_tr_b16 a[162:163], v13 offset:15936
v_mfma_f32_16x16x32_bf16 a[84:87], a[100:103], a[180:183], a[84:87]
buffer_load_dwordx4 a[152:155], v2, s[16:19], s42 offen offset:3072 sc1
v_mfma_f32_16x16x32_bf16 a[68:71], a[100:103], a[176:179], a[68:71]
v_mfma_f32_16x16x32_bf16 a[72:75], a[104:107], a[176:179], a[72:75]
ds_read_b64_tr_b16 a[164:165], v13 offset:12384
v_mfma_f32_16x16x32_bf16 a[88:91], a[104:107], a[180:183], a[88:91]
ds_read_b64_tr_b16 a[166:167], v13 offset:15968
v_mfma_f32_16x16x32_bf16 a[92:95], a[108:111], a[180:183], a[92:95]
v_mfma_f32_16x16x32_bf16 a[76:79], a[108:111], a[176:179], a[76:79]
s_waitcnt lgkmcnt(4)
v_mfma_f32_16x16x32_bf16 v[44:47], a[184:187], a[108:111], v[44:47]
ds_read_b64_tr_b16 a[168:169], v13 offset:12416
v_mfma_f32_16x16x32_bf16 v[60:63], a[188:191], a[108:111], v[60:63]
ds_read_b64_tr_b16 a[170:171], v13 offset:16000
v_mfma_f32_16x16x32_bf16 v[56:59], a[188:191], a[104:107], v[56:59]
buffer_load_dwordx4 a[156:159], v2, s[16:19], s43 offen offset:3072 sc1
v_mfma_f32_16x16x32_bf16 v[40:43], a[184:187], a[104:107], v[40:43]
v_mfma_f32_16x16x32_bf16 v[36:39], a[184:187], a[100:103], v[36:39]
ds_read_b64_tr_b16 a[172:173], v13 offset:12448
v_mfma_f32_16x16x32_bf16 v[52:55], a[188:191], a[100:103], v[52:55]
ds_read_b64_tr_b16 a[174:175], v13 offset:16032
v_mfma_f32_16x16x32_bf16 v[48:51], a[188:191], a[96:99], v[48:51]
v_mfma_f32_16x16x32_bf16 v[32:35], a[184:187], a[96:99], v[32:35]
s_add_u32 m0, s44, 0
s_waitcnt lgkmcnt(4)
v_mfma_f32_16x16x32_bf16 v[64:67], a[160:163], a[96:99], v[64:67]
ds_read_b64_tr_b16 a[176:177], v13 offset:12480
v_mfma_f32_16x16x32_bf16 v[80:83], a[164:167], a[96:99], v[80:83]
ds_read_b64_tr_b16 a[178:179], v13 offset:16064
v_mfma_f32_16x16x32_bf16 v[84:87], a[164:167], a[100:103], v[84:87]
buffer_load_dwordx4 v3, s[8:11], s36 offen lds
v_mfma_f32_16x16x32_bf16 v[68:71], a[160:163], a[100:103], v[68:71]
v_mfma_f32_16x16x32_bf16 v[72:75], a[160:163], a[104:107], v[72:75]
ds_read_b64_tr_b16 a[180:181], v13 offset:26624
v_mfma_f32_16x16x32_bf16 v[88:91], a[164:167], a[104:107], v[88:91]
ds_read_b64_tr_b16 a[182:183], v13 offset:30208
v_mfma_f32_16x16x32_bf16 v[92:95], a[164:167], a[108:111], v[92:95]
v_mfma_f32_16x16x32_bf16 v[76:79], a[160:163], a[108:111], v[76:79]
s_add_u32 m0, s44, 4096
s_waitcnt lgkmcnt(4)
v_mfma_f32_16x16x32_bf16 v[108:111], a[168:171], a[108:111], v[108:111]
ds_read_b64_tr_b16 a[184:185], v13 offset:26656
v_mfma_f32_16x16x32_bf16 v[124:127], a[172:175], a[108:111], v[124:127]
ds_read_b64_tr_b16 a[186:187], v13 offset:30240
v_mfma_f32_16x16x32_bf16 v[120:123], a[172:175], a[104:107], v[120:123]
buffer_load_dwordx4 v3, s[8:11], s37 offen lds
v_mfma_f32_16x16x32_bf16 v[104:107], a[168:171], a[104:107], v[104:107]
v_mfma_f32_16x16x32_bf16 v[100:103], a[168:171], a[100:103], v[100:103]
ds_read_b64_tr_b16 a[188:189], v13 offset:26688
v_mfma_f32_16x16x32_bf16 v[116:119], a[172:175], a[100:103], v[116:119]
ds_read_b64_tr_b16 a[190:191], v13 offset:30272
v_mfma_f32_16x16x32_bf16 v[112:115], a[172:175], a[96:99], v[112:115]
v_mfma_f32_16x16x32_bf16 v[96:99], a[168:171], a[96:99], v[96:99]
s_add_u32 m0, s44, 8192
s_waitcnt lgkmcnt(4)
v_mfma_f32_16x16x32_bf16 v[128:131], a[176:179], a[96:99], v[128:131]
ds_read_b64_tr_b16 a[160:161], v13 offset:26720
v_mfma_f32_16x16x32_bf16 v[144:147], a[180:183], a[96:99], v[144:147]
ds_read_b64_tr_b16 a[162:163], v13 offset:30304
v_mfma_f32_16x16x32_bf16 v[148:151], a[180:183], a[100:103], v[148:151]
buffer_load_dwordx4 v3, s[8:11], s38 offen lds
v_mfma_f32_16x16x32_bf16 v[132:135], a[176:179], a[100:103], v[132:135]
v_mfma_f32_16x16x32_bf16 v[136:139], a[176:179], a[104:107], v[136:139]
ds_read_b64_tr_b16 a[164:165], v13 offset:26752
v_mfma_f32_16x16x32_bf16 v[152:155], a[180:183], a[104:107], v[152:155]
ds_read_b64_tr_b16 a[166:167], v13 offset:30336
v_mfma_f32_16x16x32_bf16 v[156:159], a[180:183], a[108:111], v[156:159]
v_mfma_f32_16x16x32_bf16 v[140:143], a[176:179], a[108:111], v[140:143]
s_add_u32 m0, s45, 0
s_waitcnt lgkmcnt(4)
v_mfma_f32_16x16x32_bf16 v[172:175], a[184:187], a[108:111], v[172:175]
ds_read_b64_tr_b16 a[168:169], v13 offset:26784
v_mfma_f32_16x16x32_bf16 v[188:191], a[188:191], a[108:111], v[188:191]
ds_read_b64_tr_b16 a[170:171], v13 offset:30368
v_mfma_f32_16x16x32_bf16 v[184:187], a[188:191], a[104:107], v[184:187]
buffer_load_dwordx4 v4, s[12:15], s39 offen lds
v_mfma_f32_16x16x32_bf16 v[168:171], a[184:187], a[104:107], v[168:171]
v_mfma_f32_16x16x32_bf16 v[164:167], a[184:187], a[100:103], v[164:167]
ds_read_b64_tr_b16 a[172:173], v13 offset:26816
v_mfma_f32_16x16x32_bf16 v[180:183], a[188:191], a[100:103], v[180:183]
ds_read_b64_tr_b16 a[174:175], v13 offset:30400
v_mfma_f32_16x16x32_bf16 v[176:179], a[188:191], a[96:99], v[176:179]
v_mfma_f32_16x16x32_bf16 v[160:163], a[184:187], a[96:99], v[160:163]
s_add_u32 m0, s45, 1024
s_waitcnt lgkmcnt(4)
v_mfma_f32_16x16x32_bf16 v[192:195], a[160:163], a[96:99], v[192:195]
ds_read_b64_tr_b16 a[176:177], v11 offset:2048
v_mfma_f32_16x16x32_bf16 v[208:211], a[164:167], a[96:99], v[208:211]
ds_read_b64_tr_b16 a[178:179], v11 offset:3072
v_mfma_f32_16x16x32_bf16 v[212:215], a[164:167], a[100:103], v[212:215]
buffer_load_dwordx4 v5, s[12:15], s39 offen lds
v_mfma_f32_16x16x32_bf16 v[196:199], a[160:163], a[100:103], v[196:199]
v_mfma_f32_16x16x32_bf16 v[200:203], a[160:163], a[104:107], v[200:203]
ds_read_b64_tr_b16 a[180:181], v12 offset:2048
v_mfma_f32_16x16x32_bf16 v[216:219], a[164:167], a[104:107], v[216:219]
ds_read_b64_tr_b16 a[182:183], v12 offset:3072
v_mfma_f32_16x16x32_bf16 v[220:223], a[164:167], a[108:111], v[220:223]
v_mfma_f32_16x16x32_bf16 v[204:207], a[160:163], a[108:111], v[204:207]
s_waitcnt lgkmcnt(4)
v_mfma_f32_16x16x32_bf16 v[236:239], a[168:171], a[108:111], v[236:239]
ds_read_b64_tr_b16 a[184:185], v11 offset:6144
v_mfma_f32_16x16x32_bf16 v[252:255], a[172:175], a[108:111], v[252:255]
ds_read_b64_tr_b16 a[186:187], v11 offset:7168
v_mfma_f32_16x16x32_bf16 v[248:251], a[172:175], a[104:107], v[248:251]
buffer_load_dword v30, v15, s[72:75], s76 offen
s_add_u32 s76, s76, s77
v_mfma_f32_16x16x32_bf16 v[232:235], a[168:171], a[104:107], v[232:235]
v_mfma_f32_16x16x32_bf16 v[228:231], a[168:171], a[100:103], v[228:231]
ds_read_b64_tr_b16 a[188:189], v12 offset:6144
v_mfma_f32_16x16x32_bf16 v[244:247], a[172:175], a[100:103], v[244:247]
ds_read_b64_tr_b16 a[190:191], v12 offset:7168
v_mfma_f32_16x16x32_bf16 v[240:243], a[172:175], a[96:99], v[240:243]
v_mfma_f32_16x16x32_bf16 v[224:227], a[168:171], a[96:99], v[224:227]
s_add_u32 s40, s40, 4096
s_add_u32 s41, s41, 4096
s_add_u32 s42, s42, 4096
s_add_u32 s43, s43, 4096
s_waitcnt vmcnt(25) lgkmcnt(4)
v_mfma_f32_16x16x32_bf16 a[0:3], a[176:179], a[112:115], a[0:3]
ds_read_b64_tr_b16 a[160:161], v11 offset:10240
v_mfma_f32_16x16x32_bf16 a[16:19], a[180:183], a[112:115], a[16:19]
ds_read_b64_tr_b16 a[162:163], v11 offset:11264
v_mfma_f32_16x16x32_bf16 a[20:23], a[180:183], a[116:119], a[20:23]
buffer_load_dwordx4 a[96:99], v2, s[16:19], s40 offen offset:0 sc1
v_mfma_f32_16x16x32_bf16 a[4:7], a[176:179], a[116:119], a[4:7]
v_mfma_f32_16x16x32_bf16 a[8:11], a[176:179], a[120:123], a[8:11]
ds_read_b64_tr_b16 a[164:165], v12 offset:10240
v_mfma_f32_16x16x32_bf16 a[24:27], a[180:183], a[120:123], a[24:27]
ds_read_b64_tr_b16 a[166:167], v12 offset:11264
v_mfma_f32_16x16x32_bf16 a[28:31], a[180:183], a[124:127], a[28:31]
v_mfma_f32_16x16x32_bf16 a[12:15], a[176:179], a[124:127], a[12:15]
s_waitcnt lgkmcnt(4)
v_mfma_f32_16x16x32_bf16 a[44:47], a[184:187], a[124:127], a[44:47]
ds_read_b64_tr_b16 a[168:169], v13 offset:19456
v_mfma_f32_16x16x32_bf16 a[60:63], a[188:191], a[124:127], a[60:63]
ds_read_b64_tr_b16 a[170:171], v13 offset:23040
v_mfma_f32_16x16x32_bf16 a[56:59], a[188:191], a[120:123], a[56:59]
buffer_load_dwordx4 a[100:103], v2, s[16:19], s41 offen offset:0 sc1
v_mfma_f32_16x16x32_bf16 a[40:43], a[184:187], a[120:123], a[40:43]
v_mfma_f32_16x16x32_bf16 a[36:39], a[184:187], a[116:119], a[36:39]
ds_read_b64_tr_b16 a[172:173], v13 offset:19488
v_mfma_f32_16x16x32_bf16 a[52:55], a[188:191], a[116:119], a[52:55]
ds_read_b64_tr_b16 a[174:175], v13 offset:23072
v_mfma_f32_16x16x32_bf16 a[48:51], a[188:191], a[112:115], a[48:51]
v_mfma_f32_16x16x32_bf16 a[32:35], a[184:187], a[112:115], a[32:35]
s_waitcnt lgkmcnt(4)
v_mfma_f32_16x16x32_bf16 a[64:67], a[112:115], a[160:163], a[64:67]
ds_read_b64_tr_b16 a[176:177], v13 offset:19520
v_mfma_f32_16x16x32_bf16 a[80:83], a[112:115], a[164:167], a[80:83]
ds_read_b64_tr_b16 a[178:179], v13 offset:23104
v_mfma_f32_16x16x32_bf16 a[84:87], a[116:119], a[164:167], a[84:87]
buffer_load_dwordx4 a[104:107], v2, s[16:19], s42 offen offset:0 sc1
v_mfma_f32_16x16x32_bf16 a[68:71], a[116:119], a[160:163], a[68:71]
v_mfma_f32_16x16x32_bf16 a[72:75], a[120:123], a[160:163], a[72:75]
ds_read_b64_tr_b16 a[180:181], v13 offset:19552
v_mfma_f32_16x16x32_bf16 a[88:91], a[120:123], a[164:167], a[88:91]
ds_read_b64_tr_b16 a[182:183], v13 offset:23136
v_mfma_f32_16x16x32_bf16 a[92:95], a[124:127], a[164:167], a[92:95]
v_mfma_f32_16x16x32_bf16 a[76:79], a[124:127], a[160:163], a[76:79]
s_waitcnt lgkmcnt(4)
v_mfma_f32_16x16x32_bf16 v[44:47], a[168:171], a[124:127], v[44:47]
ds_read_b64_tr_b16 a[184:185], v13 offset:19584
v_mfma_f32_16x16x32_bf16 v[60:63], a[172:175], a[124:127], v[60:63]
ds_read_b64_tr_b16 a[186:187], v13 offset:23168
v_mfma_f32_16x16x32_bf16 v[56:59], a[172:175], a[120:123], v[56:59]
buffer_load_dwordx4 a[108:111], v2, s[16:19], s43 offen offset:0 sc1
v_mfma_f32_16x16x32_bf16 v[40:43], a[168:171], a[120:123], v[40:43]
v_mfma_f32_16x16x32_bf16 v[36:39], a[168:171], a[116:119], v[36:39]
ds_read_b64_tr_b16 a[188:189], v13 offset:19616
v_mfma_f32_16x16x32_bf16 v[52:55], a[172:175], a[116:119], v[52:55]
ds_read_b64_tr_b16 a[190:191], v13 offset:23200
v_mfma_f32_16x16x32_bf16 v[48:51], a[172:175], a[112:115], v[48:51]
v_mfma_f32_16x16x32_bf16 v[32:35], a[168:171], a[112:115], v[32:35]
s_add_u32 m0, s45, 2048
s_waitcnt lgkmcnt(4)
v_mfma_f32_16x16x32_bf16 v[64:67], a[176:179], a[112:115], v[64:67]
ds_read_b64_tr_b16 a[160:161], v13 offset:19648
v_mfma_f32_16x16x32_bf16 v[80:83], a[180:183], a[112:115], v[80:83]
ds_read_b64_tr_b16 a[162:163], v13 offset:23232
v_mfma_f32_16x16x32_bf16 v[84:87], a[180:183], a[116:119], v[84:87]
buffer_load_dwordx4 v6, s[12:15], s39 offen lds
v_mfma_f32_16x16x32_bf16 v[68:71], a[176:179], a[116:119], v[68:71]
v_mfma_f32_16x16x32_bf16 v[72:75], a[176:179], a[120:123], v[72:75]
ds_read_b64_tr_b16 a[164:165], v13 offset:33792
v_mfma_f32_16x16x32_bf16 v[88:91], a[180:183], a[120:123], v[88:91]
ds_read_b64_tr_b16 a[166:167], v13 offset:37376
v_mfma_f32_16x16x32_bf16 v[92:95], a[180:183], a[124:127], v[92:95]
v_mfma_f32_16x16x32_bf16 v[76:79], a[176:179], a[124:127], v[76:79]
s_add_u32 m0, s45, 3072
s_waitcnt lgkmcnt(4)
v_mfma_f32_16x16x32_bf16 v[108:111], a[184:187], a[124:127], v[108:111]
ds_read_b64_tr_b16 a[168:169], v13 offset:33824
v_mfma_f32_16x16x32_bf16 v[124:127], a[188:191], a[124:127], v[124:127]
ds_read_b64_tr_b16 a[170:171], v13 offset:37408
v_mfma_f32_16x16x32_bf16 v[120:123], a[188:191], a[120:123], v[120:123]
buffer_load_dwordx4 v7, s[12:15], s39 offen lds
v_mfma_f32_16x16x32_bf16 v[104:107], a[184:187], a[120:123], v[104:107]
v_mfma_f32_16x16x32_bf16 v[100:103], a[184:187], a[116:119], v[100:103]
ds_read_b64_tr_b16 a[172:173], v13 offset:33856
v_mfma_f32_16x16x32_bf16 v[116:119], a[188:191], a[116:119], v[116:119]
ds_read_b64_tr_b16 a[174:175], v13 offset:37440
v_mfma_f32_16x16x32_bf16 v[112:115], a[188:191], a[112:115], v[112:115]
v_mfma_f32_16x16x32_bf16 v[96:99], a[184:187], a[112:115], v[96:99]
s_add_u32 m0, s45, 4096
s_waitcnt lgkmcnt(4)
v_mfma_f32_16x16x32_bf16 v[128:131], a[160:163], a[112:115], v[128:131]
ds_read_b64_tr_b16 a[176:177], v13 offset:33888
v_mfma_f32_16x16x32_bf16 v[144:147], a[164:167], a[112:115], v[144:147]
ds_read_b64_tr_b16 a[178:179], v13 offset:37472
v_mfma_f32_16x16x32_bf16 v[148:151], a[164:167], a[116:119], v[148:151]
buffer_load_dwordx4 v8, s[12:15], s39 offen lds
v_mfma_f32_16x16x32_bf16 v[132:135], a[160:163], a[116:119], v[132:135]
v_mfma_f32_16x16x32_bf16 v[136:139], a[160:163], a[120:123], v[136:139]
ds_read_b64_tr_b16 a[180:181], v13 offset:33920
v_mfma_f32_16x16x32_bf16 v[152:155], a[164:167], a[120:123], v[152:155]
ds_read_b64_tr_b16 a[182:183], v13 offset:37504
v_mfma_f32_16x16x32_bf16 v[156:159], a[164:167], a[124:127], v[156:159]
v_mfma_f32_16x16x32_bf16 v[140:143], a[160:163], a[124:127], v[140:143]
s_add_u32 m0, s45, 5120
s_waitcnt lgkmcnt(4)
v_mfma_f32_16x16x32_bf16 v[172:175], a[168:171], a[124:127], v[172:175]
ds_read_b64_tr_b16 a[184:185], v13 offset:33952
v_mfma_f32_16x16x32_bf16 v[188:191], a[172:175], a[124:127], v[188:191]
ds_read_b64_tr_b16 a[186:187], v13 offset:37536
v_mfma_f32_16x16x32_bf16 v[184:187], a[172:175], a[120:123], v[184:187]
buffer_load_dwordx4 v9, s[12:15], s39 offen lds
v_mfma_f32_16x16x32_bf16 v[168:171], a[168:171], a[120:123], v[168:171]
v_mfma_f32_16x16x32_bf16 v[164:167], a[168:171], a[116:119], v[164:167]
ds_read_b64_tr_b16 a[188:189], v13 offset:33984
v_mfma_f32_16x16x32_bf16 v[180:183], a[172:175], a[116:119], v[180:183]
ds_read_b64_tr_b16 a[190:191], v13 offset:37568
v_mfma_f32_16x16x32_bf16 v[176:179], a[172:175], a[112:115], v[176:179]
v_mfma_f32_16x16x32_bf16 v[160:163], a[168:171], a[112:115], v[160:163]
v_add_u32 v11, 40960, v11
v_add_u32 v12, 40960, v12
v_add_u32 v13, 40960, v13
s_add_u32 m0, s45, 6144
s_waitcnt lgkmcnt(4)
v_mfma_f32_16x16x32_bf16 v[192:195], a[176:179], a[112:115], v[192:195]
s_waitcnt vmcnt(18)
s_barrier
ds_read_b64_tr_b16 a[160:161], v11 offset:0
v_mfma_f32_16x16x32_bf16 v[208:211], a[180:183], a[112:115], v[208:211]
ds_read_b64_tr_b16 a[162:163], v11 offset:1024
v_mfma_f32_16x16x32_bf16 v[212:215], a[180:183], a[116:119], v[212:215]
buffer_load_dwordx4 v10, s[12:15], s39 offen lds
v_mfma_f32_16x16x32_bf16 v[196:199], a[176:179], a[116:119], v[196:199]
v_mfma_f32_16x16x32_bf16 v[200:203], a[176:179], a[120:123], v[200:203]
ds_read_b64_tr_b16 a[164:165], v12 offset:0
v_mfma_f32_16x16x32_bf16 v[216:219], a[180:183], a[120:123], v[216:219]
ds_read_b64_tr_b16 a[166:167], v12 offset:1024
v_mfma_f32_16x16x32_bf16 v[220:223], a[180:183], a[124:127], v[220:223]
v_mfma_f32_16x16x32_bf16 v[204:207], a[176:179], a[124:127], v[204:207]
s_waitcnt lgkmcnt(4)
v_mfma_f32_16x16x32_bf16 v[236:239], a[184:187], a[124:127], v[236:239]
ds_read_b64_tr_b16 a[168:169], v11 offset:4096
v_mfma_f32_16x16x32_bf16 v[252:255], a[188:191], a[124:127], v[252:255]
ds_read_b64_tr_b16 a[170:171], v11 offset:5120
v_mfma_f32_16x16x32_bf16 v[248:251], a[188:191], a[120:123], v[248:251]
s_add_u32 s36, s36, 393216
s_add_u32 s37, s37, 393216
s_add_u32 s38, s38, 393216
s_add_u32 s39, s39, 458752
v_mfma_f32_16x16x32_bf16 v[232:235], a[184:187], a[120:123], v[232:235]
v_mfma_f32_16x16x32_bf16 v[228:231], a[184:187], a[116:119], v[228:231]
ds_read_b64_tr_b16 a[172:173], v12 offset:4096
v_mfma_f32_16x16x32_bf16 v[244:247], a[188:191], a[116:119], v[244:247]
ds_read_b64_tr_b16 a[174:175], v12 offset:5120
v_mfma_f32_16x16x32_bf16 v[240:243], a[188:191], a[112:115], v[240:243]
v_mfma_f32_16x16x32_bf16 v[224:227], a[184:187], a[112:115], v[224:227]
s_waitcnt vmcnt(24) lgkmcnt(4)
v_mfma_f32_16x16x32_bf16 a[0:3], a[160:163], a[128:131], a[0:3]
ds_read_b64_tr_b16 a[176:177], v11 offset:8192
v_mfma_f32_16x16x32_bf16 a[16:19], a[164:167], a[128:131], a[16:19]
ds_read_b64_tr_b16 a[178:179], v11 offset:9216
v_mfma_f32_16x16x32_bf16 a[20:23], a[164:167], a[132:135], a[20:23]
buffer_load_dwordx4 a[112:115], v2, s[16:19], s40 offen offset:1024 sc1
v_mfma_f32_16x16x32_bf16 a[4:7], a[160:163], a[132:135], a[4:7]
v_mfma_f32_16x16x32_bf16 a[8:11], a[160:163], a[136:139], a[8:11]
ds_read_b64_tr_b16 a[180:181], v12 offset:8192
v_mfma_f32_16x16x32_bf16 a[24:27], a[164:167], a[136:139], a[24:27]
ds_read_b64_tr_b16 a[182:183], v12 offset:9216
v_mfma_f32_16x16x32_bf16 a[28:31], a[164:167], a[140:143], a[28:31]
v_mfma_f32_16x16x32_bf16 a[12:15], a[160:163], a[140:143], a[12:15]
s_waitcnt lgkmcnt(4)
v_mfma_f32_16x16x32_bf16 a[44:47], a[168:171], a[140:143], a[44:47]
ds_read_b64_tr_b16 a[184:185], v13 offset:12288
v_mfma_f32_16x16x32_bf16 a[60:63], a[172:175], a[140:143], a[60:63]
ds_read_b64_tr_b16 a[186:187], v13 offset:15872
v_mfma_f32_16x16x32_bf16 a[56:59], a[172:175], a[136:139], a[56:59]
buffer_load_dwordx4 a[116:119], v2, s[16:19], s41 offen offset:1024 sc1
v_mfma_f32_16x16x32_bf16 a[40:43], a[168:171], a[136:139], a[40:43]
v_mfma_f32_16x16x32_bf16 a[36:39], a[168:171], a[132:135], a[36:39]
ds_read_b64_tr_b16 a[188:189], v13 offset:12320
v_mfma_f32_16x16x32_bf16 a[52:55], a[172:175], a[132:135], a[52:55]
ds_read_b64_tr_b16 a[190:191], v13 offset:15904
v_mfma_f32_16x16x32_bf16 a[48:51], a[172:175], a[128:131], a[48:51]
v_mfma_f32_16x16x32_bf16 a[32:35], a[168:171], a[128:131], a[32:35]
s_waitcnt lgkmcnt(4)
v_mfma_f32_16x16x32_bf16 a[64:67], a[128:131], a[176:179], a[64:67]
ds_read_b64_tr_b16 a[160:161], v13 offset:12352
v_mfma_f32_16x16x32_bf16 a[80:83], a[128:131], a[180:183], a[80:83]
ds_read_b64_tr_b16 a[162:163], v13 offset:15936
v_mfma_f32_16x16x32_bf16 a[84:87], a[132:135], a[180:183], a[84:87]
buffer_load_dwordx4 a[120:123], v2, s[16:19], s42 offen offset:1024 sc1
v_mfma_f32_16x16x32_bf16 a[68:71], a[132:135], a[176:179], a[68:71]
v_mfma_f32_16x16x32_bf16 a[72:75], a[136:139], a[176:179], a[72:75]
ds_read_b64_tr_b16 a[164:165], v13 offset:12384
v_mfma_f32_16x16x32_bf16 a[88:91], a[136:139], a[180:183], a[88:91]
ds_read_b64_tr_b16 a[166:167], v13 offset:15968
v_mfma_f32_16x16x32_bf16 a[92:95], a[140:143], a[180:183], a[92:95]
v_mfma_f32_16x16x32_bf16 a[76:79], a[140:143], a[176:179], a[76:79]
s_waitcnt lgkmcnt(4)
v_mfma_f32_16x16x32_bf16 v[44:47], a[184:187], a[140:143], v[44:47]
ds_read_b64_tr_b16 a[168:169], v13 offset:12416
v_mfma_f32_16x16x32_bf16 v[60:63], a[188:191], a[140:143], v[60:63]
ds_read_b64_tr_b16 a[170:171], v13 offset:16000
v_mfma_f32_16x16x32_bf16 v[56:59], a[188:191], a[136:139], v[56:59]
buffer_load_dwordx4 a[124:127], v2, s[16:19], s43 offen offset:1024 sc1
v_mfma_f32_16x16x32_bf16 v[40:43], a[184:187], a[136:139], v[40:43]
v_mfma_f32_16x16x32_bf16 v[36:39], a[184:187], a[132:135], v[36:39]
ds_read_b64_tr_b16 a[172:173], v13 offset:12448
v_mfma_f32_16x16x32_bf16 v[52:55], a[188:191], a[132:135], v[52:55]
ds_read_b64_tr_b16 a[174:175], v13 offset:16032
v_mfma_f32_16x16x32_bf16 v[48:51], a[188:191], a[128:131], v[48:51]
v_mfma_f32_16x16x32_bf16 v[32:35], a[184:187], a[128:131], v[32:35]
s_add_u32 m0, s44, 40960
s_waitcnt lgkmcnt(4)
v_mfma_f32_16x16x32_bf16 v[64:67], a[160:163], a[128:131], v[64:67]
ds_read_b64_tr_b16 a[176:177], v13 offset:12480
v_mfma_f32_16x16x32_bf16 v[80:83], a[164:167], a[128:131], v[80:83]
ds_read_b64_tr_b16 a[178:179], v13 offset:16064
v_mfma_f32_16x16x32_bf16 v[84:87], a[164:167], a[132:135], v[84:87]
buffer_load_dwordx4 v3, s[8:11], s36 offen lds
v_mfma_f32_16x16x32_bf16 v[68:71], a[160:163], a[132:135], v[68:71]
v_mfma_f32_16x16x32_bf16 v[72:75], a[160:163], a[136:139], v[72:75]
ds_read_b64_tr_b16 a[180:181], v13 offset:26624
v_mfma_f32_16x16x32_bf16 v[88:91], a[164:167], a[136:139], v[88:91]
ds_read_b64_tr_b16 a[182:183], v13 offset:30208
v_mfma_f32_16x16x32_bf16 v[92:95], a[164:167], a[140:143], v[92:95]
v_mfma_f32_16x16x32_bf16 v[76:79], a[160:163], a[140:143], v[76:79]
s_add_u32 m0, s44, 45056
s_waitcnt lgkmcnt(4)
v_mfma_f32_16x16x32_bf16 v[108:111], a[168:171], a[140:143], v[108:111]
ds_read_b64_tr_b16 a[184:185], v13 offset:26656
v_mfma_f32_16x16x32_bf16 v[124:127], a[172:175], a[140:143], v[124:127]
ds_read_b64_tr_b16 a[186:187], v13 offset:30240
v_mfma_f32_16x16x32_bf16 v[120:123], a[172:175], a[136:139], v[120:123]
buffer_load_dwordx4 v3, s[8:11], s37 offen lds
v_mfma_f32_16x16x32_bf16 v[104:107], a[168:171], a[136:139], v[104:107]
v_mfma_f32_16x16x32_bf16 v[100:103], a[168:171], a[132:135], v[100:103]
ds_read_b64_tr_b16 a[188:189], v13 offset:26688
v_mfma_f32_16x16x32_bf16 v[116:119], a[172:175], a[132:135], v[116:119]
ds_read_b64_tr_b16 a[190:191], v13 offset:30272
v_mfma_f32_16x16x32_bf16 v[112:115], a[172:175], a[128:131], v[112:115]
v_mfma_f32_16x16x32_bf16 v[96:99], a[168:171], a[128:131], v[96:99]
s_add_u32 m0, s44, 49152
s_waitcnt lgkmcnt(4)
v_mfma_f32_16x16x32_bf16 v[128:131], a[176:179], a[128:131], v[128:131]
ds_read_b64_tr_b16 a[160:161], v13 offset:26720
v_mfma_f32_16x16x32_bf16 v[144:147], a[180:183], a[128:131], v[144:147]
ds_read_b64_tr_b16 a[162:163], v13 offset:30304
v_mfma_f32_16x16x32_bf16 v[148:151], a[180:183], a[132:135], v[148:151]
buffer_load_dwordx4 v3, s[8:11], s38 offen lds
v_mfma_f32_16x16x32_bf16 v[132:135], a[176:179], a[132:135], v[132:135]
v_mfma_f32_16x16x32_bf16 v[136:139], a[176:179], a[136:139], v[136:139]
ds_read_b64_tr_b16 a[164:165], v13 offset:26752
v_mfma_f32_16x16x32_bf16 v[152:155], a[180:183], a[136:139], v[152:155]
ds_read_b64_tr_b16 a[166:167], v13 offset:30336
v_mfma_f32_16x16x32_bf16 v[156:159], a[180:183], a[140:143], v[156:159]
v_mfma_f32_16x16x32_bf16 v[140:143], a[176:179], a[140:143], v[140:143]
s_add_u32 m0, s45, 40960
s_waitcnt lgkmcnt(4)
v_mfma_f32_16x16x32_bf16 v[172:175], a[184:187], a[140:143], v[172:175]
ds_read_b64_tr_b16 a[168:169], v13 offset:26784
v_mfma_f32_16x16x32_bf16 v[188:191], a[188:191], a[140:143], v[188:191]
ds_read_b64_tr_b16 a[170:171], v13 offset:30368
v_mfma_f32_16x16x32_bf16 v[184:187], a[188:191], a[136:139], v[184:187]
buffer_load_dwordx4 v4, s[12:15], s39 offen lds
v_mfma_f32_16x16x32_bf16 v[168:171], a[184:187], a[136:139], v[168:171]
v_mfma_f32_16x16x32_bf16 v[164:167], a[184:187], a[132:135], v[164:167]
ds_read_b64_tr_b16 a[172:173], v13 offset:26816
v_mfma_f32_16x16x32_bf16 v[180:183], a[188:191], a[132:135], v[180:183]
ds_read_b64_tr_b16 a[174:175], v13 offset:30400
v_mfma_f32_16x16x32_bf16 v[176:179], a[188:191], a[128:131], v[176:179]
v_mfma_f32_16x16x32_bf16 v[160:163], a[184:187], a[128:131], v[160:163]
s_add_u32 m0, s45, 41984
s_waitcnt lgkmcnt(4)
v_mfma_f32_16x16x32_bf16 v[192:195], a[160:163], a[128:131], v[192:195]
ds_read_b64_tr_b16 a[176:177], v11 offset:2048
v_mfma_f32_16x16x32_bf16 v[208:211], a[164:167], a[128:131], v[208:211]
ds_read_b64_tr_b16 a[178:179], v11 offset:3072
v_mfma_f32_16x16x32_bf16 v[212:215], a[164:167], a[132:135], v[212:215]
buffer_load_dwordx4 v5, s[12:15], s39 offen lds
v_mfma_f32_16x16x32_bf16 v[196:199], a[160:163], a[132:135], v[196:199]
v_mfma_f32_16x16x32_bf16 v[200:203], a[160:163], a[136:139], v[200:203]
ds_read_b64_tr_b16 a[180:181], v12 offset:2048
v_mfma_f32_16x16x32_bf16 v[216:219], a[164:167], a[136:139], v[216:219]
ds_read_b64_tr_b16 a[182:183], v12 offset:3072
v_mfma_f32_16x16x32_bf16 v[220:223], a[164:167], a[140:143], v[220:223]
v_mfma_f32_16x16x32_bf16 v[204:207], a[160:163], a[140:143], v[204:207]
s_waitcnt lgkmcnt(4)
v_mfma_f32_16x16x32_bf16 v[236:239], a[168:171], a[140:143], v[236:239]
ds_read_b64_tr_b16 a[184:185], v11 offset:6144
v_mfma_f32_16x16x32_bf16 v[252:255], a[172:175], a[140:143], v[252:255]
ds_read_b64_tr_b16 a[186:187], v11 offset:7168
v_mfma_f32_16x16x32_bf16 v[248:251], a[172:175], a[136:139], v[248:251]
buffer_load_dword v30, v15, s[72:75], s76 offen
s_add_u32 s76, s76, s77
v_mfma_f32_16x16x32_bf16 v[232:235], a[168:171], a[136:139], v[232:235]
v_mfma_f32_16x16x32_bf16 v[228:231], a[168:171], a[132:135], v[228:231]
ds_read_b64_tr_b16 a[188:189], v12 offset:6144
v_mfma_f32_16x16x32_bf16 v[244:247], a[172:175], a[132:135], v[244:247]
ds_read_b64_tr_b16 a[190:191], v12 offset:7168
v_mfma_f32_16x16x32_bf16 v[240:243], a[172:175], a[128:131], v[240:243]
v_mfma_f32_16x16x32_bf16 v[224:227], a[168:171], a[128:131], v[224:227]
s_waitcnt vmcnt(25) lgkmcnt(4)
v_mfma_f32_16x16x32_bf16 a[0:3], a[176:179], a[144:147], a[0:3]
ds_read_b64_tr_b16 a[160:161], v11 offset:10240
v_mfma_f32_16x16x32_bf16 a[16:19], a[180:183], a[144:147], a[16:19]
ds_read_b64_tr_b16 a[162:163], v11 offset:11264
v_mfma_f32_16x16x32_bf16 a[20:23], a[180:183], a[148:151], a[20:23]
buffer_load_dwordx4 a[128:131], v2, s[16:19], s40 offen offset:2048 sc1
v_mfma_f32_16x16x32_bf16 a[4:7], a[176:179], a[148:151], a[4:7]
v_mfma_f32_16x16x32_bf16 a[8:11], a[176:179], a[152:155], a[8:11]
ds_read_b64_tr_b16 a[164:165], v12 offset:10240
v_mfma_f32_16x16x32_bf16 a[24:27], a[180:183], a[152:155], a[24:27]
ds_read_b64_tr_b16 a[166:167], v12 offset:11264
v_mfma_f32_16x16x32_bf16 a[28:31], a[180:183], a[156:159], a[28:31]
v_mfma_f32_16x16x32_bf16 a[12:15], a[176:179], a[156:159], a[12:15]
s_waitcnt lgkmcnt(4)
v_mfma_f32_16x16x32_bf16 a[44:47], a[184:187], a[156:159], a[44:47]
ds_read_b64_tr_b16 a[168:169], v13 offset:19456
v_mfma_f32_16x16x32_bf16 a[60:63], a[188:191], a[156:159], a[60:63]
ds_read_b64_tr_b16 a[170:171], v13 offset:23040
v_mfma_f32_16x16x32_bf16 a[56:59], a[188:191], a[152:155], a[56:59]
buffer_load_dwordx4 a[132:135], v2, s[16:19], s41 offen offset:2048 sc1
v_mfma_f32_16x16x32_bf16 a[40:43], a[184:187], a[152:155], a[40:43]
v_mfma_f32_16x16x32_bf16 a[36:39], a[184:187], a[148:151], a[36:39]
ds_read_b64_tr_b16 a[172:173], v13 offset:19488
v_mfma_f32_16x16x32_bf16 a[52:55], a[188:191], a[148:151], a[52:55]
ds_read_b64_tr_b16 a[174:175], v13 offset:23072
v_mfma_f32_16x16x32_bf16 a[48:51], a[188:191], a[144:147], a[48:51]
v_mfma_f32_16x16x32_bf16 a[32:35], a[184:187], a[144:147], a[32:35]
s_waitcnt lgkmcnt(4)
v_mfma_f32_16x16x32_bf16 a[64:67], a[144:147], a[160:163], a[64:67]
ds_read_b64_tr_b16 a[176:177], v13 offset:19520
v_mfma_f32_16x16x32_bf16 a[80:83], a[144:147], a[164:167], a[80:83]
ds_read_b64_tr_b16 a[178:179], v13 offset:23104
v_mfma_f32_16x16x32_bf16 a[84:87], a[148:151], a[164:167], a[84:87]
buffer_load_dwordx4 a[136:139], v2, s[16:19], s42 offen offset:2048 sc1
v_mfma_f32_16x16x32_bf16 a[68:71], a[148:151], a[160:163], a[68:71]
v_mfma_f32_16x16x32_bf16 a[72:75], a[152:155], a[160:163], a[72:75]
ds_read_b64_tr_b16 a[180:181], v13 offset:19552
v_mfma_f32_16x16x32_bf16 a[88:91], a[152:155], a[164:167], a[88:91]
ds_read_b64_tr_b16 a[182:183], v13 offset:23136
v_mfma_f32_16x16x32_bf16 a[92:95], a[156:159], a[164:167], a[92:95]
v_mfma_f32_16x16x32_bf16 a[76:79], a[156:159], a[160:163], a[76:79]
s_waitcnt lgkmcnt(4)
v_mfma_f32_16x16x32_bf16 v[44:47], a[168:171], a[156:159], v[44:47]
ds_read_b64_tr_b16 a[184:185], v13 offset:19584
v_mfma_f32_16x16x32_bf16 v[60:63], a[172:175], a[156:159], v[60:63]
ds_read_b64_tr_b16 a[186:187], v13 offset:23168
v_mfma_f32_16x16x32_bf16 v[56:59], a[172:175], a[152:155], v[56:59]
buffer_load_dwordx4 a[140:143], v2, s[16:19], s43 offen offset:2048 sc1
v_mfma_f32_16x16x32_bf16 v[40:43], a[168:171], a[152:155], v[40:43]
v_mfma_f32_16x16x32_bf16 v[36:39], a[168:171], a[148:151], v[36:39]
ds_read_b64_tr_b16 a[188:189], v13 offset:19616
v_mfma_f32_16x16x32_bf16 v[52:55], a[172:175], a[148:151], v[52:55]
ds_read_b64_tr_b16 a[190:191], v13 offset:23200
v_mfma_f32_16x16x32_bf16 v[48:51], a[172:175], a[144:147], v[48:51]
v_mfma_f32_16x16x32_bf16 v[32:35], a[168:171], a[144:147], v[32:35]
s_add_u32 m0, s45, 43008
s_waitcnt lgkmcnt(4)
v_mfma_f32_16x16x32_bf16 v[64:67], a[176:179], a[144:147], v[64:67]
ds_read_b64_tr_b16 a[160:161], v13 offset:19648
v_mfma_f32_16x16x32_bf16 v[80:83], a[180:183], a[144:147], v[80:83]
ds_read_b64_tr_b16 a[162:163], v13 offset:23232
v_mfma_f32_16x16x32_bf16 v[84:87], a[180:183], a[148:151], v[84:87]
buffer_load_dwordx4 v6, s[12:15], s39 offen lds
v_mfma_f32_16x16x32_bf16 v[68:71], a[176:179], a[148:151], v[68:71]
v_mfma_f32_16x16x32_bf16 v[72:75], a[176:179], a[152:155], v[72:75]
ds_read_b64_tr_b16 a[164:165], v13 offset:33792
v_mfma_f32_16x16x32_bf16 v[88:91], a[180:183], a[152:155], v[88:91]
ds_read_b64_tr_b16 a[166:167], v13 offset:37376
v_mfma_f32_16x16x32_bf16 v[92:95], a[180:183], a[156:159], v[92:95]
v_mfma_f32_16x16x32_bf16 v[76:79], a[176:179], a[156:159], v[76:79]
s_add_u32 m0, s45, 44032
s_waitcnt lgkmcnt(4)
v_mfma_f32_16x16x32_bf16 v[108:111], a[184:187], a[156:159], v[108:111]
ds_read_b64_tr_b16 a[168:169], v13 offset:33824
v_mfma_f32_16x16x32_bf16 v[124:127], a[188:191], a[156:159], v[124:127]
ds_read_b64_tr_b16 a[170:171], v13 offset:37408
v_mfma_f32_16x16x32_bf16 v[120:123], a[188:191], a[152:155], v[120:123]
buffer_load_dwordx4 v7, s[12:15], s39 offen lds
v_mfma_f32_16x16x32_bf16 v[104:107], a[184:187], a[152:155], v[104:107]
v_mfma_f32_16x16x32_bf16 v[100:103], a[184:187], a[148:151], v[100:103]
ds_read_b64_tr_b16 a[172:173], v13 offset:33856
v_mfma_f32_16x16x32_bf16 v[116:119], a[188:191], a[148:151], v[116:119]
ds_read_b64_tr_b16 a[174:175], v13 offset:37440
v_mfma_f32_16x16x32_bf16 v[112:115], a[188:191], a[144:147], v[112:115]
v_mfma_f32_16x16x32_bf16 v[96:99], a[184:187], a[144:147], v[96:99]
s_add_u32 m0, s45, 45056
s_waitcnt lgkmcnt(4)
v_mfma_f32_16x16x32_bf16 v[128:131], a[160:163], a[144:147], v[128:131]
ds_read_b64_tr_b16 a[176:177], v13 offset:33888
v_mfma_f32_16x16x32_bf16 v[144:147], a[164:167], a[144:147], v[144:147]
ds_read_b64_tr_b16 a[178:179], v13 offset:37472
v_mfma_f32_16x16x32_bf16 v[148:151], a[164:167], a[148:151], v[148:151]
buffer_load_dwordx4 v8, s[12:15], s39 offen lds
v_mfma_f32_16x16x32_bf16 v[132:135], a[160:163], a[148:151], v[132:135]
v_mfma_f32_16x16x32_bf16 v[136:139], a[160:163], a[152:155], v[136:139]
ds_read_b64_tr_b16 a[180:181], v13 offset:33920
v_mfma_f32_16x16x32_bf16 v[152:155], a[164:167], a[152:155], v[152:155]
ds_read_b64_tr_b16 a[182:183], v13 offset:37504
v_mfma_f32_16x16x32_bf16 v[156:159], a[164:167], a[156:159], v[156:159]
v_mfma_f32_16x16x32_bf16 v[140:143], a[160:163], a[156:159], v[140:143]
s_add_u32 m0, s45, 46080
s_waitcnt lgkmcnt(4)
v_mfma_f32_16x16x32_bf16 v[172:175], a[168:171], a[156:159], v[172:175]
ds_read_b64_tr_b16 a[184:185], v13 offset:33952
v_mfma_f32_16x16x32_bf16 v[188:191], a[172:175], a[156:159], v[188:191]
ds_read_b64_tr_b16 a[186:187], v13 offset:37536
v_mfma_f32_16x16x32_bf16 v[184:187], a[172:175], a[152:155], v[184:187]
buffer_load_dwordx4 v9, s[12:15], s39 offen lds
v_mfma_f32_16x16x32_bf16 v[168:171], a[168:171], a[152:155], v[168:171]
v_mfma_f32_16x16x32_bf16 v[164:167], a[168:171], a[148:151], v[164:167]
ds_read_b64_tr_b16 a[188:189], v13 offset:33984
v_mfma_f32_16x16x32_bf16 v[180:183], a[172:175], a[148:151], v[180:183]
ds_read_b64_tr_b16 a[190:191], v13 offset:37568
v_mfma_f32_16x16x32_bf16 v[176:179], a[172:175], a[144:147], v[176:179]
v_mfma_f32_16x16x32_bf16 v[160:163], a[168:171], a[144:147], v[160:163]
v_subrev_u32 v11, 122880, v11
v_subrev_u32 v12, 122880, v12
v_subrev_u32 v13, 122880, v13
s_add_u32 m0, s45, 47104
s_waitcnt lgkmcnt(4)
v_mfma_f32_16x16x32_bf16 v[192:195], a[176:179], a[144:147], v[192:195]
s_waitcnt vmcnt(18)
s_barrier
ds_read_b64_tr_b16 a[160:161], v11 offset:0
v_mfma_f32_16x16x32_bf16 v[208:211], a[180:183], a[144:147], v[208:211]
ds_read_b64_tr_b16 a[162:163], v11 offset:1024
v_mfma_f32_16x16x32_bf16 v[212:215], a[180:183], a[148:151], v[212:215]
buffer_load_dwordx4 v10, s[12:15], s39 offen lds
v_mfma_f32_16x16x32_bf16 v[196:199], a[176:179], a[148:151], v[196:199]
v_mfma_f32_16x16x32_bf16 v[200:203], a[176:179], a[152:155], v[200:203]
ds_read_b64_tr_b16 a[164:165], v12 offset:0
v_mfma_f32_16x16x32_bf16 v[216:219], a[180:183], a[152:155], v[216:219]
ds_read_b64_tr_b16 a[166:167], v12 offset:1024
v_mfma_f32_16x16x32_bf16 v[220:223], a[180:183], a[156:159], v[220:223]
v_mfma_f32_16x16x32_bf16 v[204:207], a[176:179], a[156:159], v[204:207]
s_waitcnt lgkmcnt(4)
v_mfma_f32_16x16x32_bf16 v[236:239], a[184:187], a[156:159], v[236:239]
ds_read_b64_tr_b16 a[168:169], v11 offset:4096
v_mfma_f32_16x16x32_bf16 v[252:255], a[188:191], a[156:159], v[252:255]
ds_read_b64_tr_b16 a[170:171], v11 offset:5120
v_mfma_f32_16x16x32_bf16 v[248:251], a[188:191], a[152:155], v[248:251]
s_add_u32 s36, s36, 393216
s_add_u32 s37, s37, 393216
s_add_u32 s38, s38, 393216
s_add_u32 s39, s39, 458752
v_mfma_f32_16x16x32_bf16 v[232:235], a[184:187], a[152:155], v[232:235]
v_mfma_f32_16x16x32_bf16 v[228:231], a[184:187], a[148:151], v[228:231]
ds_read_b64_tr_b16 a[172:173], v12 offset:4096
v_mfma_f32_16x16x32_bf16 v[244:247], a[188:191], a[148:151], v[244:247]
ds_read_b64_tr_b16 a[174:175], v12 offset:5120
v_mfma_f32_16x16x32_bf16 v[240:243], a[188:191], a[144:147], v[240:243]
s_sub_u32 s46, s46, 1
s_cmp_lg_u32 s46, 0
v_mfma_f32_16x16x32_bf16 v[224:227], a[184:187], a[144:147], v[224:227]
s_cbranch_scc1 L_g1
s_waitcnt vmcnt(24) lgkmcnt(4)
v_mfma_f32_16x16x32_bf16 a[0:3], a[160:163], a[96:99], a[0:3]
ds_read_b64_tr_b16 a[176:177], v11 offset:8192
v_mfma_f32_16x16x32_bf16 a[16:19], a[164:167], a[96:99], a[16:19]
ds_read_b64_tr_b16 a[178:179], v11 offset:9216
v_mfma_f32_16x16x32_bf16 a[20:23], a[164:167], a[100:103], a[20:23]
buffer_load_dwordx4 a[144:147], v2, s[16:19], s40 offen offset:3072 sc1
v_mfma_f32_16x16x32_bf16 a[4:7], a[160:163], a[100:103], a[4:7]
v_mfma_f32_16x16x32_bf16 a[8:11], a[160:163], a[104:107], a[8:11]
ds_read_b64_tr_b16 a[180:181], v12 offset:8192
v_mfma_f32_16x16x32_bf16 a[24:27], a[164:167], a[104:107], a[24:27]
ds_read_b64_tr_b16 a[182:183], v12 offset:9216
v_mfma_f32_16x16x32_bf16 a[28:31], a[164:167], a[108:111], a[28:31]
s_lshl_b32 s6, s2, 2
s_add_u32 s6, s6, s3
s_lshl_b32 s6, s6, 11
v_mfma_f32_16x16x32_bf16 a[12:15], a[160:163], a[108:111], a[12:15]
s_waitcnt lgkmcnt(4)
v_mfma_f32_16x16x32_bf16 a[44:47], a[168:171], a[108:111], a[44:47]
ds_read_b64_tr_b16 a[184:185], v13 offset:12288
v_mfma_f32_16x16x32_bf16 a[60:63], a[172:175], a[108:111], a[60:63]
ds_read_b64_tr_b16 a[186:187], v13 offset:15872
v_mfma_f32_16x16x32_bf16 a[56:59], a[172:175], a[104:107], a[56:59]
buffer_load_dwordx4 a[148:151], v2, s[16:19], s41 offen offset:3072 sc1
v_mfma_f32_16x16x32_bf16 a[40:43], a[168:171], a[104:107], a[40:43]
v_mfma_f32_16x16x32_bf16 a[36:39], a[168:171], a[100:103], a[36:39]
ds_read_b64_tr_b16 a[188:189], v13 offset:12320
v_mfma_f32_16x16x32_bf16 a[52:55], a[172:175], a[100:103], a[52:55]
ds_read_b64_tr_b16 a[190:191], v13 offset:15904
v_mfma_f32_16x16x32_bf16 a[48:51], a[172:175], a[96:99], a[48:51]
s_add_u32 s20, s52, s6
s_addc_u32 s21, s53, 0
s_and_b32 s21, s21, 0xffff
v_mfma_f32_16x16x32_bf16 a[32:35], a[168:171], a[96:99], a[32:35]
s_waitcnt lgkmcnt(4)
v_mfma_f32_16x16x32_bf16 a[64:67], a[96:99], a[176:179], a[64:67]
ds_read_b64_tr_b16 a[160:161], v13 offset:12352
v_mfma_f32_16x16x32_bf16 a[80:83], a[96:99], a[180:183], a[80:83]
ds_read_b64_tr_b16 a[162:163], v13 offset:15936
v_mfma_f32_16x16x32_bf16 a[84:87], a[100:103], a[180:183], a[84:87]
buffer_load_dwordx4 a[152:155], v2, s[16:19], s42 offen offset:3072 sc1
v_mfma_f32_16x16x32_bf16 a[68:71], a[100:103], a[176:179], a[68:71]
v_mfma_f32_16x16x32_bf16 a[72:75], a[104:107], a[176:179], a[72:75]
ds_read_b64_tr_b16 a[164:165], v13 offset:12384
v_mfma_f32_16x16x32_bf16 a[88:91], a[104:107], a[180:183], a[88:91]
ds_read_b64_tr_b16 a[166:167], v13 offset:15968
v_mfma_f32_16x16x32_bf16 a[92:95], a[108:111], a[180:183], a[92:95]
s_mov_b32 s22, 2048
s_mov_b32 s23, 0x20000
v_lshlrev_b32 v18, 7, v1
v_mfma_f32_16x16x32_bf16 a[76:79], a[108:111], a[176:179], a[76:79]
s_waitcnt lgkmcnt(4)
v_mfma_f32_16x16x32_bf16 v[44:47], a[184:187], a[108:111], v[44:47]
ds_read_b64_tr_b16 a[168:169], v13 offset:12416
v_mfma_f32_16x16x32_bf16 v[60:63], a[188:191], a[108:111], v[60:63]
ds_read_b64_tr_b16 a[170:171], v13 offset:16000
v_mfma_f32_16x16x32_bf16 v[56:59], a[188:191], a[104:107], v[56:59]
buffer_load_dwordx4 a[156:159], v2, s[16:19], s43 offen offset:3072 sc1
v_mfma_f32_16x16x32_bf16 v[40:43], a[184:187], a[104:107], v[40:43]
v_mfma_f32_16x16x32_bf16 v[36:39], a[184:187], a[100:103], v[36:39]
ds_read_b64_tr_b16 a[172:173], v13 offset:12448
v_mfma_f32_16x16x32_bf16 v[52:55], a[188:191], a[100:103], v[52:55]
ds_read_b64_tr_b16 a[174:175], v13 offset:16032
v_mfma_f32_16x16x32_bf16 v[48:51], a[188:191], a[96:99], v[48:51]
s_getpc_b64 s[24:25]
L_pc2:
s_sub_u32 s24, s24, L_pc2-L_pc
s_subb_u32 s25, s25, 0
v_mfma_f32_16x16x32_bf16 v[32:35], a[184:187], a[96:99], v[32:35]
s_add_u32 m0, s44, 81920
s_waitcnt lgkmcnt(4)
v_mfma_f32_16x16x32_bf16 v[64:67], a[160:163], a[96:99], v[64:67]
ds_read_b64_tr_b16 a[176:177], v13 offset:12480
v_mfma_f32_16x16x32_bf16 v[80:83], a[164:167], a[96:99], v[80:83]
ds_read_b64_tr_b16 a[178:179], v13 offset:16064
v_mfma_f32_16x16x32_bf16 v[84:87], a[164:167], a[100:103], v[84:87]
buffer_load_dwordx4 v3, s[8:11], s36 offen lds
v_mfma_f32_16x16x32_bf16 v[68:71], a[160:163], a[100:103], v[68:71]
v_mfma_f32_16x16x32_bf16 v[72:75], a[160:163], a[104:107], v[72:75]
ds_read_b64_tr_b16 a[180:181], v13 offset:26624
v_mfma_f32_16x16x32_bf16 v[88:91], a[164:167], a[104:107], v[88:91]
ds_read_b64_tr_b16 a[182:183], v13 offset:30208
v_mfma_f32_16x16x32_bf16 v[92:95], a[164:167], a[108:111], v[92:95]
v_mfma_f32_16x16x32_bf16 v[76:79], a[160:163], a[108:111], v[76:79]
s_add_u32 m0, s44, 86016
s_waitcnt lgkmcnt(4)
v_mfma_f32_16x16x32_bf16 v[108:111], a[168:171], a[108:111], v[108:111]
ds_read_b64_tr_b16 a[184:185], v13 offset:26656
v_mfma_f32_16x16x32_bf16 v[124:127], a[172:175], a[108:111], v[124:127]
ds_read_b64_tr_b16 a[186:187], v13 offset:30240
v_mfma_f32_16x16x32_bf16 v[120:123], a[172:175], a[104:107], v[120:123]
buffer_load_dwordx4 v3, s[8:11], s37 offen lds
v_mfma_f32_16x16x32_bf16 v[104:107], a[168:171], a[104:107], v[104:107]
v_mfma_f32_16x16x32_bf16 v[100:103], a[168:171], a[100:103], v[100:103]
ds_read_b64_tr_b16 a[188:189], v13 offset:26688
v_mfma_f32_16x16x32_bf16 v[116:119], a[172:175], a[100:103], v[116:119]
ds_read_b64_tr_b16 a[190:191], v13 offset:30272
v_mfma_f32_16x16x32_bf16 v[112:115], a[172:175], a[96:99], v[112:115]
v_mfma_f32_16x16x32_bf16 v[96:99], a[168:171], a[96:99], v[96:99]
s_add_u32 m0, s44, 90112
s_waitcnt lgkmcnt(4)
v_mfma_f32_16x16x32_bf16 v[128:131], a[176:179], a[96:99], v[128:131]
ds_read_b64_tr_b16 a[160:161], v13 offset:26720
v_mfma_f32_16x16x32_bf16 v[144:147], a[180:183], a[96:99], v[144:147]
ds_read_b64_tr_b16 a[162:163], v13 offset:30304
v_mfma_f32_16x16x32_bf16 v[148:151], a[180:183], a[100:103], v[148:151]
buffer_load_dwordx4 v3, s[8:11], s38 offen lds
v_mfma_f32_16x16x32_bf16 v[132:135], a[176:179], a[100:103], v[132:135]
v_mfma_f32_16x16x32_bf16 v[136:139], a[176:179], a[104:107], v[136:139]
ds_read_b64_tr_b16 a[164:165], v13 offset:26752
v_mfma_f32_16x16x32_bf16 v[152:155], a[180:183], a[104:107], v[152:155]
ds_read_b64_tr_b16 a[166:167], v13 offset:30336
v_mfma_f32_16x16x32_bf16 v[156:159], a[180:183], a[108:111], v[156:159]
v_mfma_f32_16x16x32_bf16 v[140:143], a[176:179], a[108:111], v[140:143]
s_add_u32 m0, s45, 81920
s_waitcnt lgkmcnt(4)
v_mfma_f32_16x16x32_bf16 v[172:175], a[184:187], a[108:111], v[172:175]
ds_read_b64_tr_b16 a[168:169], v13 offset:26784
v_mfma_f32_16x16x32_bf16 v[188:191], a[188:191], a[108:111], v[188:191]
ds_read_b64_tr_b16 a[170:171], v13 offset:30368
v_mfma_f32_16x16x32_bf16 v[184:187], a[188:191], a[104:107], v[184:187]
buffer_load_dwordx4 v4, s[12:15], s39 offen lds
v_mfma_f32_16x16x32_bf16 v[168:171], a[184:187], a[104:107], v[168:171]
v_mfma_f32_16x16x32_bf16 v[164:167], a[184:187], a[100:103], v[164:167]
ds_read_b64_tr_b16 a[172:173], v13 offset:26816
v_mfma_f32_16x16x32_bf16 v[180:183], a[188:191], a[100:103], v[180:183]
ds_read_b64_tr_b16 a[174:175], v13 offset:30400
v_mfma_f32_16x16x32_bf16 v[176:179], a[188:191], a[96:99], v[176:179]
v_mfma_f32_16x16x32_bf16 v[160:163], a[184:187], a[96:99], v[160:163]
s_add_u32 m0, s45, 82944
s_waitcnt lgkmcnt(4)
v_mfma_f32_16x16x32_bf16 v[192:195], a[160:163], a[96:99], v[192:195]
ds_read_b64_tr_b16 a[176:177], v11 offset:2048
v_mfma_f32_16x16x32_bf16 v[208:211], a[164:167], a[96:99], v[208:211]
ds_read_b64_tr_b16 a[178:179], v11 offset:3072
v_mfma_f32_16x16x32_bf16 v[212:215], a[164:167], a[100:103], v[212:215]
buffer_load_dwordx4 v5, s[12:15], s39 offen lds
v_mfma_f32_16x16x32_bf16 v[196:199], a[160:163], a[100:103], v[196:199]
v_mfma_f32_16x16x32_bf16 v[200:203], a[160:163], a[104:107], v[200:203]
ds_read_b64_tr_b16 a[180:181], v12 offset:2048
v_mfma_f32_16x16x32_bf16 v[216:219], a[164:167], a[104:107], v[216:219]
ds_read_b64_tr_b16 a[182:183], v12 offset:3072
v_mfma_f32_16x16x32_bf16 v[220:223], a[164:167], a[108:111], v[220:223]
buffer_load_dword v30, v18, s[20:23], 0 offen
v_mfma_f32_16x16x32_bf16 v[204:207], a[160:163], a[108:111], v[204:207]
s_waitcnt lgkmcnt(4)
v_mfma_f32_16x16x32_bf16 v[236:239], a[168:171], a[108:111], v[236:239]
ds_read_b64_tr_b16 a[184:185], v11 offset:6144
v_mfma_f32_16x16x32_bf16 v[252:255], a[172:175], a[108:111], v[252:255]
ds_read_b64_tr_b16 a[186:187], v11 offset:7168
v_mfma_f32_16x16x32_bf16 v[248:251], a[172:175], a[104:107], v[248:251]
buffer_load_dword v30, v15, s[72:75], s76 offen
s_add_u32 s76, s76, s77
v_mfma_f32_16x16x32_bf16 v[232:235], a[168:171], a[104:107], v[232:235]
v_mfma_f32_16x16x32_bf16 v[228:231], a[168:171], a[100:103], v[228:231]
ds_read_b64_tr_b16 a[188:189], v12 offset:6144
v_mfma_f32_16x16x32_bf16 v[244:247], a[172:175], a[100:103], v[244:247]
ds_read_b64_tr_b16 a[190:191], v12 offset:7168
v_mfma_f32_16x16x32_bf16 v[240:243], a[172:175], a[96:99], v[240:243]
global_load_dword v30, v25, s[24:25]
v_mfma_f32_16x16x32_bf16 v[224:227], a[168:171], a[96:99], v[224:227]
s_add_u32 s40, s40, 4096
s_add_u32 s41, s41, 4096
s_add_u32 s42, s42, 4096
s_add_u32 s43, s43, 4096
s_waitcnt vmcnt(27) lgkmcnt(4)
v_mfma_f32_16x16x32_bf16 a[0:3], a[176:179], a[112:115], a[0:3]
ds_read_b64_tr_b16 a[160:161], v11 offset:10240
v_mfma_f32_16x16x32_bf16 a[16:19], a[180:183], a[112:115], a[16:19]
ds_read_b64_tr_b16 a[162:163], v11 offset:11264
v_mfma_f32_16x16x32_bf16 a[20:23], a[180:183], a[116:119], a[20:23]
buffer_load_dwordx4 a[96:99], v2, s[16:19], s40 offen offset:0 sc1
v_mfma_f32_16x16x32_bf16 a[4:7], a[176:179], a[116:119], a[4:7]
v_mfma_f32_16x16x32_bf16 a[8:11], a[176:179], a[120:123], a[8:11]
ds_read_b64_tr_b16 a[164:165], v12 offset:10240
v_mfma_f32_16x16x32_bf16 a[24:27], a[180:183], a[120:123], a[24:27]
ds_read_b64_tr_b16 a[166:167], v12 offset:11264
v_mfma_f32_16x16x32_bf16 a[28:31], a[180:183], a[124:127], a[28:31]
v_mfma_f32_16x16x32_bf16 a[12:15], a[176:179], a[124:127], a[12:15]
s_waitcnt lgkmcnt(4)
v_mfma_f32_16x16x32_bf16 a[44:47], a[184:187], a[124:127], a[44:47]
ds_read_b64_tr_b16 a[168:169], v13 offset:19456
v_mfma_f32_16x16x32_bf16 a[60:63], a[188:191], a[124:127], a[60:63]
ds_read_b64_tr_b16 a[170:171], v13 offset:23040
v_mfma_f32_16x16x32_bf16 a[56:59], a[188:191], a[120:123], a[56:59]
buffer_load_dwordx4 a[100:103], v2, s[16:19], s41 offen offset:0 sc1
v_mfma_f32_16x16x32_bf16 a[40:43], a[184:187], a[120:123], a[40:43]
v_mfma_f32_16x16x32_bf16 a[36:39], a[184:187], a[116:119], a[36:39]
ds_read_b64_tr_b16 a[172:173], v13 offset:19488
v_mfma_f32_16x16x32_bf16 a[52:55], a[188:191], a[116:119], a[52:55]
ds_read_b64_tr_b16 a[174:175], v13 offset:23072
v_mfma_f32_16x16x32_bf16 a[48:51], a[188:191], a[112:115], a[48:51]
v_mfma_f32_16x16x32_bf16 a[32:35], a[184:187], a[112:115], a[32:35]
s_waitcnt lgkmcnt(4)
v_mfma_f32_16x16x32_bf16 a[64:67], a[112:115], a[160:163], a[64:67]
ds_read_b64_tr_b16 a[176:177], v13 offset:19520
v_mfma_f32_16x16x32_bf16 a[80:83], a[112:115], a[164:167], a[80:83]
ds_read_b64_tr_b16 a[178:179], v13 offset:23104
v_mfma_f32_16x16x32_bf16 a[84:87], a[116:119], a[164:167], a[84:87]
buffer_load_dwordx4 a[104:107], v2, s[16:19], s42 offen offset:0 sc1
v_mfma_f32_16x16x32_bf16 a[68:71], a[116:119], a[160:163], a[68:71]
v_mfma_f32_16x16x32_bf16 a[72:75], a[120:123], a[160:163], a[72:75]
ds_read_b64_tr_b16 a[180:181], v13 offset:19552
v_mfma_f32_16x16x32_bf16 a[88:91], a[120:123], a[164:167], a[88:91]
ds_read_b64_tr_b16 a[182:183], v13 offset:23136
v_mfma_f32_16x16x32_bf16 a[92:95], a[124:127], a[164:167], a[92:95]
v_mfma_f32_16x16x32_bf16 a[76:79], a[124:127], a[160:163], a[76:79]
s_waitcnt lgkmcnt(4)
v_mfma_f32_16x16x32_bf16 v[44:47], a[168:171], a[124:127], v[44:47]
ds_read_b64_tr_b16 a[184:185], v13 offset:19584
v_mfma_f32_16x16x32_bf16 v[60:63], a[172:175], a[124:127], v[60:63]
ds_read_b64_tr_b16 a[186:187], v13 offset:23168
v_mfma_f32_16x16x32_bf16 v[56:59], a[172:175], a[120:123], v[56:59]
buffer_load_dwordx4 a[108:111], v2, s[16:19], s43 offen offset:0 sc1
v_mfma_f32_16x16x32_bf16 v[40:43], a[168:171], a[120:123], v[40:43]
v_mfma_f32_16x16x32_bf16 v[36:39], a[168:171], a[116:119], v[36:39]
ds_read_b64_tr_b16 a[188:189], v13 offset:19616
v_mfma_f32_16x16x32_bf16 v[52:55], a[172:175], a[116:119], v[52:55]
ds_read_b64_tr_b16 a[190:191], v13 offset:23200
v_mfma_f32_16x16x32_bf16 v[48:51], a[172:175], a[112:115], v[48:51]
v_mfma_f32_16x16x32_bf16 v[32:35], a[168:171], a[112:115], v[32:35]
s_add_u32 m0, s45, 83968
s_waitcnt lgkmcnt(4)
v_mfma_f32_16x16x32_bf16 v[64:67], a[176:179], a[112:115], v[64:67]
ds_read_b64_tr_b16 a[160:161], v13 offset:19648
v_mfma_f32_16x16x32_bf16 v[80:83], a[180:183], a[112:115], v[80:83]
ds_read_b64_tr_b16 a[162:163], v13 offset:23232
v_mfma_f32_16x16x32_bf16 v[84:87], a[180:183], a[116:119], v[84:87]
buffer_load_dwordx4 v6, s[12:15], s39 offen lds
v_mfma_f32_16x16x32_bf16 v[68:71], a[176:179], a[116:119], v[68:71]
v_mfma_f32_16x16x32_bf16 v[72:75], a[176:179], a[120:123], v[72:75]
ds_read_b64_tr_b16 a[164:165], v13 offset:33792
v_mfma_f32_16x16x32_bf16 v[88:91], a[180:183], a[120:123], v[88:91]
ds_read_b64_tr_b16 a[166:167], v13 offset:37376
v_mfma_f32_16x16x32_bf16 v[92:95], a[180:183], a[124:127], v[92:95]
v_mfma_f32_16x16x32_bf16 v[76:79], a[176:179], a[124:127], v[76:79]
s_add_u32 m0, s45, 84992
s_waitcnt lgkmcnt(4)
v_mfma_f32_16x16x32_bf16 v[108:111], a[184:187], a[124:127], v[108:111]
ds_read_b64_tr_b16 a[168:169], v13 offset:33824
v_mfma_f32_16x16x32_bf16 v[124:127], a[188:191], a[124:127], v[124:127]
ds_read_b64_tr_b16 a[170:171], v13 offset:37408
v_mfma_f32_16x16x32_bf16 v[120:123], a[188:191], a[120:123], v[120:123]
buffer_load_dwordx4 v7, s[12:15], s39 offen lds
v_mfma_f32_16x16x32_bf16 v[104:107], a[184:187], a[120:123], v[104:107]
v_mfma_f32_16x16x32_bf16 v[100:103], a[184:187], a[116:119], v[100:103]
ds_read_b64_tr_b16 a[172:173], v13 offset:33856
v_mfma_f32_16x16x32_bf16 v[116:119], a[188:191], a[116:119], v[116:119]
ds_read_b64_tr_b16 a[174:175], v13 offset:37440
v_mfma_f32_16x16x32_bf16 v[112:115], a[188:191], a[112:115], v[112:115]
v_mfma_f32_16x16x32_bf16 v[96:99], a[184:187], a[112:115], v[96:99]
s_add_u32 m0, s45, 86016
s_waitcnt lgkmcnt(4)
v_mfma_f32_16x16x32_bf16 v[128:131], a[160:163], a[112:115], v[128:131]
ds_read_b64_tr_b16 a[176:177], v13 offset:33888
v_mfma_f32_16x16x32_bf16 v[144:147], a[164:167], a[112:115], v[144:147]
ds_read_b64_tr_b16 a[178:179], v13 offset:37472
v_mfma_f32_16x16x32_bf16 v[148:151], a[164:167], a[116:119], v[148:151]
buffer_load_dwordx4 v8, s[12:15], s39 offen lds
v_mfma_f32_16x16x32_bf16 v[132:135], a[160:163], a[116:119], v[132:135]
v_mfma_f32_16x16x32_bf16 v[136:139], a[160:163], a[120:123], v[136:139]
ds_read_b64_tr_b16 a[180:181], v13 offset:33920
v_mfma_f32_16x16x32_bf16 v[152:155], a[164:167], a[120:123], v[152:155]
ds_read_b64_tr_b16 a[182:183], v13 offset:37504
v_mfma_f32_16x16x32_bf16 v[156:159], a[164:167], a[124:127], v[156:159]
v_mfma_f32_16x16x32_bf16 v[140:143], a[160:163], a[124:127], v[140:143]
s_add_u32 m0, s45, 87040
s_waitcnt lgkmcnt(4)
v_mfma_f32_16x16x32_bf16 v[172:175], a[168:171], a[124:127], v[172:175]
ds_read_b64_tr_b16 a[184:185], v13 offset:33952
v_mfma_f32_16x16x32_bf16 v[188:191], a[172:175], a[124:127], v[188:191]
ds_read_b64_tr_b16 a[186:187], v13 offset:37536
v_mfma_f32_16x16x32_bf16 v[184:187], a[172:175], a[120:123], v[184:187]
buffer_load_dwordx4 v9, s[12:15], s39 offen lds
v_mfma_f32_16x16x32_bf16 v[168:171], a[168:171], a[120:123], v[168:171]
v_mfma_f32_16x16x32_bf16 v[164:167], a[168:171], a[116:119], v[164:167]
ds_read_b64_tr_b16 a[188:189], v13 offset:33984
v_mfma_f32_16x16x32_bf16 v[180:183], a[172:175], a[116:119], v[180:183]
ds_read_b64_tr_b16 a[190:191], v13 offset:37568
v_mfma_f32_16x16x32_bf16 v[176:179], a[172:175], a[112:115], v[176:179]
v_mfma_f32_16x16x32_bf16 v[160:163], a[168:171], a[112:115], v[160:163]
v_add_u32 v11, 40960, v11
v_add_u32 v12, 40960, v12
v_add_u32 v13, 40960, v13
s_add_u32 m0, s45, 88064
s_waitcnt lgkmcnt(4)
v_mfma_f32_16x16x32_bf16 v[192:195], a[176:179], a[112:115], v[192:195]
s_waitcnt vmcnt(20)
s_barrier
ds_read_b64_tr_b16 a[160:161], v11 offset:0
v_mfma_f32_16x16x32_bf16 v[208:211], a[180:183], a[112:115], v[208:211]
ds_read_b64_tr_b16 a[162:163], v11 offset:1024
v_mfma_f32_16x16x32_bf16 v[212:215], a[180:183], a[116:119], v[212:215]
buffer_load_dwordx4 v10, s[12:15], s39 offen lds
v_mfma_f32_16x16x32_bf16 v[196:199], a[176:179], a[116:119], v[196:199]
v_mfma_f32_16x16x32_bf16 v[200:203], a[176:179], a[120:123], v[200:203]
ds_read_b64_tr_b16 a[164:165], v12 offset:0
v_mfma_f32_16x16x32_bf16 v[216:219], a[180:183], a[120:123], v[216:219]
ds_read_b64_tr_b16 a[166:167], v12 offset:1024
v_mfma_f32_16x16x32_bf16 v[220:223], a[180:183], a[124:127], v[220:223]
v_mfma_f32_16x16x32_bf16 v[204:207], a[176:179], a[124:127], v[204:207]
s_waitcnt lgkmcnt(4)
v_mfma_f32_16x16x32_bf16 v[236:239], a[184:187], a[124:127], v[236:239]
ds_read_b64_tr_b16 a[168:169], v11 offset:4096
v_mfma_f32_16x16x32_bf16 v[252:255], a[188:191], a[124:127], v[252:255]
ds_read_b64_tr_b16 a[170:171], v11 offset:5120
v_mfma_f32_16x16x32_bf16 v[248:251], a[188:191], a[120:123], v[248:251]
s_add_u32 s36, s36, 393216
s_add_u32 s37, s37, 393216
s_add_u32 s38, s38, 393216
s_add_u32 s39, s39, 458752
v_mfma_f32_16x16x32_bf16 v[232:235], a[184:187], a[120:123], v[232:235]
v_mfma_f32_16x16x32_bf16 v[228:231], a[184:187], a[116:119], v[228:231]
ds_read_b64_tr_b16 a[172:173], v12 offset:4096
v_mfma_f32_16x16x32_bf16 v[244:247], a[188:191], a[116:119], v[244:247]
ds_read_b64_tr_b16 a[174:175], v12 offset:5120
v_mfma_f32_16x16x32_bf16 v[240:243], a[188:191], a[112:115], v[240:243]
v_mfma_f32_16x16x32_bf16 v[224:227], a[184:187], a[112:115], v[224:227]
s_waitcnt vmcnt(26) lgkmcnt(4)
v_mfma_f32_16x16x32_bf16 a[0:3], a[160:163], a[128:131], a[0:3]
ds_read_b64_tr_b16 a[176:177], v11 offset:8192
v_mfma_f32_16x16x32_bf16 a[16:19], a[164:167], a[128:131], a[16:19]
ds_read_b64_tr_b16 a[178:179], v11 offset:9216
v_mfma_f32_16x16x32_bf16 a[20:23], a[164:167], a[132:135], a[20:23]
buffer_load_dwordx4 a[112:115], v2, s[16:19], s40 offen offset:1024 sc1
v_mfma_f32_16x16x32_bf16 a[4:7], a[160:163], a[132:135], a[4:7]
v_mfma_f32_16x16x32_bf16 a[8:11], a[160:163], a[136:139], a[8:11]
ds_read_b64_tr_b16 a[180:181], v12 offset:8192
v_mfma_f32_16x16x32_bf16 a[24:27], a[164:167], a[136:139], a[24:27]
ds_read_b64_tr_b16 a[182:183], v12 offset:9216
v_mfma_f32_16x16x32_bf16 a[28:31], a[164:167], a[140:143], a[28:31]
v_mfma_f32_16x16x32_bf16 a[12:15], a[160:163], a[140:143], a[12:15]
s_waitcnt lgkmcnt(4)
v_mfma_f32_16x16x32_bf16 a[44:47], a[168:171], a[140:143], a[44:47]
ds_read_b64_tr_b16 a[184:185], v13 offset:12288
v_mfma_f32_16x16x32_bf16 a[60:63], a[172:175], a[140:143], a[60:63]
ds_read_b64_tr_b16 a[186:187], v13 offset:15872
v_mfma_f32_16x16x32_bf16 a[56:59], a[172:175], a[136:139], a[56:59]
buffer_load_dwordx4 a[116:119], v2, s[16:19], s41 offen offset:1024 sc1
v_mfma_f32_16x16x32_bf16 a[40:43], a[168:171], a[136:139], a[40:43]
v_mfma_f32_16x16x32_bf16 a[36:39], a[168:171], a[132:135], a[36:39]
ds_read_b64_tr_b16 a[188:189], v13 offset:12320
v_mfma_f32_16x16x32_bf16 a[52:55], a[172:175], a[132:135], a[52:55]
ds_read_b64_tr_b16 a[190:191], v13 offset:15904
v_mfma_f32_16x16x32_bf16 a[48:51], a[172:175], a[128:131], a[48:51]
v_mfma_f32_16x16x32_bf16 a[32:35], a[168:171], a[128:131], a[32:35]
s_waitcnt lgkmcnt(4)
v_mfma_f32_16x16x32_bf16 a[64:67], a[128:131], a[176:179], a[64:67]
ds_read_b64_tr_b16 a[160:161], v13 offset:12352
v_mfma_f32_16x16x32_bf16 a[80:83], a[128:131], a[180:183], a[80:83]
ds_read_b64_tr_b16 a[162:163], v13 offset:15936
v_mfma_f32_16x16x32_bf16 a[84:87], a[132:135], a[180:183], a[84:87]
buffer_load_dwordx4 a[120:123], v2, s[16:19], s42 offen offset:1024 sc1
v_mfma_f32_16x16x32_bf16 a[68:71], a[132:135], a[176:179], a[68:71]
v_mfma_f32_16x16x32_bf16 a[72:75], a[136:139], a[176:179], a[72:75]
ds_read_b64_tr_b16 a[164:165], v13 offset:12384
v_mfma_f32_16x16x32_bf16 a[88:91], a[136:139], a[180:183], a[88:91]
ds_read_b64_tr_b16 a[166:167], v13 offset:15968
v_mfma_f32_16x16x32_bf16 a[92:95], a[140:143], a[180:183], a[92:95]
v_mfma_f32_16x16x32_bf16 a[76:79], a[140:143], a[176:179], a[76:79]
s_waitcnt lgkmcnt(4)
v_mfma_f32_16x16x32_bf16 v[44:47], a[184:187], a[140:143], v[44:47]
ds_read_b64_tr_b16 a[168:169], v13 offset:12416
v_mfma_f32_16x16x32_bf16 v[60:63], a[188:191], a[140:143], v[60:63]
ds_read_b64_tr_b16 a[170:171], v13 offset:16000
v_mfma_f32_16x16x32_bf16 v[56:59], a[188:191], a[136:139], v[56:59]
buffer_load_dwordx4 a[124:127], v2, s[16:19], s43 offen offset:1024 sc1
v_mfma_f32_16x16x32_bf16 v[40:43], a[184:187], a[136:139], v[40:43]
v_mfma_f32_16x16x32_bf16 v[36:39], a[184:187], a[132:135], v[36:39]
ds_read_b64_tr_b16 a[172:173], v13 offset:12448
v_mfma_f32_16x16x32_bf16 v[52:55], a[188:191], a[132:135], v[52:55]
ds_read_b64_tr_b16 a[174:175], v13 offset:16032
v_mfma_f32_16x16x32_bf16 v[48:51], a[188:191], a[128:131], v[48:51]
v_mfma_f32_16x16x32_bf16 v[32:35], a[184:187], a[128:131], v[32:35]
s_add_u32 m0, s44, 122880
s_waitcnt lgkmcnt(4)
v_mfma_f32_16x16x32_bf16 v[64:67], a[160:163], a[128:131], v[64:67]
ds_read_b64_tr_b16 a[176:177], v13 offset:12480
v_mfma_f32_16x16x32_bf16 v[80:83], a[164:167], a[128:131], v[80:83]
ds_read_b64_tr_b16 a[178:179], v13 offset:16064
v_mfma_f32_16x16x32_bf16 v[84:87], a[164:167], a[132:135], v[84:87]
buffer_load_dwordx4 v3, s[8:11], s36 offen lds
v_mfma_f32_16x16x32_bf16 v[68:71], a[160:163], a[132:135], v[68:71]
v_mfma_f32_16x16x32_bf16 v[72:75], a[160:163], a[136:139], v[72:75]
ds_read_b64_tr_b16 a[180:181], v13 offset:26624
v_mfma_f32_16x16x32_bf16 v[88:91], a[164:167], a[136:139], v[88:91]
ds_read_b64_tr_b16 a[182:183], v13 offset:30208
v_mfma_f32_16x16x32_bf16 v[92:95], a[164:167], a[140:143], v[92:95]
v_mfma_f32_16x16x32_bf16 v[76:79], a[160:163], a[140:143], v[76:79]
s_add_u32 m0, s44, 126976
s_waitcnt lgkmcnt(4)
v_mfma_f32_16x16x32_bf16 v[108:111], a[168:171], a[140:143], v[108:111]
ds_read_b64_tr_b16 a[184:185], v13 offset:26656
v_mfma_f32_16x16x32_bf16 v[124:127], a[172:175], a[140:143], v[124:127]
ds_read_b64_tr_b16 a[186:187], v13 offset:30240
v_mfma_f32_16x16x32_bf16 v[120:123], a[172:175], a[136:139], v[120:123]
buffer_load_dwordx4 v3, s[8:11], s37 offen lds
v_mfma_f32_16x16x32_bf16 v[104:107], a[168:171], a[136:139], v[104:107]
v_mfma_f32_16x16x32_bf16 v[100:103], a[168:171], a[132:135], v[100:103]
ds_read_b64_tr_b16 a[188:189], v13 offset:26688
v_mfma_f32_16x16x32_bf16 v[116:119], a[172:175], a[132:135], v[116:119]
ds_read_b64_tr_b16 a[190:191], v13 offset:30272
v_mfma_f32_16x16x32_bf16 v[112:115], a[172:175], a[128:131], v[112:115]
v_mfma_f32_16x16x32_bf16 v[96:99], a[168:171], a[128:131], v[96:99]
s_add_u32 m0, s44, 131072
s_waitcnt lgkmcnt(4)
v_mfma_f32_16x16x32_bf16 v[128:131], a[176:179], a[128:131], v[128:131]
ds_read_b64_tr_b16 a[160:161], v13 offset:26720
v_mfma_f32_16x16x32_bf16 v[144:147], a[180:183], a[128:131], v[144:147]
ds_read_b64_tr_b16 a[162:163], v13 offset:30304
v_mfma_f32_16x16x32_bf16 v[148:151], a[180:183], a[132:135], v[148:151]
buffer_load_dwordx4 v3, s[8:11], s38 offen lds
v_mfma_f32_16x16x32_bf16 v[132:135], a[176:179], a[132:135], v[132:135]
v_mfma_f32_16x16x32_bf16 v[136:139], a[176:179], a[136:139], v[136:139]
ds_read_b64_tr_b16 a[164:165], v13 offset:26752
v_mfma_f32_16x16x32_bf16 v[152:155], a[180:183], a[136:139], v[152:155]
ds_read_b64_tr_b16 a[166:167], v13 offset:30336
v_mfma_f32_16x16x32_bf16 v[156:159], a[180:183], a[140:143], v[156:159]
v_mfma_f32_16x16x32_bf16 v[140:143], a[176:179], a[140:143], v[140:143]
s_add_u32 m0, s45, 122880
s_waitcnt lgkmcnt(4)
v_mfma_f32_16x16x32_bf16 v[172:175], a[184:187], a[140:143], v[172:175]
ds_read_b64_tr_b16 a[168:169], v13 offset:26784
v_mfma_f32_16x16x32_bf16 v[188:191], a[188:191], a[140:143], v[188:191]
ds_read_b64_tr_b16 a[170:171], v13 offset:30368
v_mfma_f32_16x16x32_bf16 v[184:187], a[188:191], a[136:139], v[184:187]
buffer_load_dwordx4 v4, s[12:15], s39 offen lds
v_mfma_f32_16x16x32_bf16 v[168:171], a[184:187], a[136:139], v[168:171]
v_mfma_f32_16x16x32_bf16 v[164:167], a[184:187], a[132:135], v[164:167]
ds_read_b64_tr_b16 a[172:173], v13 offset:26816
v_mfma_f32_16x16x32_bf16 v[180:183], a[188:191], a[132:135], v[180:183]
ds_read_b64_tr_b16 a[174:175], v13 offset:30400
v_mfma_f32_16x16x32_bf16 v[176:179], a[188:191], a[128:131], v[176:179]
v_mfma_f32_16x16x32_bf16 v[160:163], a[184:187], a[128:131], v[160:163]
s_add_u32 m0, s45, 123904
s_waitcnt lgkmcnt(4)
v_mfma_f32_16x16x32_bf16 v[192:195], a[160:163], a[128:131], v[192:195]
ds_read_b64_tr_b16 a[176:177], v11 offset:2048
v_mfma_f32_16x16x32_bf16 v[208:211], a[164:167], a[128:131], v[208:211]
ds_read_b64_tr_b16 a[178:179], v11 offset:3072
v_mfma_f32_16x16x32_bf16 v[212:215], a[164:167], a[132:135], v[212:215]
buffer_load_dwordx4 v5, s[12:15], s39 offen lds
v_mfma_f32_16x16x32_bf16 v[196:199], a[160:163], a[132:135], v[196:199]
v_mfma_f32_16x16x32_bf16 v[200:203], a[160:163], a[136:139], v[200:203]
ds_read_b64_tr_b16 a[180:181], v12 offset:2048
v_mfma_f32_16x16x32_bf16 v[216:219], a[164:167], a[136:139], v[216:219]
ds_read_b64_tr_b16 a[182:183], v12 offset:3072
v_mfma_f32_16x16x32_bf16 v[220:223], a[164:167], a[140:143], v[220:223]
v_mfma_f32_16x16x32_bf16 v[204:207], a[160:163], a[140:143], v[204:207]
s_waitcnt lgkmcnt(4)
v_mfma_f32_16x16x32_bf16 v[236:239], a[168:171], a[140:143], v[236:239]
ds_read_b64_tr_b16 a[184:185], v11 offset:6144
v_mfma_f32_16x16x32_bf16 v[252:255], a[172:175], a[140:143], v[252:255]
ds_read_b64_tr_b16 a[186:187], v11 offset:7168
v_mfma_f32_16x16x32_bf16 v[248:251], a[172:175], a[136:139], v[248:251]
buffer_load_dword v30, v15, s[72:75], s76 offen
s_add_u32 s76, s76, s77
v_mfma_f32_16x16x32_bf16 v[232:235], a[168:171], a[136:139], v[232:235]
v_mfma_f32_16x16x32_bf16 v[228:231], a[168:171], a[132:135], v[228:231]
ds_read_b64_tr_b16 a[188:189], v12 offset:6144
v_mfma_f32_16x16x32_bf16 v[244:247], a[172:175], a[132:135], v[244:247]
ds_read_b64_tr_b16 a[190:191], v12 offset:7168
v_mfma_f32_16x16x32_bf16 v[240:243], a[172:175], a[128:131], v[240:243]
v_mfma_f32_16x16x32_bf16 v[224:227], a[168:171], a[128:131], v[224:227]
s_waitcnt vmcnt(27) lgkmcnt(4)
v_mfma_f32_16x16x32_bf16 a[0:3], a[176:179], a[144:147], a[0:3]
ds_read_b64_tr_b16 a[160:161], v11 offset:10240
v_mfma_f32_16x16x32_bf16 a[16:19], a[180:183], a[144:147], a[16:19]
ds_read_b64_tr_b16 a[162:163], v11 offset:11264
v_mfma_f32_16x16x32_bf16 a[20:23], a[180:183], a[148:151], a[20:23]
buffer_load_dwordx4 a[128:131], v2, s[16:19], s40 offen offset:2048 sc1
v_mfma_f32_16x16x32_bf16 a[4:7], a[176:179], a[148:151], a[4:7]
v_mfma_f32_16x16x32_bf16 a[8:11], a[176:179], a[152:155], a[8:11]
ds_read_b64_tr_b16 a[164:165], v12 offset:10240
v_mfma_f32_16x16x32_bf16 a[24:27], a[180:183], a[152:155], a[24:27]
ds_read_b64_tr_b16 a[166:167], v12 offset:11264
v_mfma_f32_16x16x32_bf16 a[28:31], a[180:183], a[156:159], a[28:31]
v_mfma_f32_16x16x32_bf16 a[12:15], a[176:179], a[156:159], a[12:15]
s_waitcnt lgkmcnt(4)
v_mfma_f32_16x16x32_bf16 a[44:47], a[184:187], a[156:159], a[44:47]
ds_read_b64_tr_b16 a[168:169], v13 offset:19456
v_mfma_f32_16x16x32_bf16 a[60:63], a[188:191], a[156:159], a[60:63]
ds_read_b64_tr_b16 a[170:171], v13 offset:23040
v_mfma_f32_16x16x32_bf16 a[56:59], a[188:191], a[152:155], a[56:59]
buffer_load_dwordx4 a[132:135], v2, s[16:19], s41 offen offset:2048 sc1
v_mfma_f32_16x16x32_bf16 a[40:43], a[184:187], a[152:155], a[40:43]
v_mfma_f32_16x16x32_bf16 a[36:39], a[184:187], a[148:151], a[36:39]
ds_read_b64_tr_b16 a[172:173], v13 offset:19488
v_mfma_f32_16x16x32_bf16 a[52:55], a[188:191], a[148:151], a[52:55]
ds_read_b64_tr_b16 a[174:175], v13 offset:23072
v_mfma_f32_16x16x32_bf16 a[48:51], a[188:191], a[144:147], a[48:51]
v_mfma_f32_16x16x32_bf16 a[32:35], a[184:187], a[144:147], a[32:35]
s_waitcnt lgkmcnt(4)
v_mfma_f32_16x16x32_bf16 a[64:67], a[144:147], a[160:163], a[64:67]
ds_read_b64_tr_b16 a[176:177], v13 offset:19520
v_mfma_f32_16x16x32_bf16 a[80:83], a[144:147], a[164:167], a[80:83]
ds_read_b64_tr_b16 a[178:179], v13 offset:23104
v_mfma_f32_16x16x32_bf16 a[84:87], a[148:151], a[164:167], a[84:87]
buffer_load_dwordx4 a[136:139], v2, s[16:19], s42 offen offset:2048 sc1
v_mfma_f32_16x16x32_bf16 a[68:71], a[148:151], a[160:163], a[68:71]
v_mfma_f32_16x16x32_bf16 a[72:75], a[152:155], a[160:163], a[72:75]
ds_read_b64_tr_b16 a[180:181], v13 offset:19552
v_mfma_f32_16x16x32_bf16 a[88:91], a[152:155], a[164:167], a[88:91]
ds_read_b64_tr_b16 a[182:183], v13 offset:23136
v_mfma_f32_16x16x32_bf16 a[92:95], a[156:159], a[164:167], a[92:95]
v_mfma_f32_16x16x32_bf16 a[76:79], a[156:159], a[160:163], a[76:79]
s_waitcnt lgkmcnt(4)
v_mfma_f32_16x16x32_bf16 v[44:47], a[168:171], a[156:159], v[44:47]
ds_read_b64_tr_b16 a[184:185], v13 offset:19584
v_mfma_f32_16x16x32_bf16 v[60:63], a[172:175], a[156:159], v[60:63]
ds_read_b64_tr_b16 a[186:187], v13 offset:23168
v_mfma_f32_16x16x32_bf16 v[56:59], a[172:175], a[152:155], v[56:59]
buffer_load_dwordx4 a[140:143], v2, s[16:19], s43 offen offset:2048 sc1
v_mfma_f32_16x16x32_bf16 v[40:43], a[168:171], a[152:155], v[40:43]
v_mfma_f32_16x16x32_bf16 v[36:39], a[168:171], a[148:151], v[36:39]
ds_read_b64_tr_b16 a[188:189], v13 offset:19616
v_mfma_f32_16x16x32_bf16 v[52:55], a[172:175], a[148:151], v[52:55]
ds_read_b64_tr_b16 a[190:191], v13 offset:23200
v_mfma_f32_16x16x32_bf16 v[48:51], a[172:175], a[144:147], v[48:51]
v_mfma_f32_16x16x32_bf16 v[32:35], a[168:171], a[144:147], v[32:35]
s_add_u32 m0, s45, 124928
s_waitcnt lgkmcnt(4)
v_mfma_f32_16x16x32_bf16 v[64:67], a[176:179], a[144:147], v[64:67]
ds_read_b64_tr_b16 a[160:161], v13 offset:19648
v_mfma_f32_16x16x32_bf16 v[80:83], a[180:183], a[144:147], v[80:83]
ds_read_b64_tr_b16 a[162:163], v13 offset:23232
v_mfma_f32_16x16x32_bf16 v[84:87], a[180:183], a[148:151], v[84:87]
buffer_load_dwordx4 v6, s[12:15], s39 offen lds
v_mfma_f32_16x16x32_bf16 v[68:71], a[176:179], a[148:151], v[68:71]
v_mfma_f32_16x16x32_bf16 v[72:75], a[176:179], a[152:155], v[72:75]
ds_read_b64_tr_b16 a[164:165], v13 offset:33792
v_mfma_f32_16x16x32_bf16 v[88:91], a[180:183], a[152:155], v[88:91]
ds_read_b64_tr_b16 a[166:167], v13 offset:37376
v_mfma_f32_16x16x32_bf16 v[92:95], a[180:183], a[156:159], v[92:95]
v_mfma_f32_16x16x32_bf16 v[76:79], a[176:179], a[156:159], v[76:79]
s_add_u32 m0, s45, 125952
s_waitcnt lgkmcnt(4)
v_mfma_f32_16x16x32_bf16 v[108:111], a[184:187], a[156:159], v[108:111]
ds_read_b64_tr_b16 a[168:169], v13 offset:33824
v_mfma_f32_16x16x32_bf16 v[124:127], a[188:191], a[156:159], v[124:127]
ds_read_b64_tr_b16 a[170:171], v13 offset:37408
v_mfma_f32_16x16x32_bf16 v[120:123], a[188:191], a[152:155], v[120:123]
buffer_load_dwordx4 v7, s[12:15], s39 offen lds
v_mfma_f32_16x16x32_bf16 v[104:107], a[184:187], a[152:155], v[104:107]
v_mfma_f32_16x16x32_bf16 v[100:103], a[184:187], a[148:151], v[100:103]
ds_read_b64_tr_b16 a[172:173], v13 offset:33856
v_mfma_f32_16x16x32_bf16 v[116:119], a[188:191], a[148:151], v[116:119]
ds_read_b64_tr_b16 a[174:175], v13 offset:37440
v_mfma_f32_16x16x32_bf16 v[112:115], a[188:191], a[144:147], v[112:115]
v_mfma_f32_16x16x32_bf16 v[96:99], a[184:187], a[144:147], v[96:99]
s_add_u32 m0, s45, 126976
s_waitcnt lgkmcnt(4)
v_mfma_f32_16x16x32_bf16 v[128:131], a[160:163], a[144:147], v[128:131]
ds_read_b64_tr_b16 a[176:177], v13 offset:33888
v_mfma_f32_16x16x32_bf16 v[144:147], a[164:167], a[144:147], v[144:147]
ds_read_b64_tr_b16 a[178:179], v13 offset:37472
v_mfma_f32_16x16x32_bf16 v[148:151], a[164:167], a[148:151], v[148:151]
buffer_load_dwordx4 v8, s[12:15], s39 offen lds
v_mfma_f32_16x16x32_bf16 v[132:135], a[160:163], a[148:151], v[132:135]
v_mfma_f32_16x16x32_bf16 v[136:139], a[160:163], a[152:155], v[136:139]
ds_read_b64_tr_b16 a[180:181], v13 offset:33920
v_mfma_f32_16x16x32_bf16 v[152:155], a[164:167], a[152:155], v[152:155]
ds_read_b64_tr_b16 a[182:183], v13 offset:37504
v_mfma_f32_16x16x32_bf16 v[156:159], a[164:167], a[156:159], v[156:159]
v_mfma_f32_16x16x32_bf16 v[140:143], a[160:163], a[156:159], v[140:143]
s_add_u32 m0, s45, 128000
s_waitcnt lgkmcnt(4)
v_mfma_f32_16x16x32_bf16 v[172:175], a[168:171], a[156:159], v[172:175]
ds_read_b64_tr_b16 a[184:185], v13 offset:33952
v_mfma_f32_16x16x32_bf16 v[188:191], a[172:175], a[156:159], v[188:191]
ds_read_b64_tr_b16 a[186:187], v13 offset:37536
v_mfma_f32_16x16x32_bf16 v[184:187], a[172:175], a[152:155], v[184:187]
buffer_load_dwordx4 v9, s[12:15], s39 offen lds
v_mfma_f32_16x16x32_bf16 v[168:171], a[168:171], a[152:155], v[168:171]
v_mfma_f32_16x16x32_bf16 v[164:167], a[168:171], a[148:151], v[164:167]
ds_read_b64_tr_b16 a[188:189], v13 offset:33984
v_mfma_f32_16x16x32_bf16 v[180:183], a[172:175], a[148:151], v[180:183]
ds_read_b64_tr_b16 a[190:191], v13 offset:37568
v_mfma_f32_16x16x32_bf16 v[176:179], a[172:175], a[144:147], v[176:179]
v_mfma_f32_16x16x32_bf16 v[160:163], a[168:171], a[144:147], v[160:163]
v_add_u32 v11, 40960, v11
v_add_u32 v12, 40960, v12
v_add_u32 v13, 40960, v13
s_add_u32 m0, s45, 129024
s_waitcnt lgkmcnt(4)
v_mfma_f32_16x16x32_bf16 v[192:195], a[176:179], a[144:147], v[192:195]
s_waitcnt vmcnt(18)
s_barrier
ds_read_b64_tr_b16 a[160:161], v11 offset:4096
v_mfma_f32_16x16x32_bf16 v[208:211], a[180:183], a[144:147], v[208:211]
ds_read_b64_tr_b16 a[162:163], v11 offset:5120
v_mfma_f32_16x16x32_bf16 v[212:215], a[180:183], a[148:151], v[212:215]
buffer_load_dwordx4 v10, s[12:15], s39 offen lds
v_mfma_f32_16x16x32_bf16 v[196:199], a[176:179], a[148:151], v[196:199]
v_mfma_f32_16x16x32_bf16 v[200:203], a[176:179], a[152:155], v[200:203]
ds_read_b64_tr_b16 a[164:165], v12 offset:4096
v_mfma_f32_16x16x32_bf16 v[216:219], a[180:183], a[152:155], v[216:219]
ds_read_b64_tr_b16 a[166:167], v12 offset:5120
v_mfma_f32_16x16x32_bf16 v[220:223], a[180:183], a[156:159], v[220:223]
v_mfma_f32_16x16x32_bf16 v[204:207], a[176:179], a[156:159], v[204:207]
s_waitcnt lgkmcnt(4)
v_mfma_f32_16x16x32_bf16 v[236:239], a[184:187], a[156:159], v[236:239]
ds_read_b64_tr_b16 a[168:169], v11 offset:8192
v_mfma_f32_16x16x32_bf16 v[252:255], a[188:191], a[156:159], v[252:255]
ds_read_b64_tr_b16 a[170:171], v11 offset:9216
v_mfma_f32_16x16x32_bf16 v[248:251], a[188:191], a[152:155], v[248:251]
v_mfma_f32_16x16x32_bf16 v[232:235], a[184:187], a[152:155], v[232:235]
v_mfma_f32_16x16x32_bf16 v[228:231], a[184:187], a[148:151], v[228:231]
ds_read_b64_tr_b16 a[172:173], v12 offset:8192
v_mfma_f32_16x16x32_bf16 v[244:247], a[188:191], a[148:151], v[244:247]
ds_read_b64_tr_b16 a[174:175], v12 offset:9216
v_mfma_f32_16x16x32_bf16 v[240:243], a[188:191], a[144:147], v[240:243]
v_mfma_f32_16x16x32_bf16 v[224:227], a[184:187], a[144:147], v[224:227]
s_waitcnt vmcnt(24) lgkmcnt(4)
v_mfma_f32_16x16x32_bf16 a[32:35], a[160:163], a[96:99], a[32:35]
ds_read_b64_tr_b16 a[176:177], v11 offset:6144
v_mfma_f32_16x16x32_bf16 a[48:51], a[164:167], a[96:99], a[48:51]
ds_read_b64_tr_b16 a[178:179], v11 offset:7168
v_mfma_f32_16x16x32_bf16 a[52:55], a[164:167], a[100:103], a[52:55]
buffer_load_dwordx4 a[144:147], v2, s[16:19], s40 offen offset:3072 sc1
v_mfma_f32_16x16x32_bf16 a[36:39], a[160:163], a[100:103], a[36:39]
v_mfma_f32_16x16x32_bf16 a[40:43], a[160:163], a[104:107], a[40:43]
ds_read_b64_tr_b16 a[180:181], v12 offset:6144
v_mfma_f32_16x16x32_bf16 a[56:59], a[164:167], a[104:107], a[56:59]
ds_read_b64_tr_b16 a[182:183], v12 offset:7168
v_mfma_f32_16x16x32_bf16 a[60:63], a[164:167], a[108:111], a[60:63]
v_mfma_f32_16x16x32_bf16 a[44:47], a[160:163], a[108:111], a[44:47]
s_waitcnt lgkmcnt(4)
v_mfma_f32_16x16x32_bf16 a[76:79], a[108:111], a[168:171], a[76:79]
ds_read_b64_tr_b16 a[184:185], v11 offset:10240
v_mfma_f32_16x16x32_bf16 a[92:95], a[108:111], a[172:175], a[92:95]
ds_read_b64_tr_b16 a[186:187], v11 offset:11264
v_mfma_f32_16x16x32_bf16 a[88:91], a[104:107], a[172:175], a[88:91]
buffer_load_dwordx4 a[148:151], v2, s[16:19], s41 offen offset:3072 sc1
v_mfma_f32_16x16x32_bf16 a[72:75], a[104:107], a[168:171], a[72:75]
v_mfma_f32_16x16x32_bf16 a[68:71], a[100:103], a[168:171], a[68:71]
ds_read_b64_tr_b16 a[188:189], v12 offset:10240
v_mfma_f32_16x16x32_bf16 a[84:87], a[100:103], a[172:175], a[84:87]
ds_read_b64_tr_b16 a[190:191], v12 offset:11264
v_mfma_f32_16x16x32_bf16 a[80:83], a[96:99], a[172:175], a[80:83]
v_mfma_f32_16x16x32_bf16 a[64:67], a[96:99], a[168:171], a[64:67]
s_waitcnt vmcnt(17) lgkmcnt(4)
v_mfma_f32_16x16x32_bf16 a[32:35], a[176:179], a[112:115], a[32:35]
ds_read_b64_tr_b16 a[160:161], v11 offset:0
v_mfma_f32_16x16x32_bf16 a[48:51], a[180:183], a[112:115], a[48:51]
ds_read_b64_tr_b16 a[162:163], v11 offset:1024
v_mfma_f32_16x16x32_bf16 a[52:55], a[180:183], a[116:119], a[52:55]
buffer_load_dwordx4 a[152:155], v2, s[16:19], s42 offen offset:3072 sc1
v_mfma_f32_16x16x32_bf16 a[36:39], a[176:179], a[116:119], a[36:39]
v_mfma_f32_16x16x32_bf16 a[40:43], a[176:179], a[120:123], a[40:43]
ds_read_b64_tr_b16 a[164:165], v12 offset:0
v_mfma_f32_16x16x32_bf16 a[56:59], a[180:183], a[120:123], a[56:59]
ds_read_b64_tr_b16 a[166:167], v12 offset:1024
v_mfma_f32_16x16x32_bf16 a[60:63], a[180:183], a[124:127], a[60:63]
v_mfma_f32_16x16x32_bf16 a[44:47], a[176:179], a[124:127], a[44:47]
s_waitcnt lgkmcnt(4)
v_mfma_f32_16x16x32_bf16 a[76:79], a[124:127], a[184:187], a[76:79]
ds_read_b64_tr_b16 a[168:169], v13 offset:12288
v_mfma_f32_16x16x32_bf16 a[92:95], a[124:127], a[188:191], a[92:95]
ds_read_b64_tr_b16 a[170:171], v13 offset:15872
v_mfma_f32_16x16x32_bf16 a[88:91], a[120:123], a[188:191], a[88:91]
buffer_load_dwordx4 a[156:159], v2, s[16:19], s43 offen offset:3072 sc1
v_mfma_f32_16x16x32_bf16 a[72:75], a[120:123], a[184:187], a[72:75]
v_mfma_f32_16x16x32_bf16 a[68:71], a[116:119], a[184:187], a[68:71]
ds_read_b64_tr_b16 a[172:173], v13 offset:12320
v_mfma_f32_16x16x32_bf16 a[84:87], a[116:119], a[188:191], a[84:87]
ds_read_b64_tr_b16 a[174:175], v13 offset:15904
v_mfma_f32_16x16x32_bf16 a[80:83], a[112:115], a[188:191], a[80:83]
v_mfma_f32_16x16x32_bf16 a[64:67], a[112:115], a[184:187], a[64:67]
s_waitcnt lgkmcnt(4)
v_mfma_f32_16x16x32_bf16 a[0:3], a[160:163], a[96:99], a[0:3]
ds_read_b64_tr_b16 a[176:177], v13 offset:12352
v_mfma_f32_16x16x32_bf16 a[16:19], a[164:167], a[96:99], a[16:19]
ds_read_b64_tr_b16 a[178:179], v13 offset:15936
v_mfma_f32_16x16x32_bf16 a[20:23], a[164:167], a[100:103], a[20:23]
v_mfma_f32_16x16x32_bf16 a[4:7], a[160:163], a[100:103], a[4:7]
v_mfma_f32_16x16x32_bf16 a[8:11], a[160:163], a[104:107], a[8:11]
ds_read_b64_tr_b16 a[180:181], v13 offset:12384
v_mfma_f32_16x16x32_bf16 a[24:27], a[164:167], a[104:107], a[24:27]
ds_read_b64_tr_b16 a[182:183], v13 offset:15968
v_mfma_f32_16x16x32_bf16 a[28:31], a[164:167], a[108:111], a[28:31]
v_mfma_f32_16x16x32_bf16 a[12:15], a[160:163], a[108:111], a[12:15]
s_waitcnt lgkmcnt(4)
v_mfma_f32_16x16x32_bf16 v[44:47], a[168:171], a[108:111], v[44:47]
ds_read_b64_tr_b16 a[184:185], v13 offset:12416
s_add_u32 s20, s66, 4194304
s_addc_u32 s21, s67, 0
v_mfma_f32_16x16x32_bf16 v[60:63], a[172:175], a[108:111], v[60:63]
ds_read_b64_tr_b16 a[186:187], v13 offset:16000
s_and_b32 s21, s21, 0xffff
v_mfma_f32_16x16x32_bf16 v[56:59], a[172:175], a[104:107], v[56:59]
s_mov_b32 s22, 18874368
s_mov_b32 s23, 0x20000
v_mfma_f32_16x16x32_bf16 v[40:43], a[168:171], a[104:107], v[40:43]
s_lshl_b32 s7, s69, 15
v_mfma_f32_16x16x32_bf16 v[36:39], a[168:171], a[100:103], v[36:39]
ds_read_b64_tr_b16 a[188:189], v13 offset:12448
s_add_u32 s24, s66, 25165824
s_addc_u32 s25, s67, 0
v_mfma_f32_16x16x32_bf16 v[52:55], a[172:175], a[100:103], v[52:55]
ds_read_b64_tr_b16 a[190:191], v13 offset:16032
s_add_u32 s24, s24, s7
s_addc_u32 s25, s25, 0
v_mfma_f32_16x16x32_bf16 v[48:51], a[172:175], a[96:99], v[48:51]
s_and_b32 s25, s25, 0xffff
s_mov_b32 s26, 0x8000
v_mfma_f32_16x16x32_bf16 v[32:35], a[168:171], a[96:99], v[32:35]
s_mov_b32 s27, 0x20000
s_waitcnt lgkmcnt(4)
v_mfma_f32_16x16x32_bf16 v[64:67], a[176:179], a[96:99], v[64:67]
ds_read_b64_tr_b16 a[160:161], v13 offset:12480
s_lshl_b32 s6, s3, 12
v_mfma_f32_16x16x32_bf16 v[80:83], a[180:183], a[96:99], v[80:83]
ds_read_b64_tr_b16 a[162:163], v13 offset:16064
v_add_u32 v3, s6, v2
v_mfma_f32_16x16x32_bf16 v[84:87], a[180:183], a[100:103], v[84:87]
s_movk_i32 s71, 0x4000
v_mfma_f32_16x16x32_bf16 v[68:71], a[176:179], a[100:103], v[68:71]
v_mfma_f32_16x16x32_bf16 v[72:75], a[176:179], a[104:107], v[72:75]
ds_read_b64_tr_b16 a[164:165], v13 offset:26624
v_mfma_f32_16x16x32_bf16 v[88:91], a[180:183], a[104:107], v[88:91]
ds_read_b64_tr_b16 a[166:167], v13 offset:30208
v_mfma_f32_16x16x32_bf16 v[92:95], a[180:183], a[108:111], v[92:95]
v_mfma_f32_16x16x32_bf16 v[76:79], a[176:179], a[108:111], v[76:79]
s_waitcnt lgkmcnt(4)
v_mfma_f32_16x16x32_bf16 v[108:111], a[184:187], a[108:111], v[108:111]
ds_read_b64_tr_b16 a[168:169], v13 offset:26656
v_mfma_f32_16x16x32_bf16 v[124:127], a[188:191], a[108:111], v[124:127]
ds_read_b64_tr_b16 a[170:171], v13 offset:30240
v_mfma_f32_16x16x32_bf16 v[120:123], a[188:191], a[104:107], v[120:123]
v_mfma_f32_16x16x32_bf16 v[104:107], a[184:187], a[104:107], v[104:107]
v_mfma_f32_16x16x32_bf16 v[100:103], a[184:187], a[100:103], v[100:103]
ds_read_b64_tr_b16 a[172:173], v13 offset:26688
v_mfma_f32_16x16x32_bf16 v[116:119], a[188:191], a[100:103], v[116:119]
ds_read_b64_tr_b16 a[174:175], v13 offset:30272
v_mfma_f32_16x16x32_bf16 v[112:115], a[188:191], a[96:99], v[112:115]
v_mfma_f32_16x16x32_bf16 v[96:99], a[184:187], a[96:99], v[96:99]
s_waitcnt lgkmcnt(4)
v_mfma_f32_16x16x32_bf16 v[128:131], a[160:163], a[96:99], v[128:131]
ds_read_b64_tr_b16 a[176:177], v13 offset:26720
v_mfma_f32_16x16x32_bf16 v[144:147], a[164:167], a[96:99], v[144:147]
ds_read_b64_tr_b16 a[178:179], v13 offset:30304
v_mfma_f32_16x16x32_bf16 v[148:151], a[164:167], a[100:103], v[148:151]
v_mfma_f32_16x16x32_bf16 v[132:135], a[160:163], a[100:103], v[132:135]
v_mfma_f32_16x16x32_bf16 v[136:139], a[160:163], a[104:107], v[136:139]
ds_read_b64_tr_b16 a[180:181], v13 offset:26752
v_mfma_f32_16x16x32_bf16 v[152:155], a[164:167], a[104:107], v[152:155]
ds_read_b64_tr_b16 a[182:183], v13 offset:30336
v_mfma_f32_16x16x32_bf16 v[156:159], a[164:167], a[108:111], v[156:159]
v_mfma_f32_16x16x32_bf16 v[140:143], a[160:163], a[108:111], v[140:143]
s_waitcnt lgkmcnt(4)
v_mfma_f32_16x16x32_bf16 v[172:175], a[168:171], a[108:111], v[172:175]
ds_read_b64_tr_b16 a[184:185], v13 offset:26784
v_mfma_f32_16x16x32_bf16 v[188:191], a[172:175], a[108:111], v[188:191]
ds_read_b64_tr_b16 a[186:187], v13 offset:30368
v_mfma_f32_16x16x32_bf16 v[184:187], a[172:175], a[104:107], v[184:187]
buffer_load_dword v30, v15, s[72:75], s76 offen
s_add_u32 s76, s76, s77
v_mfma_f32_16x16x32_bf16 v[168:171], a[168:171], a[104:107], v[168:171]
v_mfma_f32_16x16x32_bf16 v[164:167], a[168:171], a[100:103], v[164:167]
ds_read_b64_tr_b16 a[188:189], v13 offset:26816
v_mfma_f32_16x16x32_bf16 v[180:183], a[172:175], a[100:103], v[180:183]
ds_read_b64_tr_b16 a[190:191], v13 offset:30400
v_mfma_f32_16x16x32_bf16 v[176:179], a[172:175], a[96:99], v[176:179]
v_mfma_f32_16x16x32_bf16 v[160:163], a[168:171], a[96:99], v[160:163]
s_waitcnt lgkmcnt(4)
v_mfma_f32_16x16x32_bf16 v[192:195], a[176:179], a[96:99], v[192:195]
s_waitcnt vmcnt(17)
s_barrier
ds_read_b64_tr_b16 a[160:161], v11 offset:45056
v_mfma_f32_16x16x32_bf16 v[208:211], a[180:183], a[96:99], v[208:211]
ds_read_b64_tr_b16 a[162:163], v11 offset:46080
v_mfma_f32_16x16x32_bf16 v[212:215], a[180:183], a[100:103], v[212:215]
v_mfma_f32_16x16x32_bf16 v[196:199], a[176:179], a[100:103], v[196:199]
v_mfma_f32_16x16x32_bf16 v[200:203], a[176:179], a[104:107], v[200:203]
ds_read_b64_tr_b16 a[164:165], v12 offset:45056
v_mfma_f32_16x16x32_bf16 v[216:219], a[180:183], a[104:107], v[216:219]
ds_read_b64_tr_b16 a[166:167], v12 offset:46080
v_mfma_f32_16x16x32_bf16 v[220:223], a[180:183], a[108:111], v[220:223]
v_mfma_f32_16x16x32_bf16 v[204:207], a[176:179], a[108:111], v[204:207]
s_waitcnt lgkmcnt(4)
v_mfma_f32_16x16x32_bf16 v[236:239], a[184:187], a[108:111], v[236:239]
ds_read_b64_tr_b16 a[168:169], v11 offset:49152
v_mfma_f32_16x16x32_bf16 v[252:255], a[188:191], a[108:111], v[252:255]
ds_read_b64_tr_b16 a[170:171], v11 offset:50176
v_mfma_f32_16x16x32_bf16 v[248:251], a[188:191], a[104:107], v[248:251]
v_mfma_f32_16x16x32_bf16 v[232:235], a[184:187], a[104:107], v[232:235]
v_mfma_f32_16x16x32_bf16 v[228:231], a[184:187], a[100:103], v[228:231]
ds_read_b64_tr_b16 a[172:173], v12 offset:49152
v_mfma_f32_16x16x32_bf16 v[244:247], a[188:191], a[100:103], v[244:247]
ds_read_b64_tr_b16 a[174:175], v12 offset:50176
v_mfma_f32_16x16x32_bf16 v[240:243], a[188:191], a[96:99], v[240:243]
v_mfma_f32_16x16x32_bf16 v[224:227], a[184:187], a[96:99], v[224:227]
s_waitcnt vmcnt(10) lgkmcnt(4)
v_mfma_f32_16x16x32_bf16 a[32:35], a[160:163], a[128:131], a[32:35]
ds_read_b64_tr_b16 a[176:177], v11 offset:47104
v_mfma_f32_16x16x32_bf16 a[48:51], a[164:167], a[128:131], a[48:51]
ds_read_b64_tr_b16 a[178:179], v11 offset:48128
v_mfma_f32_16x16x32_bf16 a[52:55], a[164:167], a[132:135], a[52:55]
v_mfma_f32_16x16x32_bf16 a[36:39], a[160:163], a[132:135], a[36:39]
v_mfma_f32_16x16x32_bf16 a[40:43], a[160:163], a[136:139], a[40:43]
ds_read_b64_tr_b16 a[180:181], v12 offset:47104
v_mfma_f32_16x16x32_bf16 a[56:59], a[164:167], a[136:139], a[56:59]
ds_read_b64_tr_b16 a[182:183], v12 offset:48128
v_mfma_f32_16x16x32_bf16 a[60:63], a[164:167], a[140:143], a[60:63]
v_mfma_f32_16x16x32_bf16 a[44:47], a[160:163], a[140:143], a[44:47]
s_waitcnt lgkmcnt(4)
v_mfma_f32_16x16x32_bf16 a[76:79], a[140:143], a[168:171], a[76:79]
ds_read_b64_tr_b16 a[184:185], v11 offset:51200
v_mfma_f32_16x16x32_bf16 a[92:95], a[140:143], a[172:175], a[92:95]
ds_read_b64_tr_b16 a[186:187], v11 offset:52224
v_mfma_f32_16x16x32_bf16 a[88:91], a[136:139], a[172:175], a[88:91]
v_mfma_f32_16x16x32_bf16 a[72:75], a[136:139], a[168:171], a[72:75]
v_mfma_f32_16x16x32_bf16 a[68:71], a[132:135], a[168:171], a[68:71]
ds_read_b64_tr_b16 a[188:189], v12 offset:51200
v_mfma_f32_16x16x32_bf16 a[84:87], a[132:135], a[172:175], a[84:87]
ds_read_b64_tr_b16 a[190:191], v12 offset:52224
v_mfma_f32_16x16x32_bf16 a[80:83], a[128:131], a[172:175], a[80:83]
v_mfma_f32_16x16x32_bf16 a[64:67], a[128:131], a[168:171], a[64:67]
s_waitcnt vmcnt(1) lgkmcnt(4)
v_mfma_f32_16x16x32_bf16 a[32:35], a[176:179], a[144:147], a[32:35]
ds_read_b64_tr_b16 a[160:161], v11 offset:2048
v_mfma_f32_16x16x32_bf16 a[48:51], a[180:183], a[144:147], a[48:51]
ds_read_b64_tr_b16 a[162:163], v11 offset:3072
v_mfma_f32_16x16x32_bf16 a[52:55], a[180:183], a[148:151], a[52:55]
v_mfma_f32_16x16x32_bf16 a[36:39], a[176:179], a[148:151], a[36:39]
v_mfma_f32_16x16x32_bf16 a[40:43], a[176:179], a[152:155], a[40:43]
ds_read_b64_tr_b16 a[164:165], v12 offset:2048
v_mfma_f32_16x16x32_bf16 a[56:59], a[180:183], a[152:155], a[56:59]
ds_read_b64_tr_b16 a[166:167], v12 offset:3072
v_mfma_f32_16x16x32_bf16 a[60:63], a[180:183], a[156:159], a[60:63]
v_mfma_f32_16x16x32_bf16 a[44:47], a[176:179], a[156:159], a[44:47]
s_waitcnt lgkmcnt(4)
v_mfma_f32_16x16x32_bf16 a[76:79], a[156:159], a[184:187], a[76:79]
ds_read_b64_tr_b16 a[168:169], v13 offset:19456
v_mfma_f32_16x16x32_bf16 a[92:95], a[156:159], a[188:191], a[92:95]
ds_read_b64_tr_b16 a[170:171], v13 offset:23040
v_mfma_f32_16x16x32_bf16 a[88:91], a[152:155], a[188:191], a[88:91]
v_mfma_f32_16x16x32_bf16 a[72:75], a[152:155], a[184:187], a[72:75]
v_mfma_f32_16x16x32_bf16 a[68:71], a[148:151], a[184:187], a[68:71]
ds_read_b64_tr_b16 a[172:173], v13 offset:19488
v_mfma_f32_16x16x32_bf16 a[84:87], a[148:151], a[188:191], a[84:87]
ds_read_b64_tr_b16 a[174:175], v13 offset:23072
v_mfma_f32_16x16x32_bf16 a[80:83], a[144:147], a[188:191], a[80:83]
v_mfma_f32_16x16x32_bf16 a[64:67], a[144:147], a[184:187], a[64:67]
s_waitcnt lgkmcnt(4)
v_mfma_f32_16x16x32_bf16 a[0:3], a[160:163], a[112:115], a[0:3]
ds_read_b64_tr_b16 a[176:177], v13 offset:19520
v_mfma_f32_16x16x32_bf16 a[16:19], a[164:167], a[112:115], a[16:19]
ds_read_b64_tr_b16 a[178:179], v13 offset:23104
v_mfma_f32_16x16x32_bf16 a[20:23], a[164:167], a[116:119], a[20:23]
v_mfma_f32_16x16x32_bf16 a[4:7], a[160:163], a[116:119], a[4:7]
v_mfma_f32_16x16x32_bf16 a[8:11], a[160:163], a[120:123], a[8:11]
ds_read_b64_tr_b16 a[180:181], v13 offset:19552
v_mfma_f32_16x16x32_bf16 a[24:27], a[164:167], a[120:123], a[24:27]
ds_read_b64_tr_b16 a[182:183], v13 offset:23136
v_mfma_f32_16x16x32_bf16 a[28:31], a[164:167], a[124:127], a[28:31]
v_mfma_f32_16x16x32_bf16 a[12:15], a[160:163], a[124:127], a[12:15]
s_waitcnt lgkmcnt(4)
v_mfma_f32_16x16x32_bf16 v[44:47], a[168:171], a[124:127], v[44:47]
ds_read_b64_tr_b16 a[184:185], v13 offset:19584
v_accvgpr_read_b32 v16, a32
v_mfma_f32_16x16x32_bf16 v[60:63], a[172:175], a[124:127], v[60:63]
ds_read_b64_tr_b16 a[186:187], v13 offset:23168
v_accvgpr_read_b32 v17, a33
v_mfma_f32_16x16x32_bf16 v[56:59], a[172:175], a[120:123], v[56:59]
v_accvgpr_read_b32 v18, a34
v_accvgpr_read_b32 v19, a35
v_mfma_f32_16x16x32_bf16 v[40:43], a[168:171], a[120:123], v[40:43]
v_accvgpr_read_b32 v20, a48
v_mfma_f32_16x16x32_bf16 v[36:39], a[168:171], a[116:119], v[36:39]
ds_read_b64_tr_b16 a[188:189], v13 offset:19616
v_accvgpr_read_b32 v21, a49
v_mfma_f32_16x16x32_bf16 v[52:55], a[172:175], a[116:119], v[52:55]
ds_read_b64_tr_b16 a[190:191], v13 offset:23200
v_accvgpr_read_b32 v22, a50
v_mfma_f32_16x16x32_bf16 v[48:51], a[172:175], a[112:115], v[48:51]
v_accvgpr_read_b32 v23, a51
v_cvt_pk_bf16_f32 v4, v16, v17
v_mfma_f32_16x16x32_bf16 v[32:35], a[168:171], a[112:115], v[32:35]
v_cvt_pk_bf16_f32 v5, v18, v19
s_waitcnt lgkmcnt(4)
v_mfma_f32_16x16x32_bf16 v[64:67], a[176:179], a[112:115], v[64:67]
ds_read_b64_tr_b16 a[160:161], v13 offset:19648
v_cvt_pk_bf16_f32 v6, v20, v21
v_mfma_f32_16x16x32_bf16 v[80:83], a[180:183], a[112:115], v[80:83]
ds_read_b64_tr_b16 a[162:163], v13 offset:23232
v_cvt_pk_bf16_f32 v7, v22, v23
v_mfma_f32_16x16x32_bf16 v[84:87], a[180:183], a[116:119], v[84:87]
buffer_store_dwordx4 v[4:7], v3, s[24:27], 0 offen offset:0 sc1
ds_write_b128 v3, v[4:7] offset:16384
v_mfma_f32_16x16x32_bf16 v[68:71], a[176:179], a[116:119], v[68:71]
v_accvgpr_read_b32 v16, a36
v_mfma_f32_16x16x32_bf16 v[72:75], a[176:179], a[120:123], v[72:75]
ds_read_b64_tr_b16 a[164:165], v13 offset:33792
v_accvgpr_read_b32 v17, a37
v_mfma_f32_16x16x32_bf16 v[88:91], a[180:183], a[120:123], v[88:91]
ds_read_b64_tr_b16 a[166:167], v13 offset:37376
v_accvgpr_read_b32 v18, a38
v_mfma_f32_16x16x32_bf16 v[92:95], a[180:183], a[124:127], v[92:95]
v_accvgpr_read_b32 v19, a39
v_accvgpr_read_b32 v20, a52
v_mfma_f32_16x16x32_bf16 v[76:79], a[176:179], a[124:127], v[76:79]
v_accvgpr_read_b32 v21, a53
s_waitcnt lgkmcnt(5)
v_mfma_f32_16x16x32_bf16 v[108:111], a[184:187], a[124:127], v[108:111]
ds_read_b64_tr_b16 a[168:169], v13 offset:33824
v_accvgpr_read_b32 v22, a54
v_mfma_f32_16x16x32_bf16 v[124:127], a[188:191], a[124:127], v[124:127]
ds_read_b64_tr_b16 a[170:171], v13 offset:37408
v_accvgpr_read_b32 v23, a55
v_mfma_f32_16x16x32_bf16 v[120:123], a[188:191], a[120:123], v[120:123]
v_cvt_pk_bf16_f32 v24, v16, v17
v_cvt_pk_bf16_f32 v25, v18, v19
v_mfma_f32_16x16x32_bf16 v[104:107], a[184:187], a[120:123], v[104:107]
v_cvt_pk_bf16_f32 v26, v20, v21
v_mfma_f32_16x16x32_bf16 v[100:103], a[184:187], a[116:119], v[100:103]
ds_read_b64_tr_b16 a[172:173], v13 offset:33856
v_cvt_pk_bf16_f32 v27, v22, v23
v_mfma_f32_16x16x32_bf16 v[116:119], a[188:191], a[116:119], v[116:119]
ds_read_b64_tr_b16 a[174:175], v13 offset:37440
buffer_store_dwordx4 v[24:27], v3, s[24:27], 0 offen offset:1024 sc1
v_mfma_f32_16x16x32_bf16 v[112:115], a[188:191], a[112:115], v[112:115]
ds_write_b128 v3, v[24:27] offset:17408
v_accvgpr_read_b32 v16, a40
v_mfma_f32_16x16x32_bf16 v[96:99], a[184:187], a[112:115], v[96:99]
v_accvgpr_read_b32 v17, a41
s_waitcnt lgkmcnt(5)
v_mfma_f32_16x16x32_bf16 v[128:131], a[160:163], a[112:115], v[128:131]
ds_read_b64_tr_b16 a[176:177], v13 offset:33888
v_accvgpr_read_b32 v18, a42
v_mfma_f32_16x16x32_bf16 v[144:147], a[164:167], a[112:115], v[144:147]
ds_read_b64_tr_b16 a[178:179], v13 offset:37472
v_accvgpr_read_b32 v19, a43
v_mfma_f32_16x16x32_bf16 v[148:151], a[164:167], a[116:119], v[148:151]
v_accvgpr_read_b32 v20, a56
v_accvgpr_read_b32 v21, a57
v_mfma_f32_16x16x32_bf16 v[132:135], a[160:163], a[116:119], v[132:135]
v_accvgpr_read_b32 v22, a58
v_mfma_f32_16x16x32_bf16 v[136:139], a[160:163], a[120:123], v[136:139]
ds_read_b64_tr_b16 a[180:181], v13 offset:33920
v_accvgpr_read_b32 v23, a59
v_mfma_f32_16x16x32_bf16 v[152:155], a[164:167], a[120:123], v[152:155]
ds_read_b64_tr_b16 a[182:183], v13 offset:37504
v_cvt_pk_bf16_f32 v4, v16, v17
v_mfma_f32_16x16x32_bf16 v[156:159], a[164:167], a[124:127], v[156:159]
v_cvt_pk_bf16_f32 v5, v18, v19
v_cvt_pk_bf16_f32 v6, v20, v21
v_mfma_f32_16x16x32_bf16 v[140:143], a[160:163], a[124:127], v[140:143]
v_cvt_pk_bf16_f32 v7, v22, v23
s_waitcnt lgkmcnt(5)
v_mfma_f32_16x16x32_bf16 v[172:175], a[168:171], a[124:127], v[172:175]
ds_read_b64_tr_b16 a[184:185], v13 offset:33952
buffer_store_dwordx4 v[4:7], v3, s[24:27], 0 offen offset:2048 sc1
v_mfma_f32_16x16x32_bf16 v[188:191], a[172:175], a[124:127], v[188:191]
ds_read_b64_tr_b16 a[186:187], v13 offset:37536
ds_write_b128 v3, v[4:7] offset:18432
v_mfma_f32_16x16x32_bf16 v[184:187], a[172:175], a[120:123], v[184:187]
v_accvgpr_read_b32 v16, a44
v_accvgpr_read_b32 v17, a45
v_mfma_f32_16x16x32_bf16 v[168:171], a[168:171], a[120:123], v[168:171]
v_accvgpr_read_b32 v18, a46
v_mfma_f32_16x16x32_bf16 v[164:167], a[168:171], a[116:119], v[164:167]
ds_read_b64_tr_b16 a[188:189], v13 offset:33984
v_accvgpr_read_b32 v19, a47
v_mfma_f32_16x16x32_bf16 v[180:183], a[172:175], a[116:119], v[180:183]
ds_read_b64_tr_b16 a[190:191], v13 offset:37568
v_accvgpr_read_b32 v20, a60
v_mfma_f32_16x16x32_bf16 v[176:179], a[172:175], a[112:115], v[176:179]
v_accvgpr_read_b32 v21, a61
v_accvgpr_read_b32 v22, a62
v_mfma_f32_16x16x32_bf16 v[160:163], a[168:171], a[112:115], v[160:163]
v_accvgpr_read_b32 v23, a63
v_add_u32 v13, 40960, v13
s_waitcnt lgkmcnt(5)
v_mfma_f32_16x16x32_bf16 v[192:195], a[176:179], a[112:115], v[192:195]
s_waitcnt vmcnt(8)
s_barrier
ds_read_b64_tr_b16 a[160:161], v11 offset:40960
v_cvt_pk_bf16_f32 v24, v16, v17
v_mfma_f32_16x16x32_bf16 v[208:211], a[180:183], a[112:115], v[208:211]
ds_read_b64_tr_b16 a[162:163], v11 offset:41984
v_cvt_pk_bf16_f32 v25, v18, v19
v_mfma_f32_16x16x32_bf16 v[212:215], a[180:183], a[116:119], v[212:215]
v_cvt_pk_bf16_f32 v26, v20, v21
v_cvt_pk_bf16_f32 v27, v22, v23
v_mfma_f32_16x16x32_bf16 v[196:199], a[176:179], a[116:119], v[196:199]
buffer_store_dwordx4 v[24:27], v3, s[24:27], 0 offen offset:3072 sc1
v_mfma_f32_16x16x32_bf16 v[200:203], a[176:179], a[120:123], v[200:203]
ds_read_b64_tr_b16 a[164:165], v12 offset:40960
ds_write_b128 v3, v[24:27] offset:19456
v_mfma_f32_16x16x32_bf16 v[216:219], a[180:183], a[120:123], v[216:219]
ds_read_b64_tr_b16 a[166:167], v12 offset:41984
v_accvgpr_read_b32 v16, a64
v_mfma_f32_16x16x32_bf16 v[220:223], a[180:183], a[124:127], v[220:223]
v_accvgpr_read_b32 v17, a65
v_accvgpr_read_b32 v18, a66
v_mfma_f32_16x16x32_bf16 v[204:207], a[176:179], a[124:127], v[204:207]
v_accvgpr_read_b32 v19, a67
s_waitcnt lgkmcnt(5)
v_mfma_f32_16x16x32_bf16 v[236:239], a[184:187], a[124:127], v[236:239]
ds_read_b64_tr_b16 a[168:169], v13 offset:12288
v_accvgpr_read_b32 v20, a68
v_mfma_f32_16x16x32_bf16 v[252:255], a[188:191], a[124:127], v[252:255]
ds_read_b64_tr_b16 a[170:171], v13 offset:15872
v_accvgpr_read_b32 v21, a69
v_mfma_f32_16x16x32_bf16 v[248:251], a[188:191], a[120:123], v[248:251]
v_accvgpr_read_b32 v22, a70
v_accvgpr_read_b32 v23, a71
v_mfma_f32_16x16x32_bf16 v[232:235], a[184:187], a[120:123], v[232:235]
v_cvt_pk_bf16_f32 v4, v16, v17
v_mfma_f32_16x16x32_bf16 v[228:231], a[184:187], a[116:119], v[228:231]
ds_read_b64_tr_b16 a[172:173], v13 offset:12320
v_cvt_pk_bf16_f32 v5, v18, v19
v_mfma_f32_16x16x32_bf16 v[244:247], a[188:191], a[116:119], v[244:247]
ds_read_b64_tr_b16 a[174:175], v13 offset:15904
v_cvt_pk_bf16_f32 v6, v20, v21
v_mfma_f32_16x16x32_bf16 v[240:243], a[188:191], a[112:115], v[240:243]
v_cvt_pk_bf16_f32 v7, v22, v23
buffer_store_dwordx4 v[4:7], v3, s[24:27], s71 offen offset:0 sc1
v_mfma_f32_16x16x32_bf16 v[224:227], a[184:187], a[112:115], v[224:227]
ds_write_b128 v3, v[4:7] offset:49152
s_waitcnt lgkmcnt(5)
v_mfma_f32_16x16x32_bf16 a[0:3], a[160:163], a[128:131], a[0:3]
ds_read_b64_tr_b16 a[176:177], v13 offset:12352
v_accvgpr_read_b32 v16, a80
v_mfma_f32_16x16x32_bf16 a[16:19], a[164:167], a[128:131], a[16:19]
ds_read_b64_tr_b16 a[178:179], v13 offset:15936
v_accvgpr_read_b32 v17, a81
v_mfma_f32_16x16x32_bf16 a[20:23], a[164:167], a[132:135], a[20:23]
v_accvgpr_read_b32 v18, a82
v_accvgpr_read_b32 v19, a83
v_mfma_f32_16x16x32_bf16 a[4:7], a[160:163], a[132:135], a[4:7]
v_accvgpr_read_b32 v20, a84
v_mfma_f32_16x16x32_bf16 a[8:11], a[160:163], a[136:139], a[8:11]
ds_read_b64_tr_b16 a[180:181], v13 offset:12384
v_accvgpr_read_b32 v21, a85
v_mfma_f32_16x16x32_bf16 a[24:27], a[164:167], a[136:139], a[24:27]
ds_read_b64_tr_b16 a[182:183], v13 offset:15968
v_accvgpr_read_b32 v22, a86
v_mfma_f32_16x16x32_bf16 a[28:31], a[164:167], a[140:143], a[28:31]
v_accvgpr_read_b32 v23, a87
v_cvt_pk_bf16_f32 v24, v16, v17
v_mfma_f32_16x16x32_bf16 a[12:15], a[160:163], a[140:143], a[12:15]
v_cvt_pk_bf16_f32 v25, v18, v19
s_waitcnt lgkmcnt(5)
v_mfma_f32_16x16x32_bf16 v[44:47], a[168:171], a[140:143], v[44:47]
ds_read_b64_tr_b16 a[184:185], v13 offset:12416
v_cvt_pk_bf16_f32 v26, v20, v21
v_mfma_f32_16x16x32_bf16 v[60:63], a[172:175], a[140:143], v[60:63]
ds_read_b64_tr_b16 a[186:187], v13 offset:16000
v_cvt_pk_bf16_f32 v27, v22, v23
v_mfma_f32_16x16x32_bf16 v[56:59], a[172:175], a[136:139], v[56:59]
buffer_store_dwordx4 v[24:27], v3, s[24:27], s71 offen offset:1024 sc1
ds_write_b128 v3, v[24:27] offset:50176
v_mfma_f32_16x16x32_bf16 v[40:43], a[168:171], a[136:139], v[40:43]
v_accvgpr_read_b32 v16, a72
v_mfma_f32_16x16x32_bf16 v[36:39], a[168:171], a[132:135], v[36:39]
ds_read_b64_tr_b16 a[188:189], v13 offset:12448
v_accvgpr_read_b32 v17, a73
v_mfma_f32_16x16x32_bf16 v[52:55], a[172:175], a[132:135], v[52:55]
ds_read_b64_tr_b16 a[190:191], v13 offset:16032
v_accvgpr_read_b32 v18, a74
v_mfma_f32_16x16x32_bf16 v[48:51], a[172:175], a[128:131], v[48:51]
v_accvgpr_read_b32 v19, a75
v_accvgpr_read_b32 v20, a76
v_mfma_f32_16x16x32_bf16 v[32:35], a[168:171], a[128:131], v[32:35]
v_accvgpr_read_b32 v21, a77
s_waitcnt lgkmcnt(5)
v_mfma_f32_16x16x32_bf16 v[64:67], a[176:179], a[128:131], v[64:67]
ds_read_b64_tr_b16 a[160:161], v13 offset:12480
v_accvgpr_read_b32 v22, a78
v_mfma_f32_16x16x32_bf16 v[80:83], a[180:183], a[128:131], v[80:83]
ds_read_b64_tr_b16 a[162:163], v13 offset:16064
v_accvgpr_read_b32 v23, a79
v_mfma_f32_16x16x32_bf16 v[84:87], a[180:183], a[132:135], v[84:87]
v_cvt_pk_bf16_f32 v4, v16, v17
v_cvt_pk_bf16_f32 v5, v18, v19
v_mfma_f32_16x16x32_bf16 v[68:71], a[176:179], a[132:135], v[68:71]
v_cvt_pk_bf16_f32 v6, v20, v21
v_mfma_f32_16x16x32_bf16 v[72:75], a[176:179], a[136:139], v[72:75]
ds_read_b64_tr_b16 a[164:165], v13 offset:26624
v_cvt_pk_bf16_f32 v7, v22, v23
v_mfma_f32_16x16x32_bf16 v[88:91], a[180:183], a[136:139], v[88:91]
ds_read_b64_tr_b16 a[166:167], v13 offset:30208
buffer_store_dwordx4 v[4:7], v3, s[24:27], s71 offen offset:2048 sc1
v_mfma_f32_16x16x32_bf16 v[92:95], a[180:183], a[140:143], v[92:95]
ds_write_b128 v3, v[4:7] offset:51200
v_accvgpr_read_b32 v16, a88
v_mfma_f32_16x16x32_bf16 v[76:79], a[176:179], a[140:143], v[76:79]
v_accvgpr_read_b32 v17, a89
s_waitcnt lgkmcnt(5)
v_mfma_f32_16x16x32_bf16 v[108:111], a[184:187], a[140:143], v[108:111]
ds_read_b64_tr_b16 a[168:169], v13 offset:26656
v_accvgpr_read_b32 v18, a90
v_mfma_f32_16x16x32_bf16 v[124:127], a[188:191], a[140:143], v[124:127]
ds_read_b64_tr_b16 a[170:171], v13 offset:30240
v_accvgpr_read_b32 v19, a91
v_mfma_f32_16x16x32_bf16 v[120:123], a[188:191], a[136:139], v[120:123]
v_accvgpr_read_b32 v20, a92
v_accvgpr_read_b32 v21, a93
v_mfma_f32_16x16x32_bf16 v[104:107], a[184:187], a[136:139], v[104:107]
v_accvgpr_read_b32 v22, a94
v_mfma_f32_16x16x32_bf16 v[100:103], a[184:187], a[132:135], v[100:103]
ds_read_b64_tr_b16 a[172:173], v13 offset:26688
v_accvgpr_read_b32 v23, a95
v_mfma_f32_16x16x32_bf16 v[116:119], a[188:191], a[132:135], v[116:119]
ds_read_b64_tr_b16 a[174:175], v13 offset:30272
v_cvt_pk_bf16_f32 v24, v16, v17
v_mfma_f32_16x16x32_bf16 v[112:115], a[188:191], a[128:131], v[112:115]
v_cvt_pk_bf16_f32 v25, v18, v19
v_cvt_pk_bf16_f32 v26, v20, v21
v_mfma_f32_16x16x32_bf16 v[96:99], a[184:187], a[128:131], v[96:99]
v_cvt_pk_bf16_f32 v27, v22, v23
s_waitcnt lgkmcnt(5)
v_mfma_f32_16x16x32_bf16 v[128:131], a[160:163], a[128:131], v[128:131]
ds_read_b64_tr_b16 a[176:177], v13 offset:26720
buffer_store_dwordx4 v[24:27], v3, s[24:27], s71 offen offset:3072 sc1
v_mfma_f32_16x16x32_bf16 v[144:147], a[164:167], a[128:131], v[144:147]
ds_read_b64_tr_b16 a[178:179], v13 offset:30304
ds_write_b128 v3, v[24:27] offset:52224
v_mfma_f32_16x16x32_bf16 v[148:151], a[164:167], a[132:135], v[148:151]
s_sub_u32 s28, s24, 1048576
s_subb_u32 s29, s25, 0
s_and_b32 s29, s29, 0xffff
v_mfma_f32_16x16x32_bf16 v[132:135], a[160:163], a[132:135], v[132:135]
s_cmp_eq_u32 s4, 0
s_cselect_b32 s30, 0, 0x8000
v_mfma_f32_16x16x32_bf16 v[136:139], a[160:163], a[136:139], v[136:139]
ds_read_b64_tr_b16 a[180:181], v13 offset:26752
s_mov_b32 s31, 0x20000
v_mfma_f32_16x16x32_bf16 v[152:155], a[164:167], a[136:139], v[152:155]
ds_read_b64_tr_b16 a[182:183], v13 offset:30336
s_mul_i32 s7, s47, 147456
v_mfma_f32_16x16x32_bf16 v[156:159], a[164:167], a[140:143], v[156:159]
s_lshr_b32 s8, s5, 3
s_lshl_b32 s6, s8, 13
v_mfma_f32_16x16x32_bf16 v[140:143], a[160:163], a[140:143], v[140:143]
s_add_u32 s7, s7, s6
s_waitcnt lgkmcnt(5)
v_mfma_f32_16x16x32_bf16 v[172:175], a[168:171], a[140:143], v[172:175]
ds_read_b64_tr_b16 a[184:185], v13 offset:26784
s_mul_i32 s6, s5, 7
v_mfma_f32_16x16x32_bf16 v[188:191], a[172:175], a[140:143], v[188:191]
ds_read_b64_tr_b16 a[186:187], v13 offset:30368
s_add_u32 s6, s6, 1
v_mfma_f32_16x16x32_bf16 v[184:187], a[172:175], a[136:139], v[184:187]
buffer_load_dword v30, v15, s[72:75], s76 offen
s_add_u32 s76, s76, s77
s_lshr_b32 s6, s6, 1
s_lshl_b32 s6, s6, 10
v_mfma_f32_16x16x32_bf16 v[168:171], a[168:171], a[136:139], v[168:171]
s_add_u32 s36, s7, s6
v_mfma_f32_16x16x32_bf16 v[164:167], a[168:171], a[132:135], v[164:167]
ds_read_b64_tr_b16 a[188:189], v13 offset:26816
s_movk_i32 s6, 3072
v_mfma_f32_16x16x32_bf16 v[180:183], a[172:175], a[132:135], v[180:183]
ds_read_b64_tr_b16 a[190:191], v13 offset:30400
s_bitcmp1_b32 s5, 0
s_cselect_b32 s6, -512, s6
v_mfma_f32_16x16x32_bf16 v[176:179], a[172:175], a[128:131], v[176:179]
s_add_u32 s40, s36, s6
s_mul_i32 s8, s8, 28
v_mfma_f32_16x16x32_bf16 v[160:163], a[168:171], a[128:131], v[160:163]
s_and_b32 s6, s5, 7
s_waitcnt lgkmcnt(4)
v_mfma_f32_16x16x32_bf16 v[192:195], a[176:179], a[128:131], v[192:195]
ds_read_b64_tr_b16 a[160:161], v11 offset:43008
s_add_u32 s6, s6, s8
v_mfma_f32_16x16x32_bf16 v[208:211], a[180:183], a[128:131], v[208:211]
ds_read_b64_tr_b16 a[162:163], v11 offset:44032
s_add_u32 s6, s6, 28
v_mfma_f32_16x16x32_bf16 v[212:215], a[180:183], a[132:135], v[212:215]
s_lshl_b32 s6, s6, 10
s_add_u32 s8, s7, s6
v_mfma_f32_16x16x32_bf16 v[196:199], a[176:179], a[132:135], v[196:199]
s_add_u32 s37, s36, 147456
v_mfma_f32_16x16x32_bf16 v[200:203], a[176:179], a[136:139], v[200:203]
ds_read_b64_tr_b16 a[164:165], v12 offset:43008
s_add_u32 s41, s40, 147456
v_mfma_f32_16x16x32_bf16 v[216:219], a[180:183], a[136:139], v[216:219]
ds_read_b64_tr_b16 a[166:167], v12 offset:44032
s_add_u32 s9, s8, 147456
v_mfma_f32_16x16x32_bf16 v[220:223], a[180:183], a[140:143], v[220:223]
s_add_u32 s38, s37, 147456
s_add_u32 s42, s41, 147456
v_mfma_f32_16x16x32_bf16 v[204:207], a[176:179], a[140:143], v[204:207]
s_add_u32 s10, s9, 147456
s_waitcnt lgkmcnt(4)
v_mfma_f32_16x16x32_bf16 v[236:239], a[184:187], a[140:143], v[236:239]
ds_read_b64_tr_b16 a[168:169], v13 offset:19456
s_add_u32 s39, s38, 147456
v_mfma_f32_16x16x32_bf16 v[252:255], a[188:191], a[140:143], v[252:255]
ds_read_b64_tr_b16 a[170:171], v13 offset:23040
s_add_u32 s43, s42, 147456
v_mfma_f32_16x16x32_bf16 v[248:251], a[188:191], a[136:139], v[248:251]
s_add_u32 s11, s10, 147456
s_sub_u32 s44, s70, 4080
v_mfma_f32_16x16x32_bf16 v[232:235], a[184:187], a[136:139], v[232:235]
s_max_i32 s44, s44, 0
v_mfma_f32_16x16x32_bf16 v[228:231], a[184:187], a[132:135], v[228:231]
ds_read_b64_tr_b16 a[172:173], v13 offset:19488
v_mfma_f32_16x16x32_bf16 v[244:247], a[188:191], a[132:135], v[244:247]
ds_read_b64_tr_b16 a[174:175], v13 offset:23072
v_mfma_f32_16x16x32_bf16 v[240:243], a[188:191], a[128:131], v[240:243]
v_mfma_f32_16x16x32_bf16 v[224:227], a[184:187], a[128:131], v[224:227]
s_waitcnt lgkmcnt(4)
v_mfma_f32_16x16x32_bf16 a[0:3], a[160:163], a[144:147], a[0:3]
ds_read_b64_tr_b16 a[176:177], v13 offset:19520
v_mfma_f32_16x16x32_bf16 a[16:19], a[164:167], a[144:147], a[16:19]
ds_read_b64_tr_b16 a[178:179], v13 offset:23104
v_mfma_f32_16x16x32_bf16 a[20:23], a[164:167], a[148:151], a[20:23]
v_mfma_f32_16x16x32_bf16 a[4:7], a[160:163], a[148:151], a[4:7]
v_mfma_f32_16x16x32_bf16 a[8:11], a[160:163], a[152:155], a[8:11]
ds_read_b64_tr_b16 a[180:181], v13 offset:19552
v_mfma_f32_16x16x32_bf16 a[24:27], a[164:167], a[152:155], a[24:27]
ds_read_b64_tr_b16 a[182:183], v13 offset:23136
v_mfma_f32_16x16x32_bf16 a[28:31], a[164:167], a[156:159], a[28:31]
v_mfma_f32_16x16x32_bf16 a[12:15], a[160:163], a[156:159], a[12:15]
s_waitcnt lgkmcnt(4)
v_mfma_f32_16x16x32_bf16 v[44:47], a[168:171], a[156:159], v[44:47]
ds_read_b64_tr_b16 a[184:185], v13 offset:19584
v_mfma_f32_16x16x32_bf16 v[60:63], a[172:175], a[156:159], v[60:63]
ds_read_b64_tr_b16 a[186:187], v13 offset:23168
v_mfma_f32_16x16x32_bf16 v[56:59], a[172:175], a[152:155], v[56:59]
v_mfma_f32_16x16x32_bf16 v[40:43], a[168:171], a[152:155], v[40:43]
v_mfma_f32_16x16x32_bf16 v[36:39], a[168:171], a[148:151], v[36:39]
ds_read_b64_tr_b16 a[188:189], v13 offset:19616
v_mfma_f32_16x16x32_bf16 v[52:55], a[172:175], a[148:151], v[52:55]
ds_read_b64_tr_b16 a[190:191], v13 offset:23200
v_mfma_f32_16x16x32_bf16 v[48:51], a[172:175], a[144:147], v[48:51]
v_mfma_f32_16x16x32_bf16 v[32:35], a[168:171], a[144:147], v[32:35]
s_waitcnt lgkmcnt(4)
v_mfma_f32_16x16x32_bf16 v[64:67], a[176:179], a[144:147], v[64:67]
ds_read_b64_tr_b16 a[160:161], v13 offset:19648
v_mfma_f32_16x16x32_bf16 v[80:83], a[180:183], a[144:147], v[80:83]
ds_read_b64_tr_b16 a[162:163], v13 offset:23232
v_mfma_f32_16x16x32_bf16 v[84:87], a[180:183], a[148:151], v[84:87]
v_mfma_f32_16x16x32_bf16 v[68:71], a[176:179], a[148:151], v[68:71]
v_mfma_f32_16x16x32_bf16 v[72:75], a[176:179], a[152:155], v[72:75]
ds_read_b64_tr_b16 a[164:165], v13 offset:33792
v_mfma_f32_16x16x32_bf16 v[88:91], a[180:183], a[152:155], v[88:91]
ds_read_b64_tr_b16 a[166:167], v13 offset:37376
v_mfma_f32_16x16x32_bf16 v[92:95], a[180:183], a[156:159], v[92:95]
v_mfma_f32_16x16x32_bf16 v[76:79], a[176:179], a[156:159], v[76:79]
s_waitcnt lgkmcnt(4)
v_mfma_f32_16x16x32_bf16 v[108:111], a[184:187], a[156:159], v[108:111]
ds_read_b64_tr_b16 a[168:169], v13 offset:33824
v_mfma_f32_16x16x32_bf16 v[124:127], a[188:191], a[156:159], v[124:127]
ds_read_b64_tr_b16 a[170:171], v13 offset:37408
v_mfma_f32_16x16x32_bf16 v[120:123], a[188:191], a[152:155], v[120:123]
v_mfma_f32_16x16x32_bf16 v[104:107], a[184:187], a[152:155], v[104:107]
v_mfma_f32_16x16x32_bf16 v[100:103], a[184:187], a[148:151], v[100:103]
ds_read_b64_tr_b16 a[172:173], v13 offset:33856
v_mfma_f32_16x16x32_bf16 v[116:119], a[188:191], a[148:151], v[116:119]
ds_read_b64_tr_b16 a[174:175], v13 offset:37440
v_mfma_f32_16x16x32_bf16 v[112:115], a[188:191], a[144:147], v[112:115]
v_mfma_f32_16x16x32_bf16 v[96:99], a[184:187], a[144:147], v[96:99]
s_waitcnt lgkmcnt(4)
v_mfma_f32_16x16x32_bf16 v[128:131], a[160:163], a[144:147], v[128:131]
ds_read_b64_tr_b16 a[176:177], v13 offset:33888
v_mfma_f32_16x16x32_bf16 v[144:147], a[164:167], a[144:147], v[144:147]
ds_read_b64_tr_b16 a[178:179], v13 offset:37472
v_mfma_f32_16x16x32_bf16 v[148:151], a[164:167], a[148:151], v[148:151]
v_mfma_f32_16x16x32_bf16 v[132:135], a[160:163], a[148:151], v[132:135]
v_mfma_f32_16x16x32_bf16 v[136:139], a[160:163], a[152:155], v[136:139]
ds_read_b64_tr_b16 a[180:181], v13 offset:33920
v_mfma_f32_16x16x32_bf16 v[152:155], a[164:167], a[152:155], v[152:155]
ds_read_b64_tr_b16 a[182:183], v13 offset:37504
v_mfma_f32_16x16x32_bf16 v[156:159], a[164:167], a[156:159], v[156:159]
v_mfma_f32_16x16x32_bf16 v[140:143], a[160:163], a[156:159], v[140:143]
s_waitcnt lgkmcnt(4)
v_mfma_f32_16x16x32_bf16 v[172:175], a[168:171], a[156:159], v[172:175]
ds_read_b64_tr_b16 a[184:185], v13 offset:33952
v_mfma_f32_16x16x32_bf16 v[188:191], a[172:175], a[156:159], v[188:191]
ds_read_b64_tr_b16 a[186:187], v13 offset:37536
v_mfma_f32_16x16x32_bf16 v[184:187], a[172:175], a[152:155], v[184:187]
v_mfma_f32_16x16x32_bf16 v[168:171], a[168:171], a[152:155], v[168:171]
v_mfma_f32_16x16x32_bf16 v[164:167], a[168:171], a[148:151], v[164:167]
ds_read_b64_tr_b16 a[188:189], v13 offset:33984
v_mfma_f32_16x16x32_bf16 v[180:183], a[172:175], a[148:151], v[180:183]
ds_read_b64_tr_b16 a[190:191], v13 offset:37568
v_mfma_f32_16x16x32_bf16 v[176:179], a[172:175], a[144:147], v[176:179]
v_mfma_f32_16x16x32_bf16 v[160:163], a[168:171], a[144:147], v[160:163]
s_waitcnt lgkmcnt(4)
v_mfma_f32_16x16x32_bf16 v[192:195], a[176:179], a[144:147], v[192:195]
v_mfma_f32_16x16x32_bf16 v[208:211], a[180:183], a[144:147], v[208:211]
v_mfma_f32_16x16x32_bf16 v[212:215], a[180:183], a[148:151], v[212:215]
v_mfma_f32_16x16x32_bf16 v[196:199], a[176:179], a[148:151], v[196:199]
s_waitcnt vmcnt(1)
buffer_store_dword v28, v29, s[32:35], s70 offen offset:16 sc1
v_mfma_f32_16x16x32_bf16 v[200:203], a[176:179], a[152:155], v[200:203]
v_mfma_f32_16x16x32_bf16 v[216:219], a[180:183], a[152:155], v[216:219]
v_mfma_f32_16x16x32_bf16 v[220:223], a[180:183], a[156:159], v[220:223]
v_mfma_f32_16x16x32_bf16 v[204:207], a[176:179], a[156:159], v[204:207]
s_waitcnt lgkmcnt(0)
v_mfma_f32_16x16x32_bf16 v[236:239], a[184:187], a[156:159], v[236:239]
v_mfma_f32_16x16x32_bf16 v[252:255], a[188:191], a[156:159], v[252:255]
v_mfma_f32_16x16x32_bf16 v[248:251], a[188:191], a[152:155], v[248:251]
v_mfma_f32_16x16x32_bf16 v[232:235], a[184:187], a[152:155], v[232:235]
v_mfma_f32_16x16x32_bf16 v[228:231], a[184:187], a[148:151], v[228:231]
v_mfma_f32_16x16x32_bf16 v[244:247], a[188:191], a[148:151], v[244:247]
v_mfma_f32_16x16x32_bf16 v[240:243], a[188:191], a[144:147], v[240:243]
v_mfma_f32_16x16x32_bf16 v[224:227], a[184:187], a[144:147], v[224:227]
v_mov_b32 v6, 0xbdd2d3e8
v_mov_b32 v7, 0xc0135761
v_lshlrev_b32 v9, 3, v1
v_lshlrev_b32 v18, 7, v1
s_add_u32 s6, s2, s3
s_cmp_eq_u32 s6, 0
s_cbranch_scc0 L_ep0
s_movk_i32 s7, 0
buffer_load_dwordx4 a[128:131], v18, s[32:35], s7 offen sc1
s_movk_i32 s7, 8192
buffer_load_dwordx4 a[132:135], v18, s[32:35], s7 offen sc1
s_movk_i32 s7, 16384
buffer_load_dwordx4 a[136:139], v18, s[32:35], s7 offen sc1
s_movk_i32 s7, 24576
buffer_load_dwordx4 a[140:143], v18, s[32:35], s7 offen sc1
L_ep0:
v_pk_mul_f32 v[14:15], v[32:33], v[32:33]
v_pk_mul_f32 v[16:17], v[34:35], v[34:35]
v_pk_fma_f32 v[14:15], v[14:15], v[6:7], v[6:7] op_sel:[0,0,1] op_sel_hi:[1,0,1]
v_pk_fma_f32 v[16:17], v[16:17], v[6:7], v[6:7] op_sel:[0,0,1] op_sel_hi:[1,0,1]
v_pk_mul_f32 v[14:15], v[14:15], v[32:33]
v_pk_mul_f32 v[16:17], v[16:17], v[34:35]
v_exp_f32 v14, v14
v_exp_f32 v15, v15
v_exp_f32 v16, v16
v_exp_f32_e64 v17, v17
v_pk_mul_f32 v[144:145], v[32:33], v[144:145]
v_pk_mul_f32 v[146:147], v[34:35], v[146:147]
v_pk_add_f32 v[14:15], v[14:15], 1.0 op_sel_hi:[1,0]
v_pk_add_f32 v[16:17], v[16:17], 1.0 op_sel_hi:[1,0]
v_rcp_f32 v14, v14
v_rcp_f32 v15, v15
v_rcp_f32 v16, v16
v_rcp_f32 v17, v17
v_pk_mul_f32 v[144:145], v[144:145], v[14:15]
v_pk_mul_f32 v[146:147], v[146:147], v[16:17]
v_cvt_pk_bf16_f32 v32, v144, v145
v_cvt_pk_bf16_f32 v33, v146, v147
v_pk_mul_f32 v[14:15], v[48:49], v[48:49]
v_pk_mul_f32 v[16:17], v[50:51], v[50:51]
v_pk_fma_f32 v[14:15], v[14:15], v[6:7], v[6:7] op_sel:[0,0,1] op_sel_hi:[1,0,1]
v_pk_fma_f32 v[16:17], v[16:17], v[6:7], v[6:7] op_sel:[0,0,1] op_sel_hi:[1,0,1]
v_pk_mul_f32 v[14:15], v[14:15], v[48:49]
v_pk_mul_f32 v[16:17], v[16:17], v[50:51]
v_exp_f32 v14, v14
v_exp_f32 v15, v15
v_exp_f32 v16, v16
v_exp_f32 v17, v17
v_pk_mul_f32 v[160:161], v[48:49], v[160:161]
v_pk_mul_f32 v[162:163], v[50:51], v[162:163]
v_pk_add_f32 v[14:15], v[14:15], 1.0 op_sel_hi:[1,0]
v_pk_add_f32 v[16:17], v[16:17], 1.0 op_sel_hi:[1,0]
v_rcp_f32 v14, v14
v_rcp_f32 v15, v15
v_rcp_f32 v16, v16
v_rcp_f32 v17, v17
v_pk_mul_f32 v[160:161], v[160:161], v[14:15]
v_pk_mul_f32 v[162:163], v[162:163], v[16:17]
v_cvt_pk_bf16_f32 v34, v160, v161
v_cvt_pk_bf16_f32 v35, v162, v163
v_pk_mul_f32 v[14:15], v[64:65], v[64:65]
v_pk_mul_f32 v[16:17], v[66:67], v[66:67]
v_pk_fma_f32 v[14:15], v[14:15], v[6:7], v[6:7] op_sel:[0,0,1] op_sel_hi:[1,0,1]
v_pk_fma_f32 v[16:17], v[16:17], v[6:7], v[6:7] op_sel:[0,0,1] op_sel_hi:[1,0,1]
v_pk_mul_f32 v[14:15], v[14:15], v[64:65]
v_pk_mul_f32 v[16:17], v[16:17], v[66:67]
v_exp_f32 v14, v14
v_exp_f32 v15, v15
v_exp_f32 v16, v16
v_exp_f32 v17, v17
v_pk_mul_f32 v[176:177], v[64:65], v[176:177]
v_pk_mul_f32 v[178:179], v[66:67], v[178:179]
v_pk_add_f32 v[14:15], v[14:15], 1.0 op_sel_hi:[1,0]
v_pk_add_f32 v[16:17], v[16:17], 1.0 op_sel_hi:[1,0]
v_rcp_f32 v14, v14
v_rcp_f32 v15, v15
v_rcp_f32 v16, v16
v_rcp_f32 v17, v17
v_pk_mul_f32 v[176:177], v[176:177], v[14:15]
v_pk_mul_f32 v[178:179], v[178:179], v[16:17]
v_cvt_pk_bf16_f32 v64, v176, v177
v_cvt_pk_bf16_f32 v65, v178, v179
v_pk_mul_f32 v[14:15], v[80:81], v[80:81]
v_pk_mul_f32 v[16:17], v[82:83], v[82:83]
v_pk_fma_f32 v[14:15], v[14:15], v[6:7], v[6:7] op_sel:[0,0,1] op_sel_hi:[1,0,1]
v_pk_fma_f32 v[16:17], v[16:17], v[6:7], v[6:7] op_sel:[0,0,1] op_sel_hi:[1,0,1]
v_pk_mul_f32 v[14:15], v[14:15], v[80:81]
v_pk_mul_f32 v[16:17], v[16:17], v[82:83]
v_exp_f32 v14, v14
v_exp_f32 v15, v15
v_exp_f32 v16, v16
v_exp_f32 v17, v17
v_pk_mul_f32 v[192:193], v[80:81], v[192:193]
v_pk_mul_f32 v[194:195], v[82:83], v[194:195]
v_pk_add_f32 v[14:15], v[14:15], 1.0 op_sel_hi:[1,0]
v_pk_add_f32 v[16:17], v[16:17], 1.0 op_sel_hi:[1,0]
v_rcp_f32 v14, v14
v_rcp_f32 v15, v15
v_rcp_f32 v16, v16
v_rcp_f32 v17, v17
v_pk_mul_f32 v[192:193], v[192:193], v[14:15]
v_pk_mul_f32 v[194:195], v[194:195], v[16:17]
v_cvt_pk_bf16_f32 v66, v192, v193
v_cvt_pk_bf16_f32 v67, v194, v195
buffer_load_dword v18, v31, s[32:35], s44 offen sc1
v_pk_mul_f32 v[14:15], v[96:97], v[96:97]
v_pk_mul_f32 v[16:17], v[98:99], v[98:99]
v_pk_fma_f32 v[14:15], v[14:15], v[6:7], v[6:7] op_sel:[0,0,1] op_sel_hi:[1,0,1]
v_pk_fma_f32 v[16:17], v[16:17], v[6:7], v[6:7] op_sel:[0,0,1] op_sel_hi:[1,0,1]
v_pk_mul_f32 v[14:15], v[14:15], v[96:97]
v_pk_mul_f32 v[16:17], v[16:17], v[98:99]
v_exp_f32 v14, v14
v_exp_f32 v15, v15
v_exp_f32 v16, v16
v_exp_f32 v17, v17
v_pk_mul_f32 v[208:209], v[96:97], v[208:209]
v_pk_mul_f32 v[210:211], v[98:99], v[210:211]
v_pk_add_f32 v[14:15], v[14:15], 1.0 op_sel_hi:[1,0]
v_pk_add_f32 v[16:17], v[16:17], 1.0 op_sel_hi:[1,0]
v_rcp_f32 v14, v14
v_rcp_f32 v15, v15
v_rcp_f32 v16, v16
v_rcp_f32 v17, v17
v_pk_mul_f32 v[208:209], v[208:209], v[14:15]
v_pk_mul_f32 v[210:211], v[210:211], v[16:17]
v_cvt_pk_bf16_f32 v96, v208, v209
v_cvt_pk_bf16_f32 v97, v210, v211
v_pk_mul_f32 v[14:15], v[112:113], v[112:113]
v_pk_mul_f32 v[16:17], v[114:115], v[114:115]
v_pk_fma_f32 v[14:15], v[14:15], v[6:7], v[6:7] op_sel:[0,0,1] op_sel_hi:[1,0,1]
v_pk_fma_f32 v[16:17], v[16:17], v[6:7], v[6:7] op_sel:[0,0,1] op_sel_hi:[1,0,1]
v_pk_mul_f32 v[14:15], v[14:15], v[112:113]
v_pk_mul_f32 v[16:17], v[16:17], v[114:115]
v_exp_f32 v14, v14
v_exp_f32 v15, v15
v_exp_f32 v16, v16
v_exp_f32 v17, v17
v_pk_mul_f32 v[224:225], v[112:113], v[224:225]
v_pk_mul_f32 v[226:227], v[114:115], v[226:227]
v_pk_add_f32 v[14:15], v[14:15], 1.0 op_sel_hi:[1,0]
v_pk_add_f32 v[16:17], v[16:17], 1.0 op_sel_hi:[1,0]
v_rcp_f32 v14, v14
v_rcp_f32 v15, v15
v_rcp_f32 v16, v16
v_rcp_f32 v17, v17
v_pk_mul_f32 v[224:225], v[224:225], v[14:15]
v_pk_mul_f32 v[226:227], v[226:227], v[16:17]
v_cvt_pk_bf16_f32 v98, v224, v225
v_cvt_pk_bf16_f32 v99, v226, v227
v_pk_mul_f32 v[14:15], v[128:129], v[128:129]
v_pk_mul_f32 v[16:17], v[130:131], v[130:131]
v_pk_fma_f32 v[14:15], v[14:15], v[6:7], v[6:7] op_sel:[0,0,1] op_sel_hi:[1,0,1]
v_pk_fma_f32 v[16:17], v[16:17], v[6:7], v[6:7] op_sel:[0,0,1] op_sel_hi:[1,0,1]
v_pk_mul_f32 v[14:15], v[14:15], v[128:129]
v_pk_mul_f32 v[16:17], v[16:17], v[130:131]
v_exp_f32 v14, v14
v_exp_f32 v15, v15
v_exp_f32 v16, v16
v_exp_f32 v17, v17
v_pk_mul_f32 v[240:241], v[128:129], v[240:241]
v_pk_mul_f32 v[242:243], v[130:131], v[242:243]
v_pk_add_f32 v[14:15], v[14:15], 1.0 op_sel_hi:[1,0]
v_pk_add_f32 v[16:17], v[16:17], 1.0 op_sel_hi:[1,0]
v_rcp_f32 v14, v14
v_rcp_f32 v15, v15
v_rcp_f32 v16, v16
v_rcp_f32 v17, v17
v_pk_mul_f32 v[240:241], v[240:241], v[14:15]
v_pk_mul_f32 v[242:243], v[242:243], v[16:17]
v_cvt_pk_bf16_f32 v128, v240, v241
v_cvt_pk_bf16_f32 v129, v242, v243
v_pk_mul_f32 v[14:15], v[36:37], v[36:37]
v_pk_mul_f32 v[16:17], v[38:39], v[38:39]
v_pk_fma_f32 v[14:15], v[14:15], v[6:7], v[6:7] op_sel:[0,0,1] op_sel_hi:[1,0,1]
v_pk_fma_f32 v[16:17], v[16:17], v[6:7], v[6:7] op_sel:[0,0,1] op_sel_hi:[1,0,1]
v_pk_mul_f32 v[14:15], v[14:15], v[36:37]
v_pk_mul_f32 v[16:17], v[16:17], v[38:39]
v_exp_f32 v14, v14
v_exp_f32 v15, v15
v_exp_f32 v16, v16
v_exp_f32 v17, v17
v_pk_mul_f32 v[148:149], v[36:37], v[148:149]
v_pk_mul_f32 v[150:151], v[38:39], v[150:151]
v_pk_add_f32 v[14:15], v[14:15], 1.0 op_sel_hi:[1,0]
v_pk_add_f32 v[16:17], v[16:17], 1.0 op_sel_hi:[1,0]
v_rcp_f32 v14, v14
v_rcp_f32 v15, v15
v_rcp_f32 v16, v16
v_rcp_f32 v17, v17
v_pk_mul_f32 v[148:149], v[148:149], v[14:15]
v_pk_mul_f32 v[150:151], v[150:151], v[16:17]
v_cvt_pk_bf16_f32 v36, v148, v149
v_cvt_pk_bf16_f32 v37, v150, v151
v_pk_mul_f32 v[14:15], v[52:53], v[52:53]
v_pk_mul_f32 v[16:17], v[54:55], v[54:55]
v_pk_fma_f32 v[14:15], v[14:15], v[6:7], v[6:7] op_sel:[0,0,1] op_sel_hi:[1,0,1]
v_pk_fma_f32 v[16:17], v[16:17], v[6:7], v[6:7] op_sel:[0,0,1] op_sel_hi:[1,0,1]
v_pk_mul_f32 v[14:15], v[14:15], v[52:53]
v_pk_mul_f32 v[16:17], v[16:17], v[54:55]
v_exp_f32 v14, v14
v_exp_f32 v15, v15
v_exp_f32 v16, v16
v_exp_f32 v17, v17
v_pk_mul_f32 v[164:165], v[52:53], v[164:165]
v_pk_mul_f32 v[166:167], v[54:55], v[166:167]
v_pk_add_f32 v[14:15], v[14:15], 1.0 op_sel_hi:[1,0]
v_pk_add_f32 v[16:17], v[16:17], 1.0 op_sel_hi:[1,0]
v_rcp_f32 v14, v14
v_rcp_f32 v15, v15
v_rcp_f32 v16, v16
v_rcp_f32 v17, v17
v_pk_mul_f32 v[164:165], v[164:165], v[14:15]
v_pk_mul_f32 v[166:167], v[166:167], v[16:17]
v_cvt_pk_bf16_f32 v38, v164, v165
v_cvt_pk_bf16_f32 v39, v166, v167
v_pk_mul_f32 v[14:15], v[68:69], v[68:69]
v_pk_mul_f32 v[16:17], v[70:71], v[70:71]
v_pk_fma_f32 v[14:15], v[14:15], v[6:7], v[6:7] op_sel:[0,0,1] op_sel_hi:[1,0,1]
v_pk_fma_f32 v[16:17], v[16:17], v[6:7], v[6:7] op_sel:[0,0,1] op_sel_hi:[1,0,1]
v_pk_mul_f32 v[14:15], v[14:15], v[68:69]
v_pk_mul_f32 v[16:17], v[16:17], v[70:71]
v_exp_f32 v14, v14
v_exp_f32 v15, v15
v_exp_f32 v16, v16
v_exp_f32 v17, v17
v_pk_mul_f32 v[180:181], v[68:69], v[180:181]
v_pk_mul_f32 v[182:183], v[70:71], v[182:183]
v_pk_add_f32 v[14:15], v[14:15], 1.0 op_sel_hi:[1,0]
v_pk_add_f32 v[16:17], v[16:17], 1.0 op_sel_hi:[1,0]
v_rcp_f32 v14, v14
v_rcp_f32 v15, v15
v_rcp_f32 v16, v16
v_rcp_f32 v17, v17
v_pk_mul_f32 v[180:181], v[180:181], v[14:15]
v_pk_mul_f32 v[182:183], v[182:183], v[16:17]
v_cvt_pk_bf16_f32 v68, v180, v181
v_cvt_pk_bf16_f32 v69, v182, v183
s_waitcnt vmcnt(0)
s_cmp_eq_u32 s4, 0
s_cbranch_scc1 L_pkv_ok
v_cmp_ne_u32 vcc, s68, v18
s_nop 4
s_cbranch_vccz L_pkv_ok
s_mov_b32 s6, 0
L_pkv_chk:
buffer_load_dword v0, v31, s[32:35], s44 offen sc1
s_add_u32 s6, s6, 1
s_waitcnt vmcnt(0)
v_cmp_ne_u32 vcc, s68, v0
s_nop 4
s_cbranch_vccz L_pkv_ok
s_cmp_lt_u32 s6, 0x20000
s_cbranch_scc1 L_pkv_chk
L_pkv_ok:
buffer_load_dwordx4 a[96:99], v3, s[28:31], 0 offen offset:0 sc1
buffer_load_dwordx4 a[100:103], v3, s[28:31], 0 offen offset:1024 sc1
buffer_load_dwordx4 a[104:107], v3, s[28:31], 0 offen offset:2048 sc1
buffer_load_dwordx4 a[108:111], v3, s[28:31], 0 offen offset:3072 sc1
buffer_load_dwordx4 a[112:115], v3, s[28:31], s71 offen offset:0 sc1
buffer_load_dwordx4 a[116:119], v3, s[28:31], s71 offen offset:1024 sc1
buffer_load_dwordx4 a[120:123], v3, s[28:31], s71 offen offset:2048 sc1
buffer_load_dwordx4 a[124:127], v3, s[28:31], s71 offen offset:3072 sc1
s_add_u32 s6, s2, s3
s_cmp_eq_u32 s6, 0
s_cbranch_scc0 L_ep1
v_lshlrev_b32 v19, 7, v1
s_mov_b32 s6, 0
L_epc:
s_mov_b64 s[12:13], 0
v_accvgpr_read_b32 v18, a128
v_cmp_ne_u32 vcc, s68, v18
s_nop 1
s_or_b64 s[12:13], s[12:13], vcc
v_accvgpr_read_b32 v18, a129
v_cmp_ne_u32 vcc, s68, v18
s_nop 1
s_or_b64 s[12:13], s[12:13], vcc
v_accvgpr_read_b32 v18, a130
v_cmp_ne_u32 vcc, s68, v18
s_nop 1
s_or_b64 s[12:13], s[12:13], vcc
v_accvgpr_read_b32 v18, a131
v_cmp_ne_u32 vcc, s68, v18
s_nop 1
s_or_b64 s[12:13], s[12:13], vcc
v_accvgpr_read_b32 v18, a132
v_cmp_ne_u32 vcc, s68, v18
s_nop 1
s_or_b64 s[12:13], s[12:13], vcc
v_accvgpr_read_b32 v18, a133
v_cmp_ne_u32 vcc, s68, v18
s_nop 1
s_or_b64 s[12:13], s[12:13], vcc
v_accvgpr_read_b32 v18, a134
v_cmp_ne_u32 vcc, s68, v18
s_nop 1
s_or_b64 s[12:13], s[12:13], vcc
v_accvgpr_read_b32 v18, a135
v_cmp_ne_u32 vcc, s68, v18
s_nop 1
s_or_b64 s[12:13], s[12:13], vcc
v_accvgpr_read_b32 v18, a136
v_cmp_ne_u32 vcc, s68, v18
s_nop 1
s_or_b64 s[12:13], s[12:13], vcc
v_accvgpr_read_b32 v18, a137
v_cmp_ne_u32 vcc, s68, v18
s_nop 1
s_or_b64 s[12:13], s[12:13], vcc
v_accvgpr_read_b32 v18, a138
v_cmp_ne_u32 vcc, s68, v18
s_nop 1
s_or_b64 s[12:13], s[12:13], vcc
v_accvgpr_read_b32 v18, a139
v_cmp_ne_u32 vcc, s68, v18
s_nop 1
s_or_b64 s[12:13], s[12:13], vcc
v_accvgpr_read_b32 v18, a140
v_cmp_ne_u32 vcc, s68, v18
s_nop 1
s_or_b64 s[12:13], s[12:13], vcc
v_accvgpr_read_b32 v18, a141
v_cmp_ne_u32 vcc, s68, v18
s_nop 1
s_or_b64 s[12:13], s[12:13], vcc
v_accvgpr_read_b32 v18, a142
v_cmp_ne_u32 vcc, s68, v18
s_nop 1
s_or_b64 s[12:13], s[12:13], vcc
v_accvgpr_read_b32 v18, a143
v_cmp_ne_u32 vcc, s68, v18
s_nop 1
s_or_b64 s[12:13], s[12:13], vcc
s_cbranch_scc0 L_epw
s_add_u32 s6, s6, 1
s_cmp_ge_u32 s6, 0x20000
s_cbranch_scc1 L_epw
s_movk_i32 s7, 0
buffer_load_dwordx4 a[128:131], v19, s[32:35], s7 offen sc1
s_movk_i32 s7, 8192
buffer_load_dwordx4 a[132:135], v19, s[32:35], s7 offen sc1
s_movk_i32 s7, 16384
buffer_load_dwordx4 a[136:139], v19, s[32:35], s7 offen sc1
s_movk_i32 s7, 24576
buffer_load_dwordx4 a[140:143], v19, s[32:35], s7 offen sc1
s_waitcnt vmcnt(0)
s_branch L_epc
L_epw:
s_mov_b32 s7, 32768
buffer_store_dword v28, v29, s[32:35], s7 offen sc0 sc1
L_ep1:
v_pk_mul_f32 v[14:15], v[84:85], v[84:85]
v_pk_mul_f32 v[16:17], v[86:87], v[86:87]
v_pk_fma_f32 v[14:15], v[14:15], v[6:7], v[6:7] op_sel:[0,0,1] op_sel_hi:[1,0,1]
buffer_store_dwordx4 v[32:35], v2, s[20:23], s36 offen offset:0 sc1
v_pk_fma_f32 v[16:17], v[16:17], v[6:7], v[6:7] op_sel:[0,0,1] op_sel_hi:[1,0,1]
v_pk_mul_f32 v[14:15], v[14:15], v[84:85]
v_pk_mul_f32 v[16:17], v[16:17], v[86:87]
v_exp_f32 v14, v14
v_exp_f32 v15, v15
v_exp_f32 v16, v16
v_exp_f32 v17, v17
v_pk_mul_f32 v[196:197], v[84:85], v[196:197]
v_pk_mul_f32 v[198:199], v[86:87], v[198:199]
v_pk_add_f32 v[14:15], v[14:15], 1.0 op_sel_hi:[1,0]
v_pk_add_f32 v[16:17], v[16:17], 1.0 op_sel_hi:[1,0]
v_rcp_f32 v14, v14
v_rcp_f32 v15, v15
v_rcp_f32 v16, v16
v_rcp_f32 v17, v17
v_pk_mul_f32 v[196:197], v[196:197], v[14:15]
v_pk_mul_f32 v[198:199], v[198:199], v[16:17]
v_cvt_pk_bf16_f32 v70, v196, v197
v_cvt_pk_bf16_f32 v71, v198, v199
v_pk_mul_f32 v[14:15], v[100:101], v[100:101]
v_pk_mul_f32 v[16:17], v[102:103], v[102:103]
v_pk_fma_f32 v[14:15], v[14:15], v[6:7], v[6:7] op_sel:[0,0,1] op_sel_hi:[1,0,1]
v_pk_fma_f32 v[16:17], v[16:17], v[6:7], v[6:7] op_sel:[0,0,1] op_sel_hi:[1,0,1]
v_pk_mul_f32 v[14:15], v[14:15], v[100:101]
v_pk_mul_f32 v[16:17], v[16:17], v[102:103]
v_exp_f32 v14, v14
v_exp_f32 v15, v15
v_exp_f32 v16, v16
v_exp_f32 v17, v17
v_pk_mul_f32 v[212:213], v[100:101], v[212:213]
v_pk_mul_f32 v[214:215], v[102:103], v[214:215]
v_pk_add_f32 v[14:15], v[14:15], 1.0 op_sel_hi:[1,0]
v_pk_add_f32 v[16:17], v[16:17], 1.0 op_sel_hi:[1,0]
v_rcp_f32_e64 v14, v14
buffer_store_dwordx4 v[64:67], v2, s[20:23], s36 offen offset:1024 sc1
v_rcp_f32 v15, v15
v_rcp_f32 v16, v16
v_rcp_f32_e64 v17, v17
v_pk_mul_f32 v[212:213], v[212:213], v[14:15]
v_pk_mul_f32 v[214:215], v[214:215], v[16:17]
v_cvt_pk_bf16_f32 v100, v212, v213
v_cvt_pk_bf16_f32 v101, v214, v215
v_pk_mul_f32 v[14:15], v[116:117], v[116:117]
v_pk_mul_f32 v[16:17], v[118:119], v[118:119]
v_pk_fma_f32 v[14:15], v[14:15], v[6:7], v[6:7] op_sel:[0,0,1] op_sel_hi:[1,0,1]
v_pk_fma_f32 v[16:17], v[16:17], v[6:7], v[6:7] op_sel:[0,0,1] op_sel_hi:[1,0,1]
v_pk_mul_f32 v[14:15], v[14:15], v[116:117]
v_pk_mul_f32 v[16:17], v[16:17], v[118:119]
v_exp_f32 v14, v14
v_exp_f32 v15, v15
v_exp_f32 v16, v16
v_exp_f32 v17, v17
v_pk_mul_f32 v[228:229], v[116:117], v[228:229]
v_pk_mul_f32 v[230:231], v[118:119], v[230:231]
v_pk_add_f32 v[14:15], v[14:15], 1.0 op_sel_hi:[1,0]
v_pk_add_f32 v[16:17], v[16:17], 1.0 op_sel_hi:[1,0]
v_rcp_f32 v14, v14
v_rcp_f32 v15, v15
v_rcp_f32 v16, v16
v_rcp_f32 v17, v17
v_pk_mul_f32 v[228:229], v[228:229], v[14:15]
v_pk_mul_f32 v[230:231], v[230:231], v[16:17]
v_cvt_pk_bf16_f32 v102, v228, v229
v_cvt_pk_bf16_f32 v103, v230, v231
v_pk_mul_f32 v[14:15], v[132:133], v[132:133]
v_pk_mul_f32 v[16:17], v[134:135], v[134:135]
v_pk_fma_f32 v[14:15], v[14:15], v[6:7], v[6:7] op_sel:[0,0,1] op_sel_hi:[1,0,1]
v_pk_fma_f32 v[16:17], v[16:17], v[6:7], v[6:7] op_sel:[0,0,1] op_sel_hi:[1,0,1]
v_pk_mul_f32 v[14:15], v[14:15], v[132:133]
buffer_store_dwordx4 v[96:99], v2, s[20:23], s36 offen offset:2048 sc1
v_pk_mul_f32 v[16:17], v[16:17], v[134:135]
v_exp_f32 v14, v14
v_exp_f32 v15, v15
v_exp_f32 v16, v16
v_exp_f32 v17, v17
v_pk_mul_f32 v[244:245], v[132:133], v[244:245]
v_pk_mul_f32 v[246:247], v[134:135], v[246:247]
v_pk_add_f32 v[14:15], v[14:15], 1.0 op_sel_hi:[1,0]
v_pk_add_f32 v[16:17], v[16:17], 1.0 op_sel_hi:[1,0]
v_rcp_f32 v14, v14
v_rcp_f32 v15, v15
v_rcp_f32 v16, v16
v_rcp_f32 v17, v17
v_pk_mul_f32 v[244:245], v[244:245], v[14:15]
v_pk_mul_f32 v[246:247], v[246:247], v[16:17]
v_cvt_pk_bf16_f32 v132, v244, v245
v_cvt_pk_bf16_f32 v133, v246, v247
v_pk_mul_f32 v[14:15], v[40:41], v[40:41]
v_pk_mul_f32 v[16:17], v[42:43], v[42:43]
v_pk_fma_f32 v[14:15], v[14:15], v[6:7], v[6:7] op_sel:[0,0,1] op_sel_hi:[1,0,1]
v_pk_fma_f32 v[16:17], v[16:17], v[6:7], v[6:7] op_sel:[0,0,1] op_sel_hi:[1,0,1]
v_pk_mul_f32 v[14:15], v[14:15], v[40:41]
v_pk_mul_f32 v[16:17], v[16:17], v[42:43]
v_exp_f32 v14, v14
v_exp_f32 v15, v15
v_exp_f32 v16, v16
v_exp_f32 v17, v17
v_pk_mul_f32 v[152:153], v[40:41], v[152:153]
v_pk_mul_f32 v[154:155], v[42:43], v[154:155]
v_pk_add_f32 v[14:15], v[14:15], 1.0 op_sel_hi:[1,0]
v_pk_add_f32 v[16:17], v[16:17], 1.0 op_sel_hi:[1,0]
v_rcp_f32 v14, v14
v_rcp_f32 v15, v15
v_rcp_f32 v16, v16
buffer_store_dwordx2 v[128:129], v9, s[20:23], s40 offen sc1
v_rcp_f32 v17, v17
v_pk_mul_f32 v[152:153], v[152:153], v[14:15]
v_pk_mul_f32 v[154:155], v[154:155], v[16:17]
v_cvt_pk_bf16_f32 v40, v152, v153
v_cvt_pk_bf16_f32 v41, v154, v155
v_pk_mul_f32 v[14:15], v[56:57], v[56:57]
v_pk_mul_f32 v[16:17], v[58:59], v[58:59]
v_pk_fma_f32 v[14:15], v[14:15], v[6:7], v[6:7] op_sel:[0,0,1] op_sel_hi:[1,0,1]
v_pk_fma_f32 v[16:17], v[16:17], v[6:7], v[6:7] op_sel:[0,0,1] op_sel_hi:[1,0,1]
v_pk_mul_f32 v[14:15], v[14:15], v[56:57]
v_pk_mul_f32 v[16:17], v[16:17], v[58:59]
v_exp_f32 v14, v14
v_exp_f32 v15, v15
v_exp_f32 v16, v16
v_exp_f32 v17, v17
v_pk_mul_f32 v[168:169], v[56:57], v[168:169]
v_pk_mul_f32 v[170:171], v[58:59], v[170:171]
v_pk_add_f32 v[14:15], v[14:15], 1.0 op_sel_hi:[1,0]
v_pk_add_f32 v[16:17], v[16:17], 1.0 op_sel_hi:[1,0]
v_rcp_f32 v14, v14
v_rcp_f32 v15, v15
v_rcp_f32 v16, v16
v_rcp_f32 v17, v17
v_pk_mul_f32 v[168:169], v[168:169], v[14:15]
v_pk_mul_f32 v[170:171], v[170:171], v[16:17]
v_cvt_pk_bf16_f32 v42, v168, v169
v_cvt_pk_bf16_f32 v43, v170, v171
v_pk_mul_f32 v[14:15], v[72:73], v[72:73]
v_pk_mul_f32 v[16:17], v[74:75], v[74:75]
v_pk_fma_f32 v[14:15], v[14:15], v[6:7], v[6:7] op_sel:[0,0,1] op_sel_hi:[1,0,1]
v_pk_fma_f32 v[16:17], v[16:17], v[6:7], v[6:7] op_sel:[0,0,1] op_sel_hi:[1,0,1]
v_pk_mul_f32 v[14:15], v[14:15], v[72:73]
v_pk_mul_f32 v[16:17], v[16:17], v[74:75]
v_exp_f32_e64 v14, v14
buffer_store_dwordx4 v[36:39], v2, s[20:23], s37 offen offset:0 sc1
v_exp_f32 v15, v15
v_exp_f32 v16, v16
v_exp_f32_e64 v17, v17
v_pk_mul_f32 v[184:185], v[72:73], v[184:185]
v_pk_mul_f32 v[186:187], v[74:75], v[186:187]
v_pk_add_f32 v[14:15], v[14:15], 1.0 op_sel_hi:[1,0]
v_pk_add_f32 v[16:17], v[16:17], 1.0 op_sel_hi:[1,0]
v_rcp_f32 v14, v14
v_rcp_f32 v15, v15
v_rcp_f32 v16, v16
v_rcp_f32 v17, v17
v_pk_mul_f32 v[184:185], v[184:185], v[14:15]
v_pk_mul_f32 v[186:187], v[186:187], v[16:17]
v_cvt_pk_bf16_f32 v72, v184, v185
v_cvt_pk_bf16_f32 v73, v186, v187
v_pk_mul_f32 v[14:15], v[88:89], v[88:89]
v_pk_mul_f32 v[16:17], v[90:91], v[90:91]
v_pk_fma_f32 v[14:15], v[14:15], v[6:7], v[6:7] op_sel:[0,0,1] op_sel_hi:[1,0,1]
v_pk_fma_f32 v[16:17], v[16:17], v[6:7], v[6:7] op_sel:[0,0,1] op_sel_hi:[1,0,1]
v_pk_mul_f32 v[14:15], v[14:15], v[88:89]
v_pk_mul_f32 v[16:17], v[16:17], v[90:91]
v_exp_f32 v14, v14
v_exp_f32 v15, v15
v_exp_f32 v16, v16
v_exp_f32 v17, v17
v_pk_mul_f32 v[200:201], v[88:89], v[200:201]
v_pk_mul_f32 v[202:203], v[90:91], v[202:203]
v_pk_add_f32 v[14:15], v[14:15], 1.0 op_sel_hi:[1,0]
v_pk_add_f32 v[16:17], v[16:17], 1.0 op_sel_hi:[1,0]
v_rcp_f32 v14, v14
v_rcp_f32 v15, v15
v_rcp_f32 v16, v16
v_rcp_f32 v17, v17
v_pk_mul_f32 v[200:201], v[200:201], v[14:15]
buffer_store_dwordx4 v[68:71], v2, s[20:23], s37 offen offset:1024 sc1
v_pk_mul_f32 v[202:203], v[202:203], v[16:17]
v_cvt_pk_bf16_f32 v74, v200, v201
v_cvt_pk_bf16_f32 v75, v202, v203
v_pk_mul_f32 v[14:15], v[104:105], v[104:105]
v_pk_mul_f32 v[16:17], v[106:107], v[106:107]
v_pk_fma_f32 v[14:15], v[14:15], v[6:7], v[6:7] op_sel:[0,0,1] op_sel_hi:[1,0,1]
v_pk_fma_f32 v[16:17], v[16:17], v[6:7], v[6:7] op_sel:[0,0,1] op_sel_hi:[1,0,1]
v_pk_mul_f32 v[14:15], v[14:15], v[104:105]
v_pk_mul_f32 v[16:17], v[16:17], v[106:107]
v_exp_f32 v14, v14
v_exp_f32 v15, v15
v_exp_f32 v16, v16
v_exp_f32 v17, v17
v_pk_mul_f32 v[216:217], v[104:105], v[216:217]
v_pk_mul_f32 v[218:219], v[106:107], v[218:219]
v_pk_add_f32 v[14:15], v[14:15], 1.0 op_sel_hi:[1,0]
v_pk_add_f32 v[16:17], v[16:17], 1.0 op_sel_hi:[1,0]
v_rcp_f32 v14, v14
v_rcp_f32 v15, v15
v_rcp_f32 v16, v16
v_rcp_f32 v17, v17
v_pk_mul_f32 v[216:217], v[216:217], v[14:15]
v_pk_mul_f32 v[218:219], v[218:219], v[16:17]
v_cvt_pk_bf16_f32 v104, v216, v217
v_cvt_pk_bf16_f32 v105, v218, v219
v_pk_mul_f32 v[14:15], v[120:121], v[120:121]
v_pk_mul_f32 v[16:17], v[122:123], v[122:123]
v_pk_fma_f32 v[14:15], v[14:15], v[6:7], v[6:7] op_sel:[0,0,1] op_sel_hi:[1,0,1]
v_pk_fma_f32 v[16:17], v[16:17], v[6:7], v[6:7] op_sel:[0,0,1] op_sel_hi:[1,0,1]
v_pk_mul_f32 v[14:15], v[14:15], v[120:121]
v_pk_mul_f32 v[16:17], v[16:17], v[122:123]
v_exp_f32 v14, v14
v_exp_f32 v15, v15
v_exp_f32 v16, v16
buffer_store_dwordx4 v[100:103], v2, s[20:23], s37 offen offset:2048 sc1
v_exp_f32 v17, v17
v_pk_mul_f32 v[232:233], v[120:121], v[232:233]
v_pk_mul_f32 v[234:235], v[122:123], v[234:235]
v_pk_add_f32 v[14:15], v[14:15], 1.0 op_sel_hi:[1,0]
v_pk_add_f32 v[16:17], v[16:17], 1.0 op_sel_hi:[1,0]
v_rcp_f32 v14, v14
v_rcp_f32 v15, v15
v_rcp_f32 v16, v16
v_rcp_f32 v17, v17
v_pk_mul_f32 v[232:233], v[232:233], v[14:15]
v_pk_mul_f32 v[234:235], v[234:235], v[16:17]
v_cvt_pk_bf16_f32 v106, v232, v233
v_cvt_pk_bf16_f32 v107, v234, v235
v_pk_mul_f32 v[14:15], v[136:137], v[136:137]
v_pk_mul_f32 v[16:17], v[138:139], v[138:139]
v_pk_fma_f32 v[14:15], v[14:15], v[6:7], v[6:7] op_sel:[0,0,1] op_sel_hi:[1,0,1]
v_pk_fma_f32 v[16:17], v[16:17], v[6:7], v[6:7] op_sel:[0,0,1] op_sel_hi:[1,0,1]
v_pk_mul_f32 v[14:15], v[14:15], v[136:137]
v_pk_mul_f32 v[16:17], v[16:17], v[138:139]
v_exp_f32 v14, v14
v_exp_f32 v15, v15
v_exp_f32 v16, v16
v_exp_f32 v17, v17
v_pk_mul_f32 v[248:249], v[136:137], v[248:249]
v_pk_mul_f32 v[250:251], v[138:139], v[250:251]
v_pk_add_f32 v[14:15], v[14:15], 1.0 op_sel_hi:[1,0]
v_pk_add_f32 v[16:17], v[16:17], 1.0 op_sel_hi:[1,0]
v_rcp_f32 v14, v14
v_rcp_f32 v15, v15
v_rcp_f32 v16, v16
v_rcp_f32 v17, v17
v_pk_mul_f32 v[248:249], v[248:249], v[14:15]
v_pk_mul_f32 v[250:251], v[250:251], v[16:17]
v_cvt_pk_bf16_f32 v136, v248, v249
v_cvt_pk_bf16_f32 v137, v250, v251
v_pk_mul_f32 v[14:15], v[44:45], v[44:45]
v_pk_mul_f32 v[16:17], v[46:47], v[46:47]
v_pk_fma_f32 v[14:15], v[14:15], v[6:7], v[6:7] op_sel:[0,0,1] op_sel_hi:[1,0,1]
buffer_store_dwordx2 v[132:133], v9, s[20:23], s41 offen sc1
v_pk_fma_f32 v[16:17], v[16:17], v[6:7], v[6:7] op_sel:[0,0,1] op_sel_hi:[1,0,1]
v_pk_mul_f32 v[14:15], v[14:15], v[44:45]
v_pk_mul_f32 v[16:17], v[16:17], v[46:47]
v_exp_f32 v14, v14
v_exp_f32 v15, v15
v_exp_f32 v16, v16
v_exp_f32 v17, v17
v_pk_mul_f32 v[156:157], v[44:45], v[156:157]
v_pk_mul_f32 v[158:159], v[46:47], v[158:159]
v_pk_add_f32 v[14:15], v[14:15], 1.0 op_sel_hi:[1,0]
v_pk_add_f32 v[16:17], v[16:17], 1.0 op_sel_hi:[1,0]
v_rcp_f32 v14, v14
v_rcp_f32 v15, v15
v_rcp_f32 v16, v16
v_rcp_f32 v17, v17
v_pk_mul_f32 v[156:157], v[156:157], v[14:15]
v_pk_mul_f32 v[158:159], v[158:159], v[16:17]
v_cvt_pk_bf16_f32 v44, v156, v157
v_cvt_pk_bf16_f32 v45, v158, v159
v_pk_mul_f32 v[14:15], v[60:61], v[60:61]
v_pk_mul_f32 v[16:17], v[62:63], v[62:63]
v_pk_fma_f32 v[14:15], v[14:15], v[6:7], v[6:7] op_sel:[0,0,1] op_sel_hi:[1,0,1]
v_pk_fma_f32 v[16:17], v[16:17], v[6:7], v[6:7] op_sel:[0,0,1] op_sel_hi:[1,0,1]
v_pk_mul_f32 v[14:15], v[14:15], v[60:61]
v_pk_mul_f32 v[16:17], v[16:17], v[62:63]
v_exp_f32 v14, v14
v_exp_f32 v15, v15
v_exp_f32 v16, v16
v_exp_f32 v17, v17
v_pk_mul_f32 v[172:173], v[60:61], v[172:173]
buffer_store_dwordx4 v[40:43], v2, s[20:23], s38 offen offset:0 sc1
v_pk_mul_f32 v[174:175], v[62:63], v[174:175]
v_pk_add_f32 v[14:15], v[14:15], 1.0 op_sel_hi:[1,0]
v_pk_add_f32 v[16:17], v[16:17], 1.0 op_sel_hi:[1,0]
v_rcp_f32 v14, v14
v_rcp_f32 v15, v15
v_rcp_f32 v16, v16
v_rcp_f32 v17, v17
v_pk_mul_f32 v[172:173], v[172:173], v[14:15]
v_pk_mul_f32 v[174:175], v[174:175], v[16:17]
v_cvt_pk_bf16_f32 v46, v172, v173
v_cvt_pk_bf16_f32 v47, v174, v175
v_pk_mul_f32 v[14:15], v[76:77], v[76:77]
v_pk_mul_f32 v[16:17], v[78:79], v[78:79]
v_pk_fma_f32 v[14:15], v[14:15], v[6:7], v[6:7] op_sel:[0,0,1] op_sel_hi:[1,0,1]
v_pk_fma_f32 v[16:17], v[16:17], v[6:7], v[6:7] op_sel:[0,0,1] op_sel_hi:[1,0,1]
v_pk_mul_f32 v[14:15], v[14:15], v[76:77]
v_pk_mul_f32 v[16:17], v[16:17], v[78:79]
v_exp_f32 v14, v14
v_exp_f32 v15, v15
v_exp_f32 v16, v16
v_exp_f32 v17, v17
v_pk_mul_f32 v[188:189], v[76:77], v[188:189]
v_pk_mul_f32 v[190:191], v[78:79], v[190:191]
v_pk_add_f32 v[14:15], v[14:15], 1.0 op_sel_hi:[1,0]
v_pk_add_f32 v[16:17], v[16:17], 1.0 op_sel_hi:[1,0]
v_rcp_f32 v14, v14
v_rcp_f32 v15, v15
v_rcp_f32 v16, v16
v_rcp_f32 v17, v17
v_pk_mul_f32 v[188:189], v[188:189], v[14:15]
buffer_store_dwordx4 v[72:75], v2, s[20:23], s38 offen offset:1024 sc1
v_pk_mul_f32 v[190:191], v[190:191], v[16:17]
v_cvt_pk_bf16_f32 v76, v188, v189
v_cvt_pk_bf16_f32 v77, v190, v191
v_pk_mul_f32 v[14:15], v[92:93], v[92:93]
v_pk_mul_f32 v[16:17], v[94:95], v[94:95]
v_pk_fma_f32 v[14:15], v[14:15], v[6:7], v[6:7] op_sel:[0,0,1] op_sel_hi:[1,0,1]
v_pk_fma_f32 v[16:17], v[16:17], v[6:7], v[6:7] op_sel:[0,0,1] op_sel_hi:[1,0,1]
v_pk_mul_f32 v[14:15], v[14:15], v[92:93]
s_waitcnt vmcnt(10)
ds_write_b128 v3, a[96:99] offset:0
ds_write_b128 v3, a[100:103] offset:1024
v_pk_mul_f32 v[16:17], v[16:17], v[94:95]
v_exp_f32 v14, v14
v_exp_f32 v15, v15
v_exp_f32 v16, v16
v_exp_f32_e64 v17, v17
v_pk_mul_f32 v[204:205], v[92:93], v[204:205]
v_pk_mul_f32 v[206:207], v[94:95], v[206:207]
v_pk_add_f32 v[14:15], v[14:15], 1.0 op_sel_hi:[1,0]
v_pk_add_f32 v[16:17], v[16:17], 1.0 op_sel_hi:[1,0]
v_rcp_f32 v14, v14
v_rcp_f32 v15, v15
v_rcp_f32 v16, v16
v_rcp_f32 v17, v17
v_pk_mul_f32 v[204:205], v[204:205], v[14:15]
v_pk_mul_f32 v[206:207], v[206:207], v[16:17]
v_cvt_pk_bf16_f32 v78, v204, v205
v_cvt_pk_bf16_f32 v79, v206, v207
v_pk_mul_f32 v[14:15], v[108:109], v[108:109]
v_pk_mul_f32 v[16:17], v[110:111], v[110:111]
v_pk_fma_f32 v[14:15], v[14:15], v[6:7], v[6:7] op_sel:[0,0,1] op_sel_hi:[1,0,1]
ds_write_b128 v3, a[104:107] offset:2048
ds_write_b128 v3, a[108:111] offset:3072
v_pk_fma_f32 v[16:17], v[16:17], v[6:7], v[6:7] op_sel:[0,0,1] op_sel_hi:[1,0,1]
v_pk_mul_f32 v[14:15], v[14:15], v[108:109]
buffer_store_dwordx4 v[104:107], v2, s[20:23], s38 offen offset:2048 sc1
v_pk_mul_f32 v[16:17], v[16:17], v[110:111]
v_exp_f32 v14, v14
v_exp_f32 v15, v15
v_exp_f32 v16, v16
v_exp_f32 v17, v17
v_pk_mul_f32 v[220:221], v[108:109], v[220:221]
v_pk_mul_f32 v[222:223], v[110:111], v[222:223]
v_pk_add_f32 v[14:15], v[14:15], 1.0 op_sel_hi:[1,0]
v_pk_add_f32 v[16:17], v[16:17], 1.0 op_sel_hi:[1,0]
v_rcp_f32 v14, v14
v_rcp_f32 v15, v15
v_rcp_f32 v16, v16
v_rcp_f32 v17, v17
v_pk_mul_f32 v[220:221], v[220:221], v[14:15]
v_pk_mul_f32 v[222:223], v[222:223], v[16:17]
v_cvt_pk_bf16_f32 v108, v220, v221
v_cvt_pk_bf16_f32 v109, v222, v223
v_pk_mul_f32 v[14:15], v[124:125], v[124:125]
ds_write_b128 v3, a[112:115] offset:32768
ds_write_b128 v3, a[116:119] offset:33792
v_pk_mul_f32 v[16:17], v[126:127], v[126:127]
v_pk_fma_f32 v[14:15], v[14:15], v[6:7], v[6:7] op_sel:[0,0,1] op_sel_hi:[1,0,1]
v_pk_fma_f32 v[16:17], v[16:17], v[6:7], v[6:7] op_sel:[0,0,1] op_sel_hi:[1,0,1]
v_pk_mul_f32 v[14:15], v[14:15], v[124:125]
v_pk_mul_f32 v[16:17], v[16:17], v[126:127]
v_exp_f32 v14, v14
v_exp_f32 v15, v15
v_exp_f32 v16, v16
v_exp_f32 v17, v17
v_pk_mul_f32 v[236:237], v[124:125], v[236:237]
v_pk_mul_f32 v[238:239], v[126:127], v[238:239]
v_pk_add_f32 v[14:15], v[14:15], 1.0 op_sel_hi:[1,0]
buffer_store_dwordx2 v[136:137], v9, s[20:23], s42 offen sc1
v_pk_add_f32 v[16:17], v[16:17], 1.0 op_sel_hi:[1,0]
v_rcp_f32 v14, v14
v_rcp_f32 v15, v15
v_rcp_f32 v16, v16
v_rcp_f32 v17, v17
v_pk_mul_f32 v[236:237], v[236:237], v[14:15]
v_pk_mul_f32 v[238:239], v[238:239], v[16:17]
v_cvt_pk_bf16_f32 v110, v236, v237
ds_write_b128 v3, a[120:123] offset:34816
ds_write_b128 v3, a[124:127] offset:35840
v_cvt_pk_bf16_f32 v111, v238, v239
v_pk_mul_f32 v[14:15], v[140:141], v[140:141]
v_pk_mul_f32 v[16:17], v[142:143], v[142:143]
v_pk_fma_f32 v[14:15], v[14:15], v[6:7], v[6:7] op_sel:[0,0,1] op_sel_hi:[1,0,1]
v_pk_fma_f32 v[16:17], v[16:17], v[6:7], v[6:7] op_sel:[0,0,1] op_sel_hi:[1,0,1]
v_pk_mul_f32 v[14:15], v[14:15], v[140:141]
v_pk_mul_f32 v[16:17], v[16:17], v[142:143]
v_exp_f32 v14, v14
v_exp_f32 v15, v15
v_exp_f32 v16, v16
v_exp_f32 v17, v17
v_pk_mul_f32 v[252:253], v[140:141], v[252:253]
v_pk_mul_f32 v[254:255], v[142:143], v[254:255]
v_pk_add_f32 v[14:15], v[14:15], 1.0 op_sel_hi:[1,0]
v_pk_add_f32 v[16:17], v[16:17], 1.0 op_sel_hi:[1,0]
v_rcp_f32 v14, v14
v_rcp_f32 v15, v15
v_rcp_f32 v16, v16
v_rcp_f32 v17, v17
v_pk_mul_f32 v[252:253], v[252:253], v[14:15]
v_pk_mul_f32 v[254:255], v[254:255], v[16:17]
v_cvt_pk_bf16_f32 v140, v252, v253
v_cvt_pk_bf16_f32 v141, v254, v255
s_waitcnt lgkmcnt(0)
s_barrier
ds_read_b128 a[96:99], v3 offset:0
ds_read_b128 a[100:103], v3 offset:1024
ds_read_b128 a[104:107], v3 offset:2048
ds_read_b128 a[108:111], v3 offset:3072
ds_read_b128 a[112:115], v3 offset:4096
ds_read_b128 a[116:119], v3 offset:5120
ds_read_b128 a[120:123], v3 offset:6144
ds_read_b128 a[124:127], v3 offset:7168
ds_read_b128 a[128:131], v3 offset:8192
ds_read_b128 a[132:135], v3 offset:9216
ds_read_b128 a[136:139], v3 offset:10240
ds_read_b128 a[140:143], v3 offset:11264
ds_read_b128 a[144:147], v3 offset:12288
ds_read_b128 a[148:151], v3 offset:13312
ds_read_b128 a[152:155], v3 offset:14336
v_accvgpr_write_b32 a32, v44
v_accvgpr_write_b32 a33, v45
v_accvgpr_write_b32 a34, v46
v_accvgpr_write_b32 a35, v47
v_accvgpr_write_b32 a36, v76
v_accvgpr_write_b32 a37, v77
v_accvgpr_write_b32 a38, v78
v_accvgpr_write_b32 a39, v79
v_accvgpr_write_b32 a40, v108
v_accvgpr_write_b32 a41, v109
v_accvgpr_write_b32 a42, v110
v_accvgpr_write_b32 a43, v111
v_accvgpr_write_b32 a44, v140
v_accvgpr_write_b32 a45, v141
v_accvgpr_read_b32 v14, a0
v_accvgpr_read_b32 v15, a1
v_accvgpr_read_b32 v16, a2
v_accvgpr_read_b32 v17, a3
v_accvgpr_read_b32 v18, a16
v_accvgpr_read_b32 v19, a17
v_accvgpr_read_b32 v20, a18
v_accvgpr_read_b32 v21, a19
v_cvt_pk_bf16_f32 v32, v14, v15
v_cvt_pk_bf16_f32 v33, v16, v17
v_cvt_pk_bf16_f32 v34, v18, v19
v_cvt_pk_bf16_f32 v35, v20, v21
v_and_b32 v24, 15, v1
v_lshrrev_b32 v25, 4, v1
v_lshlrev_b32 v26, 2, v25
v_mov_b32 v27, 0xf149f2ca
s_cmp_eq_u32 s4, 0
s_cselect_b32 s6, s3, 4
s_cmp_lt_u32 s6, 4
s_cselect_b32 s7, 0xf149f2ca, 0
v_mov_b32 v240, s7
v_mov_b32 v241, s7
v_mov_b32 v242, s7
v_mov_b32 v243, s7
s_cmp_lt_u32 s6, 3
s_cselect_b32 s7, 0xf149f2ca, 0
v_mov_b32 v244, s7
v_mov_b32 v245, s7
v_mov_b32 v246, s7
v_mov_b32 v247, s7
s_cmp_lt_u32 s6, 2
s_cselect_b32 s7, 0xf149f2ca, 0
v_mov_b32 v248, s7
v_mov_b32 v249, s7
v_mov_b32 v250, s7
v_mov_b32_e64 v251, s7
s_cmp_lt_u32 s6, 1
s_cselect_b32 s7, 0xf149f2ca, 0
v_mov_b32 v252, s7
v_mov_b32 v253, s7
v_mov_b32 v254, s7
v_mov_b32 v255, s7
v_add_u32 v22, 0, v26
v_cmp_gt_u32 vcc, v22, v24
v_mov_b32 v56, 0x3f803f80
s_nop 0
v_cndmask_b32 v48, v27, v240, vcc
v_cndmask_b32 v52, v31, v27, vcc
v_add_u32_e64 v22, 1, v26
v_cmp_gt_u32 vcc, v22, v24
v_mov_b32 v57, 0x3f803f80
s_nop 0
v_cndmask_b32 v49, v27, v240, vcc
v_cndmask_b32 v53, v31, v27, vcc
v_add_u32_e64 v22, 2, v26
v_cmp_gt_u32 vcc, v22, v24
v_mov_b32 v58, 0x3f803f80
s_nop 0
v_cndmask_b32 v50, v27, v240, vcc
v_cndmask_b32 v54, v31, v27, vcc
v_add_u32_e64 v22, 3, v26
v_cmp_gt_u32 vcc, v22, v24
v_mov_b32 v59, 0x3f803f80
s_nop 0
v_cndmask_b32 v51, v27, v240, vcc
v_cndmask_b32 v55, v31, v27, vcc
s_waitcnt lgkmcnt(14)
v_mfma_f32_16x16x32_bf16 v[96:99], a[96:99], v[32:35], v[48:51]
ds_read_b128 a[156:159], v3 offset:15360
v_accvgpr_read_b32 v14, a4
v_accvgpr_read_b32 v15, a5
v_accvgpr_read_b32 v16, a6
v_accvgpr_read_b32 v17, a7
v_accvgpr_read_b32 v18, a20
v_accvgpr_read_b32 v19, a21
s_waitcnt lgkmcnt(14)
v_mfma_f32_16x16x32_bf16 v[100:103], a[100:103], v[32:35], v[240:243]
ds_read_b128 a[160:163], v3 offset:16384
v_accvgpr_read_b32 v20, a22
v_accvgpr_read_b32 v21, a23
v_cvt_pk_bf16_f32 v36, v14, v15
v_cvt_pk_bf16_f32 v37, v16, v17
v_cvt_pk_bf16_f32 v38, v18, v19
v_cvt_pk_bf16_f32 v39, v20, v21
s_waitcnt lgkmcnt(14)
v_mfma_f32_16x16x32_bf16 v[104:107], a[104:107], v[32:35], v[240:243]
ds_read_b128 a[164:167], v3 offset:17408
v_accvgpr_read_b32 v14, a8
v_accvgpr_read_b32 v15, a9
v_accvgpr_read_b32 v16, a10
v_accvgpr_read_b32 v17, a11
v_accvgpr_read_b32 v18, a24
v_accvgpr_read_b32 v19, a25
s_waitcnt lgkmcnt(14)
v_mfma_f32_16x16x32_bf16 v[108:111], a[108:111], v[32:35], v[240:243]
ds_read_b128 a[168:171], v3 offset:18432
v_accvgpr_read_b32 v20, a26
v_accvgpr_read_b32 v21, a27
v_cvt_pk_bf16_f32 v40, v14, v15
v_cvt_pk_bf16_f32 v41, v16, v17
v_cvt_pk_bf16_f32 v42, v18, v19
v_cvt_pk_bf16_f32 v43, v20, v21
s_waitcnt lgkmcnt(14)
v_mfma_f32_16x16x32_bf16 v[112:115], a[112:115], v[32:35], v[244:247]
ds_read_b128 a[172:175], v3 offset:19456
v_accvgpr_read_b32 v14, a12
v_accvgpr_read_b32 v15, a13
v_accvgpr_read_b32 v16, a14
v_accvgpr_read_b32 v17, a15
v_accvgpr_read_b32 v18, a28
v_accvgpr_read_b32 v19, a29
s_waitcnt lgkmcnt(14)
v_mfma_f32_16x16x32_bf16 v[116:119], a[116:119], v[32:35], v[244:247]
ds_read_b128 a[176:179], v3 offset:32768
v_accvgpr_read_b32 v20, a30
v_accvgpr_read_b32 v21, a31
v_cvt_pk_bf16_f32 v44, v14, v15
v_cvt_pk_bf16_f32 v45, v16, v17
v_cvt_pk_bf16_f32 v46, v18, v19
v_cvt_pk_bf16_f32 v47, v20, v21
s_waitcnt lgkmcnt(14)
v_mfma_f32_16x16x32_bf16 v[120:123], a[120:123], v[32:35], v[244:247]
ds_read_b128 a[180:183], v3 offset:33792
s_mov_b32 s46, 0x3e8293ee
s_mov_b32 s47, 0x3e8293ee
s_and_b32 s12, s2, 1
s_lshl_b32 s12, s12, 2
s_bfe_u32 s6, s2, 0x20003
s_add_u32 s12, s12, s6
s_waitcnt lgkmcnt(14)
v_mfma_f32_16x16x32_bf16 v[124:127], a[124:127], v[32:35], v[244:247]
ds_read_b128 a[184:187], v3 offset:34816
s_lshr_b32 s13, s2, 5
s_bfe_u32 s78, s2, 0x20001
s_lshl_b32 s6, s78, 2
v_xor_b32 v23, s6, v24
v_add_u32 v22, 0, v25
v_lshlrev_b32 v22, 1, v22
s_waitcnt lgkmcnt(14)
v_mfma_f32_16x16x32_bf16 v[128:131], a[128:131], v[32:35], v[248:251]
ds_read_b128 a[188:191], v3 offset:35840
v_xor_b32 v22, v22, v23
v_lshlrev_b32 v22, 4, v22
v_lshl_add_u32 v22, v25, 11, v22
v_add_u32 v84, 0, v22
v_add_u32 v22, 4, v25
v_lshlrev_b32 v22, 1, v22
s_waitcnt lgkmcnt(14)
v_mfma_f32_16x16x32_bf16 v[132:135], a[132:135], v[32:35], v[248:251]
ds_read_b128 a[192:195], v3 offset:36864
v_xor_b32 v22, v22, v23
v_lshlrev_b32 v22, 4, v22
v_lshl_add_u32 v22, v25, 11, v22
v_add_u32 v85, 7168, v22
v_add_u32 v22, 0, v25
v_lshlrev_b32_e64 v22, 1, v22
s_waitcnt lgkmcnt(14)
v_mfma_f32_16x16x32_bf16 v[136:139], a[136:139], v[32:35], v[248:251]
ds_read_b128 a[196:199], v3 offset:37888
v_xor_b32 v22, v22, v23
v_lshlrev_b32 v22, 4, v22
v_lshl_add_u32 v22, v25, 11, v22
v_add_u32 v86, 14336, v22
v_add_u32 v22, 4, v25
v_lshlrev_b32_e64 v22, 1, v22
s_waitcnt lgkmcnt(14)
v_mfma_f32_16x16x32_bf16 v[140:143], a[140:143], v[32:35], v[248:251]
ds_read_b128 a[200:203], v3 offset:38912
v_xor_b32 v22, v22, v23
v_lshlrev_b32 v22, 4, v22
v_lshl_add_u32 v22, v25, 11, v22
v_add_u32 v87, 21504, v22
v_lshlrev_b32 v89, 11, v24
v_and_b32_e64 v22, 1, v25
s_waitcnt lgkmcnt(14)
v_mfma_f32_16x16x32_bf16 v[144:147], a[144:147], v[32:35], v[252:255]
ds_read_b128 a[204:207], v3 offset:39936
v_lshl_add_u32 v89, v22, 5, v89
v_lshrrev_b32 v22, 1, v25
v_lshl_add_u32 v89, v22, 4, v89
v_and_b32 v88, 7, v1
v_lshlrev_b32 v88, 7, v88
s_lshl_b32 s14, s12, 2
s_waitcnt lgkmcnt(14)
v_mfma_f32_16x16x32_bf16 v[148:151], a[148:151], v[32:35], v[252:255]
ds_read_b128 a[208:211], v3 offset:40960
s_add_u32 s14, s14, s3
s_lshl_b32 s15, s13, 8
s_lshl_b32 s45, s12, 12
s_lshl_b32 s6, s78, 10
s_add_u32 s45, s45, s6
s_lshl_b32 s6, s3, 2
s_waitcnt lgkmcnt(14)
v_mfma_f32_16x16x32_bf16 v[152:155], a[152:155], v[32:35], v[252:255]
ds_read_b128 a[212:215], v3 offset:41984
s_add_u32 s45, s45, s6
s_add_u32 s45, s45, 32
s_sub_u32 s74, 7340032, s15
s_add_u32 s72, s60, s15
s_addc_u32 s73, s61, 0
s_and_b32 s73, s73, 0xffff
s_waitcnt lgkmcnt(14)
v_mfma_f32_16x16x32_bf16 v[156:159], a[156:159], v[32:35], v[252:255]
ds_read_b128 a[216:219], v3 offset:43008
s_mov_b32 s75, 0x20000
s_lshl_b32 s77, s3, 16
s_mul_i32 s76, s78, 1835008
s_add_u32 s76, s76, s77
s_add_u32 s79, s76, 0x8000
s_lshl_b32 s44, s3, 13
s_waitcnt lgkmcnt(14)
v_mfma_f32_16x16x32_bf16 v[160:163], a[160:163], v[32:35], v[52:55]
ds_read_b128 a[220:223], v3 offset:44032
ds_read_b128 a[224:227], v3 offset:45056
ds_read_b128 a[228:231], v3 offset:46080
ds_read_b128 a[232:235], v3 offset:47104
ds_read_b128 a[236:239], v3 offset:48128
ds_read_b128 a[240:243], v3 offset:49152
ds_read_b128 a[244:247], v3 offset:50176
ds_read_b128 a[248:251], v3 offset:51200
ds_read_b128 a[252:255], v3 offset:52224
v_max_f32 v18, v96, v97
v_max_f32_e64 v19, v98, v99
v_max3_f32 v18, v18, v100, v101
v_max3_f32 v19, v19, v102, v103
v_max3_f32 v18, v18, v104, v105
v_max3_f32 v19, v19, v106, v107
v_max3_f32 v18, v18, v108, v109
v_max3_f32 v19, v19, v110, v111
v_max3_f32 v18, v18, v112, v113
v_max3_f32 v19, v19, v114, v115
v_max3_f32 v18, v18, v116, v117
v_max3_f32 v19, v19, v118, v119
v_max3_f32 v18, v18, v120, v121
v_max3_f32 v19, v19, v122, v123
v_max3_f32 v18, v18, v124, v125
v_max3_f32 v19, v19, v126, v127
v_max3_f32 v18, v18, v128, v129
v_max3_f32 v19, v19, v130, v131
v_max3_f32 v18, v18, v132, v133
v_max3_f32 v19, v19, v134, v135
v_max3_f32 v18, v18, v136, v137
v_max3_f32 v19, v19, v138, v139
v_max3_f32 v18, v18, v140, v141
v_max3_f32 v19, v19, v142, v143
v_max3_f32 v18, v18, v144, v145
v_max3_f32 v19, v19, v146, v147
v_max3_f32 v18, v18, v148, v149
v_max3_f32 v19, v19, v150, v151
v_max3_f32 v18, v18, v152, v153
v_max3_f32 v19, v19, v154, v155
v_max3_f32 v18, v18, v156, v157
v_max3_f32 v19, v19, v158, v159
v_max3_f32 v18, v18, v160, v161
v_max3_f32 v19, v19, v162, v163
v_max_f32 v18, v18, v19
v_mov_b32 v19, v18
s_nop 1
v_permlane32_swap_b32 v19, v18
v_max_f32 v18, v18, v19
v_mov_b32 v19, v18
s_nop 1
v_permlane16_swap_b32 v19, v18
v_max_f32 v18, v18, v19
v_mul_f32 v18, s46, v18
v_pk_fma_f32 v[96:97], v[96:97], s[46:47], v[18:19] op_sel_hi:[1,1,0] neg_lo:[0,0,1] neg_hi:[0,0,1]
v_pk_fma_f32 v[98:99], v[98:99], s[46:47], v[18:19] op_sel_hi:[1,1,0] neg_lo:[0,0,1] neg_hi:[0,0,1]
v_pk_fma_f32 v[100:101], v[100:101], s[46:47], v[18:19] op_sel_hi:[1,1,0] neg_lo:[0,0,1] neg_hi:[0,0,1]
buffer_store_dwordx4 a[32:35], v2, s[20:23], s39 offen offset:0 sc1
v_pk_fma_f32 v[102:103], v[102:103], s[46:47], v[18:19] op_sel_hi:[1,1,0] neg_lo:[0,0,1] neg_hi:[0,0,1]
v_pk_fma_f32 v[104:105], v[104:105], s[46:47], v[18:19] op_sel_hi:[1,1,0] neg_lo:[0,0,1] neg_hi:[0,0,1]
v_pk_fma_f32 v[106:107], v[106:107], s[46:47], v[18:19] op_sel_hi:[1,1,0] neg_lo:[0,0,1] neg_hi:[0,0,1]
v_pk_fma_f32 v[108:109], v[108:109], s[46:47], v[18:19] op_sel_hi:[1,1,0] neg_lo:[0,0,1] neg_hi:[0,0,1]
v_pk_fma_f32 v[110:111], v[110:111], s[46:47], v[18:19] op_sel_hi:[1,1,0] neg_lo:[0,0,1] neg_hi:[0,0,1]
v_pk_fma_f32 v[112:113], v[112:113], s[46:47], v[18:19] op_sel_hi:[1,1,0] neg_lo:[0,0,1] neg_hi:[0,0,1]
v_pk_fma_f32 v[114:115], v[114:115], s[46:47], v[18:19] op_sel_hi:[1,1,0] neg_lo:[0,0,1] neg_hi:[0,0,1]
v_pk_fma_f32 v[116:117], v[116:117], s[46:47], v[18:19] op_sel_hi:[1,1,0] neg_lo:[0,0,1] neg_hi:[0,0,1]
v_pk_fma_f32 v[118:119], v[118:119], s[46:47], v[18:19] op_sel_hi:[1,1,0] neg_lo:[0,0,1] neg_hi:[0,0,1]
v_pk_fma_f32 v[120:121], v[120:121], s[46:47], v[18:19] op_sel_hi:[1,1,0] neg_lo:[0,0,1] neg_hi:[0,0,1]
v_pk_fma_f32 v[122:123], v[122:123], s[46:47], v[18:19] op_sel_hi:[1,1,0] neg_lo:[0,0,1] neg_hi:[0,0,1]
v_pk_fma_f32 v[124:125], v[124:125], s[46:47], v[18:19] op_sel_hi:[1,1,0] neg_lo:[0,0,1] neg_hi:[0,0,1]
v_pk_fma_f32 v[126:127], v[126:127], s[46:47], v[18:19] op_sel_hi:[1,1,0] neg_lo:[0,0,1] neg_hi:[0,0,1]
v_pk_fma_f32 v[128:129], v[128:129], s[46:47], v[18:19] op_sel_hi:[1,1,0] neg_lo:[0,0,1] neg_hi:[0,0,1]
v_pk_fma_f32 v[130:131], v[130:131], s[46:47], v[18:19] op_sel_hi:[1,1,0] neg_lo:[0,0,1] neg_hi:[0,0,1]
v_pk_fma_f32 v[132:133], v[132:133], s[46:47], v[18:19] op_sel_hi:[1,1,0] neg_lo:[0,0,1] neg_hi:[0,0,1]
v_pk_fma_f32 v[134:135], v[134:135], s[46:47], v[18:19] op_sel_hi:[1,1,0] neg_lo:[0,0,1] neg_hi:[0,0,1]
v_pk_fma_f32 v[136:137], v[136:137], s[46:47], v[18:19] op_sel_hi:[1,1,0] neg_lo:[0,0,1] neg_hi:[0,0,1]
v_pk_fma_f32 v[138:139], v[138:139], s[46:47], v[18:19] op_sel_hi:[1,1,0] neg_lo:[0,0,1] neg_hi:[0,0,1]
v_pk_fma_f32 v[140:141], v[140:141], s[46:47], v[18:19] op_sel_hi:[1,1,0] neg_lo:[0,0,1] neg_hi:[0,0,1]
v_pk_fma_f32 v[142:143], v[142:143], s[46:47], v[18:19] op_sel_hi:[1,1,0] neg_lo:[0,0,1] neg_hi:[0,0,1]
v_pk_fma_f32 v[144:145], v[144:145], s[46:47], v[18:19] op_sel_hi:[1,1,0] neg_lo:[0,0,1] neg_hi:[0,0,1]
v_pk_fma_f32 v[146:147], v[146:147], s[46:47], v[18:19] op_sel_hi:[1,1,0] neg_lo:[0,0,1] neg_hi:[0,0,1]
v_pk_fma_f32 v[148:149], v[148:149], s[46:47], v[18:19] op_sel_hi:[1,1,0] neg_lo:[0,0,1] neg_hi:[0,0,1]
v_pk_fma_f32 v[150:151], v[150:151], s[46:47], v[18:19] op_sel_hi:[1,1,0] neg_lo:[0,0,1] neg_hi:[0,0,1]
v_pk_fma_f32 v[152:153], v[152:153], s[46:47], v[18:19] op_sel_hi:[1,1,0] neg_lo:[0,0,1] neg_hi:[0,0,1]
v_pk_fma_f32 v[154:155], v[154:155], s[46:47], v[18:19] op_sel_hi:[1,1,0] neg_lo:[0,0,1] neg_hi:[0,0,1]
v_pk_fma_f32 v[156:157], v[156:157], s[46:47], v[18:19] op_sel_hi:[1,1,0] neg_lo:[0,0,1] neg_hi:[0,0,1]
v_pk_fma_f32 v[158:159], v[158:159], s[46:47], v[18:19] op_sel_hi:[1,1,0] neg_lo:[0,0,1] neg_hi:[0,0,1]
v_pk_fma_f32 v[160:161], v[160:161], s[46:47], v[18:19] op_sel_hi:[1,1,0] neg_lo:[0,0,1] neg_hi:[0,0,1]
v_pk_fma_f32 v[162:163], v[162:163], s[46:47], v[18:19] op_sel_hi:[1,1,0] neg_lo:[0,0,1] neg_hi:[0,0,1]
s_waitcnt lgkmcnt(0)
v_exp_f32 v96, v96
v_mfma_f32_16x16x32_bf16 v[172:175], a[100:103], v[36:39], v[48:51]
v_exp_f32 v97, v97
v_exp_f32 v98, v98
buffer_store_dwordx4 a[36:39], v2, s[20:23], s39 offen offset:1024 sc1
v_exp_f32_e64 v99, v99
v_mfma_f32_16x16x32_bf16 v[176:179], a[104:107], v[36:39], v[240:243]
v_exp_f32 v100, v100
v_exp_f32 v101, v101
v_exp_f32 v102, v102
v_mfma_f32_16x16x32_bf16 v[180:183], a[108:111], v[36:39], v[240:243]
v_exp_f32 v103, v103
v_cvt_pk_bf16_f32 v96, v96, v97
v_cvt_pk_bf16_f32 v97, v98, v99
v_mfma_f32_16x16x32_bf16 v[184:187], a[112:115], v[36:39], v[244:247]
v_exp_f32 v104, v104
v_exp_f32 v105, v105
v_exp_f32 v106, v106
v_mfma_f32_16x16x32_bf16 v[188:191], a[116:119], v[36:39], v[244:247]
v_exp_f32 v107, v107
v_cvt_pk_bf16_f32 v98, v100, v101
v_cvt_pk_bf16_f32 v99, v102, v103
v_mfma_f32_16x16x32_bf16 v[192:195], a[120:123], v[36:39], v[244:247]
v_exp_f32 v108, v108
v_exp_f32 v109, v109
v_exp_f32 v110, v110
v_mfma_f32_16x16x32_bf16 v[196:199], a[124:127], v[36:39], v[244:247]
v_exp_f32 v111, v111
v_cvt_pk_bf16_f32 v104, v104, v105
v_cvt_pk_bf16_f32 v105, v106, v107
v_mfma_f32_16x16x32_bf16 v[200:203], a[128:131], v[36:39], v[248:251]
v_exp_f32 v112, v112
v_exp_f32 v113, v113
v_exp_f32 v114, v114
v_mfma_f32_16x16x32_bf16 v[204:207], a[132:135], v[36:39], v[248:251]
v_exp_f32 v115, v115
v_cvt_pk_bf16_f32 v106, v108, v109
v_cvt_pk_bf16_f32 v107, v110, v111
v_mfma_f32_16x16x32_bf16 v[208:211], a[136:139], v[36:39], v[248:251]
v_exp_f32 v116, v116
v_exp_f32 v117, v117
v_exp_f32 v118, v118
v_mfma_f32_16x16x32_bf16 v[212:215], a[140:143], v[36:39], v[248:251]
v_exp_f32 v119, v119
v_cvt_pk_bf16_f32 v112, v112, v113
v_cvt_pk_bf16_f32 v113, v114, v115
v_mfma_f32_16x16x32_bf16 v[216:219], a[144:147], v[36:39], v[252:255]
v_exp_f32_e64 v120, v120
buffer_store_dwordx4 a[40:43], v2, s[20:23], s39 offen offset:2048 sc1
v_exp_f32 v121, v121
v_exp_f32 v122, v122
v_mfma_f32_16x16x32_bf16 v[220:223], a[148:151], v[36:39], v[252:255]
v_exp_f32_e64 v123, v123
v_cvt_pk_bf16_f32 v114, v116, v117
v_cvt_pk_bf16_f32 v115, v118, v119
v_mfma_f32_16x16x32_bf16 v[224:227], a[152:155], v[36:39], v[252:255]
v_exp_f32 v124, v124
v_exp_f32 v125, v125
v_exp_f32 v126, v126
v_mfma_f32_16x16x32_bf16 v[228:231], a[156:159], v[36:39], v[252:255]
v_exp_f32 v127, v127
v_cvt_pk_bf16_f32 v120, v120, v121
v_cvt_pk_bf16_f32 v121, v122, v123
v_mfma_f32_16x16x32_bf16 v[232:235], a[160:163], v[36:39], 0
v_exp_f32 v128, v128
v_exp_f32 v129, v129
v_exp_f32 v130, v130
v_mfma_f32_16x16x32_bf16 v[236:239], a[164:167], v[36:39], v[52:55]
v_exp_f32 v131, v131
v_cvt_pk_bf16_f32 v122, v124, v125
v_cvt_pk_bf16_f32 v123, v126, v127
v_exp_f32 v132, v132
v_exp_f32 v133, v133
v_exp_f32 v134, v134
v_exp_f32 v135, v135
v_cvt_pk_bf16_f32 v128, v128, v129
v_cvt_pk_bf16_f32 v129, v130, v131
v_exp_f32 v136, v136
v_exp_f32 v137, v137
v_exp_f32 v138, v138
v_exp_f32 v139, v139
v_cvt_pk_bf16_f32 v130, v132, v133
v_cvt_pk_bf16_f32 v131, v134, v135
v_exp_f32 v140, v140
v_exp_f32 v141, v141
v_exp_f32_e64 v142, v142
buffer_store_dwordx2 a[44:45], v9, s[20:23], s43 offen sc1
v_exp_f32 v143, v143
v_cvt_pk_bf16_f32 v136, v136, v137
v_cvt_pk_bf16_f32 v137, v138, v139
v_exp_f32 v144, v144
v_exp_f32 v145, v145
v_exp_f32 v146, v146
v_exp_f32 v147, v147
v_cvt_pk_bf16_f32 v138, v140, v141
v_cvt_pk_bf16_f32 v139, v142, v143
v_exp_f32 v148, v148
v_exp_f32 v149, v149
v_exp_f32 v150, v150
v_exp_f32 v151, v151
v_cvt_pk_bf16_f32 v144, v144, v145
v_cvt_pk_bf16_f32 v145, v146, v147
v_exp_f32 v152, v152
v_exp_f32 v153, v153
v_exp_f32 v154, v154
v_exp_f32 v155, v155
v_cvt_pk_bf16_f32 v146, v148, v149
v_cvt_pk_bf16_f32 v147, v150, v151
v_exp_f32 v156, v156
v_exp_f32 v157, v157
v_exp_f32 v158, v158
v_exp_f32 v159, v159
v_cvt_pk_bf16_f32 v152, v152, v153
v_cvt_pk_bf16_f32 v153, v154, v155
v_exp_f32 v160, v160
v_exp_f32 v161, v161
v_exp_f32 v162, v162
v_exp_f32_e64 v163, v163
v_cvt_pk_bf16_f32 v154, v156, v157
v_cvt_pk_bf16_f32 v155, v158, v159
v_cvt_pk_bf16_f32 v160, v160, v161
v_cvt_pk_bf16_f32 v161, v162, v163
v_mov_b32 v162, 0
v_mov_b32 v163, 0
v_max_f32 v18, v172, v173
v_max_f32 v19, v174, v175
v_mfma_f32_16x16x32_bf16 v[60:63], a[176:179], v[96:99], 0
v_max3_f32 v18, v18, v176, v177
v_max3_f32 v19, v19, v178, v179
v_mfma_f32_16x16x32_bf16 v[64:67], a[180:183], v[96:99], 0
v_max3_f32 v18, v18, v180, v181
v_max3_f32 v19, v19, v182, v183
v_mfma_f32_16x16x32_bf16 v[68:71], v[56:59], v[96:99], 0
v_max3_f32 v18, v18, v184, v185
v_max3_f32 v19, v19, v186, v187
v_mfma_f32_16x16x32_bf16 v[60:63], a[184:187], v[104:107], v[60:63]
v_max3_f32 v18, v18, v188, v189
v_max3_f32 v19, v19, v190, v191
v_mfma_f32_16x16x32_bf16 v[64:67], a[188:191], v[104:107], v[64:67]
v_max3_f32 v18, v18, v192, v193
v_max3_f32 v19, v19, v194, v195
v_mfma_f32_16x16x32_bf16 v[68:71], v[56:59], v[104:107], v[68:71]
v_max3_f32 v18, v18, v196, v197
v_max3_f32 v19, v19, v198, v199
v_mfma_f32_16x16x32_bf16 v[60:63], a[192:195], v[112:115], v[60:63]
v_max3_f32 v18, v18, v200, v201
v_max3_f32 v19, v19, v202, v203
v_mfma_f32_16x16x32_bf16 v[64:67], a[196:199], v[112:115], v[64:67]
v_max3_f32 v18, v18, v204, v205
v_max3_f32 v19, v19, v206, v207
v_mfma_f32_16x16x32_bf16 v[68:71], v[56:59], v[112:115], v[68:71]
v_max3_f32 v18, v18, v208, v209
v_max3_f32 v19, v19, v210, v211
v_mfma_f32_16x16x32_bf16 v[60:63], a[200:203], v[120:123], v[60:63]
v_max3_f32 v18, v18, v212, v213
v_max3_f32 v19, v19, v214, v215
v_mfma_f32_16x16x32_bf16 v[64:67], a[204:207], v[120:123], v[64:67]
v_max3_f32 v18, v18, v216, v217
v_max3_f32 v19, v19, v218, v219
v_mfma_f32_16x16x32_bf16 v[68:71], v[56:59], v[120:123], v[68:71]
v_max3_f32 v18, v18, v220, v221
v_max3_f32 v19, v19, v222, v223
v_mfma_f32_16x16x32_bf16 v[60:63], a[208:211], v[128:131], v[60:63]
v_max3_f32 v18, v18, v224, v225
v_max3_f32 v19, v19, v226, v227
v_mfma_f32_16x16x32_bf16 v[64:67], a[212:215], v[128:131], v[64:67]
v_max3_f32 v18, v18, v228, v229
v_max3_f32 v19, v19, v230, v231
v_mfma_f32_16x16x32_bf16 v[68:71], v[56:59], v[128:131], v[68:71]
v_max3_f32 v18, v18, v232, v233
v_max3_f32 v19, v19, v234, v235
v_mfma_f32_16x16x32_bf16 v[60:63], a[216:219], v[136:139], v[60:63]
v_max3_f32 v18, v18, v236, v237
v_max3_f32 v19, v19, v238, v239
v_max_f32 v18, v18, v19
v_mov_b32 v19, v18
s_nop 1
v_permlane32_swap_b32 v19, v18
v_max_f32 v18, v18, v19
v_mov_b32 v19, v18
s_nop 1
v_permlane16_swap_b32 v19, v18
v_max_f32 v18, v18, v19
v_mul_f32 v18, s46, v18
v_pk_fma_f32 v[172:173], v[172:173], s[46:47], v[18:19] op_sel_hi:[1,1,0] neg_lo:[0,0,1] neg_hi:[0,0,1]
v_pk_fma_f32 v[174:175], v[174:175], s[46:47], v[18:19] op_sel_hi:[1,1,0] neg_lo:[0,0,1] neg_hi:[0,0,1]
v_pk_fma_f32 v[176:177], v[176:177], s[46:47], v[18:19] op_sel_hi:[1,1,0] neg_lo:[0,0,1] neg_hi:[0,0,1]
s_waitcnt vmcnt(0)
buffer_store_dword v28, v29, s[32:35], s70 offen offset:32 sc1
v_pk_fma_f32 v[178:179], v[178:179], s[46:47], v[18:19] op_sel_hi:[1,1,0] neg_lo:[0,0,1] neg_hi:[0,0,1]
v_pk_fma_f32 v[180:181], v[180:181], s[46:47], v[18:19] op_sel_hi:[1,1,0] neg_lo:[0,0,1] neg_hi:[0,0,1]
v_pk_fma_f32 v[182:183], v[182:183], s[46:47], v[18:19] op_sel_hi:[1,1,0] neg_lo:[0,0,1] neg_hi:[0,0,1]
v_pk_fma_f32 v[184:185], v[184:185], s[46:47], v[18:19] op_sel_hi:[1,1,0] neg_lo:[0,0,1] neg_hi:[0,0,1]
v_pk_fma_f32 v[186:187], v[186:187], s[46:47], v[18:19] op_sel_hi:[1,1,0] neg_lo:[0,0,1] neg_hi:[0,0,1]
v_pk_fma_f32 v[188:189], v[188:189], s[46:47], v[18:19] op_sel_hi:[1,1,0] neg_lo:[0,0,1] neg_hi:[0,0,1]
v_pk_fma_f32 v[190:191], v[190:191], s[46:47], v[18:19] op_sel_hi:[1,1,0] neg_lo:[0,0,1] neg_hi:[0,0,1]
v_pk_fma_f32 v[192:193], v[192:193], s[46:47], v[18:19] op_sel_hi:[1,1,0] neg_lo:[0,0,1] neg_hi:[0,0,1]
v_pk_fma_f32 v[194:195], v[194:195], s[46:47], v[18:19] op_sel_hi:[1,1,0] neg_lo:[0,0,1] neg_hi:[0,0,1]
v_pk_fma_f32 v[196:197], v[196:197], s[46:47], v[18:19] op_sel_hi:[1,1,0] neg_lo:[0,0,1] neg_hi:[0,0,1]
v_pk_fma_f32 v[198:199], v[198:199], s[46:47], v[18:19] op_sel_hi:[1,1,0] neg_lo:[0,0,1] neg_hi:[0,0,1]
v_pk_fma_f32 v[200:201], v[200:201], s[46:47], v[18:19] op_sel_hi:[1,1,0] neg_lo:[0,0,1] neg_hi:[0,0,1]
v_pk_fma_f32 v[202:203], v[202:203], s[46:47], v[18:19] op_sel_hi:[1,1,0] neg_lo:[0,0,1] neg_hi:[0,0,1]
v_pk_fma_f32 v[204:205], v[204:205], s[46:47], v[18:19] op_sel_hi:[1,1,0] neg_lo:[0,0,1] neg_hi:[0,0,1]
v_pk_fma_f32 v[206:207], v[206:207], s[46:47], v[18:19] op_sel_hi:[1,1,0] neg_lo:[0,0,1] neg_hi:[0,0,1]
v_pk_fma_f32 v[208:209], v[208:209], s[46:47], v[18:19] op_sel_hi:[1,1,0] neg_lo:[0,0,1] neg_hi:[0,0,1]
v_pk_fma_f32 v[210:211], v[210:211], s[46:47], v[18:19] op_sel_hi:[1,1,0] neg_lo:[0,0,1] neg_hi:[0,0,1]
s_barrier
v_pk_fma_f32 v[212:213], v[212:213], s[46:47], v[18:19] op_sel_hi:[1,1,0] neg_lo:[0,0,1] neg_hi:[0,0,1]
v_pk_fma_f32 v[214:215], v[214:215], s[46:47], v[18:19] op_sel_hi:[1,1,0] neg_lo:[0,0,1] neg_hi:[0,0,1]
v_pk_fma_f32 v[216:217], v[216:217], s[46:47], v[18:19] op_sel_hi:[1,1,0] neg_lo:[0,0,1] neg_hi:[0,0,1]
v_pk_fma_f32 v[218:219], v[218:219], s[46:47], v[18:19] op_sel_hi:[1,1,0] neg_lo:[0,0,1] neg_hi:[0,0,1]
v_pk_fma_f32 v[220:221], v[220:221], s[46:47], v[18:19] op_sel_hi:[1,1,0] neg_lo:[0,0,1] neg_hi:[0,0,1]
v_pk_fma_f32 v[222:223], v[222:223], s[46:47], v[18:19] op_sel_hi:[1,1,0] neg_lo:[0,0,1] neg_hi:[0,0,1]
v_pk_fma_f32 v[224:225], v[224:225], s[46:47], v[18:19] op_sel_hi:[1,1,0] neg_lo:[0,0,1] neg_hi:[0,0,1]
v_pk_fma_f32 v[226:227], v[226:227], s[46:47], v[18:19] op_sel_hi:[1,1,0] neg_lo:[0,0,1] neg_hi:[0,0,1]
v_pk_fma_f32 v[228:229], v[228:229], s[46:47], v[18:19] op_sel_hi:[1,1,0] neg_lo:[0,0,1] neg_hi:[0,0,1]
v_pk_fma_f32 v[230:231], v[230:231], s[46:47], v[18:19] op_sel_hi:[1,1,0] neg_lo:[0,0,1] neg_hi:[0,0,1]
v_pk_fma_f32 v[232:233], v[232:233], s[46:47], v[18:19] op_sel_hi:[1,1,0] neg_lo:[0,0,1] neg_hi:[0,0,1]
v_pk_fma_f32 v[234:235], v[234:235], s[46:47], v[18:19] op_sel_hi:[1,1,0] neg_lo:[0,0,1] neg_hi:[0,0,1]
v_pk_fma_f32 v[236:237], v[236:237], s[46:47], v[18:19] op_sel_hi:[1,1,0] neg_lo:[0,0,1] neg_hi:[0,0,1]
v_pk_fma_f32 v[238:239], v[238:239], s[46:47], v[18:19] op_sel_hi:[1,1,0] neg_lo:[0,0,1] neg_hi:[0,0,1]
v_exp_f32 v172, v172
v_mfma_f32_16x16x32_bf16 v[64:67], a[220:223], v[136:139], v[64:67]
v_exp_f32 v173, v173
v_exp_f32_e64 v174, v174
s_add_u32 m0, s44, 98560
s_nop 0
buffer_load_dwordx4 v84, s[72:75], s76 offen offset:0 lds
v_exp_f32 v175, v175
v_mfma_f32_16x16x32_bf16 v[68:71], v[56:59], v[136:139], v[68:71]
v_mov_b32 v168, 0
v_mov_b32 v169, 0
v_exp_f32 v176, v176
v_mfma_f32_16x16x32_bf16 v[60:63], a[224:227], v[144:147], v[60:63]
v_exp_f32 v177, v177
v_exp_f32 v178, v178
v_exp_f32 v179, v179
v_mfma_f32_16x16x32_bf16 v[64:67], a[228:231], v[144:147], v[64:67]
v_cvt_pk_bf16_f32 v170, v172, v173
v_cvt_pk_bf16_f32 v171, v174, v175
v_exp_f32_e64 v180, v180
v_mfma_f32_16x16x32_bf16 v[68:71], v[56:59], v[144:147], v[68:71]
v_exp_f32 v181, v181
v_exp_f32 v182, v182
buffer_load_dwordx4 v85, s[72:75], s76 offen offset:1024 lds
v_exp_f32_e64 v183, v183
v_mfma_f32_16x16x32_bf16 v[60:63], a[232:235], v[152:155], v[60:63]
v_cvt_pk_bf16_f32 v176, v176, v177
v_cvt_pk_bf16_f32 v177, v178, v179
v_exp_f32_e64 v184, v184
v_mfma_f32_16x16x32_bf16 v[64:67], a[236:239], v[152:155], v[64:67]
v_exp_f32 v185, v185
v_exp_f32 v186, v186
v_exp_f32_e64 v187, v187
v_mfma_f32_16x16x32_bf16 v[68:71], v[56:59], v[152:155], v[68:71]
v_cvt_pk_bf16_f32 v178, v180, v181
v_cvt_pk_bf16_f32 v179, v182, v183
v_exp_f32 v188, v188
v_mfma_f32_16x16x32_bf16 v[60:63], a[240:243], v[160:163], v[60:63]
v_exp_f32 v189, v189
v_exp_f32 v190, v190
buffer_load_dwordx4 v86, s[72:75], s76 offen offset:2048 lds
v_exp_f32 v191, v191
v_mfma_f32_16x16x32_bf16 v[64:67], a[244:247], v[160:163], v[64:67]
v_cvt_pk_bf16_f32 v184, v184, v185
v_cvt_pk_bf16_f32 v185, v186, v187
v_exp_f32 v192, v192
v_mfma_f32_16x16x32_bf16 v[68:71], v[56:59], v[160:163], v[68:71]
v_exp_f32 v193, v193
v_exp_f32 v194, v194
v_exp_f32 v195, v195
v_mfma_f32_16x16x32_bf16 v[96:99], a[104:107], v[40:43], v[48:51]
v_cvt_pk_bf16_f32 v186, v188, v189
v_cvt_pk_bf16_f32 v187, v190, v191
v_exp_f32_e64 v196, v196
v_mfma_f32_16x16x32_bf16 v[100:103], a[108:111], v[40:43], v[240:243]
v_exp_f32 v197, v197
v_exp_f32 v198, v198
buffer_load_dwordx4 v87, s[72:75], s76 offen offset:3072 lds
v_exp_f32_e64 v199, v199
v_mfma_f32_16x16x32_bf16 v[104:107], a[112:115], v[40:43], v[244:247]
v_cvt_pk_bf16_f32 v192, v192, v193
v_cvt_pk_bf16_f32 v193, v194, v195
v_exp_f32_e64 v200, v200
v_mfma_f32_16x16x32_bf16 v[108:111], a[116:119], v[40:43], v[244:247]
v_rcp_f32 v20, v68
v_exp_f32 v201, v201
v_exp_f32 v202, v202
v_exp_f32 v203, v203
v_mfma_f32_16x16x32_bf16 v[112:115], a[120:123], v[40:43], v[244:247]
v_mul_f32 v60, v20, v60
v_cvt_pk_bf16_f32 v194, v196, v197
v_cvt_pk_bf16_f32 v195, v198, v199
v_exp_f32 v204, v204
v_mfma_f32_16x16x32_bf16 v[116:119], a[124:127], v[40:43], v[244:247]
v_mul_f32 v61, v20, v61
v_exp_f32 v205, v205
v_exp_f32 v206, v206
s_add_u32 m0, s44, 102656
s_nop 0
buffer_load_dwordx4 v84, s[72:75], s79 offen offset:0 lds
v_exp_f32 v207, v207
v_mfma_f32_16x16x32_bf16 v[120:123], a[128:131], v[40:43], v[248:251]
v_mul_f32 v62, v20, v62
v_cvt_pk_bf16_f32 v200, v200, v201
v_cvt_pk_bf16_f32 v201, v202, v203
v_exp_f32 v208, v208
v_mfma_f32_16x16x32_bf16 v[124:127], a[132:135], v[40:43], v[248:251]
v_mul_f32 v63, v20, v63
v_exp_f32 v209, v209
v_exp_f32 v210, v210
v_exp_f32_e64 v211, v211
v_mfma_f32_16x16x32_bf16 v[128:131], a[136:139], v[40:43], v[248:251]
v_mul_f32 v64, v20, v64
v_cvt_pk_bf16_f32 v202, v204, v205
v_cvt_pk_bf16_f32 v203, v206, v207
v_exp_f32 v212, v212
v_mfma_f32_16x16x32_bf16 v[132:135], a[140:143], v[40:43], v[248:251]
v_mul_f32 v65, v20, v65
v_exp_f32 v213, v213
v_exp_f32 v214, v214
buffer_load_dwordx4 v85, s[72:75], s79 offen offset:1024 lds
v_exp_f32 v215, v215
v_mfma_f32_16x16x32_bf16 v[136:139], a[144:147], v[40:43], v[252:255]
v_mul_f32 v66, v20, v66
v_cvt_pk_bf16_f32 v208, v208, v209
v_cvt_pk_bf16_f32 v209, v210, v211
v_exp_f32 v216, v216
v_mfma_f32_16x16x32_bf16 v[140:143], a[148:151], v[40:43], v[252:255]
v_mul_f32 v67, v20, v67
v_exp_f32 v217, v217
v_exp_f32 v218, v218
v_exp_f32 v219, v219
v_mfma_f32_16x16x32_bf16 v[144:147], a[152:155], v[40:43], v[252:255]
v_cvt_pk_bf16_f32 v4, v60, v61
v_cvt_pk_bf16_f32 v210, v212, v213
v_cvt_pk_bf16_f32 v211, v214, v215
v_exp_f32_e64 v220, v220
v_mfma_f32_16x16x32_bf16 v[148:151], a[156:159], v[40:43], v[252:255]
v_cvt_pk_bf16_f32 v5, v62, v63
v_exp_f32 v221, v221
v_exp_f32 v222, v222
buffer_load_dwordx4 v86, s[72:75], s79 offen offset:2048 lds
v_exp_f32_e64 v223, v223
v_mfma_f32_16x16x32_bf16 v[152:155], a[160:163], v[40:43], 0
v_cvt_pk_bf16_f32 v6, v64, v65
v_cvt_pk_bf16_f32 v216, v216, v217
v_cvt_pk_bf16_f32 v217, v218, v219
v_exp_f32 v224, v224
v_mfma_f32_16x16x32_bf16 v[156:159], a[164:167], v[40:43], 0
v_cvt_pk_bf16_f32 v7, v66, v67
v_exp_f32 v225, v225
v_exp_f32 v226, v226
v_exp_f32 v227, v227
v_mfma_f32_16x16x32_bf16 v[160:163], a[168:171], v[40:43], v[52:55]
buffer_store_dwordx4 v[4:7], v2, s[20:23], s8 offen sc1
v_cvt_pk_bf16_f32 v218, v220, v221
v_cvt_pk_bf16_f32 v219, v222, v223
v_exp_f32 v228, v228
v_exp_f32 v229, v229
v_exp_f32_e64 v230, v230
buffer_load_dwordx4 v87, s[72:75], s79 offen offset:3072 lds
s_add_u32 s76, s76, 262144
s_add_u32 s79, s79, 262144
v_exp_f32_e64 v231, v231
v_cvt_pk_bf16_f32 v224, v224, v225
v_cvt_pk_bf16_f32 v225, v226, v227
v_exp_f32 v232, v232
v_exp_f32 v233, v233
v_exp_f32 v234, v234
v_exp_f32 v235, v235
v_cvt_pk_bf16_f32 v226, v228, v229
v_cvt_pk_bf16_f32 v227, v230, v231
v_exp_f32 v236, v236
v_exp_f32 v237, v237
v_exp_f32 v238, v238
v_exp_f32 v239, v239
v_cvt_pk_bf16_f32 v232, v232, v233
v_cvt_pk_bf16_f32 v233, v234, v235
v_cvt_pk_bf16_f32 v234, v236, v237
v_cvt_pk_bf16_f32 v235, v238, v239
v_max_f32 v18, v96, v97
v_max_f32 v19, v98, v99
v_mfma_f32_16x16x32_bf16 v[72:75], a[176:179], v[168:171], 0
v_max3_f32 v18, v18, v100, v101
v_max3_f32 v19, v19, v102, v103
v_mfma_f32_16x16x32_bf16 v[76:79], a[180:183], v[168:171], 0
v_max3_f32 v18, v18, v104, v105
v_max3_f32 v19, v19, v106, v107
v_mfma_f32_16x16x32_bf16 v[80:83], v[56:59], v[168:171], 0
v_max3_f32 v18, v18, v108, v109
v_max3_f32 v19, v19, v110, v111
v_mfma_f32_16x16x32_bf16 v[72:75], a[184:187], v[176:179], v[72:75]
v_max3_f32 v18, v18, v112, v113
v_max3_f32 v19, v19, v114, v115
v_mfma_f32_16x16x32_bf16 v[76:79], a[188:191], v[176:179], v[76:79]
v_max3_f32 v18, v18, v116, v117
v_max3_f32 v19, v19, v118, v119
v_mfma_f32_16x16x32_bf16 v[80:83], v[56:59], v[176:179], v[80:83]
v_max3_f32 v18, v18, v120, v121
v_max3_f32 v19, v19, v122, v123
v_mfma_f32_16x16x32_bf16 v[72:75], a[192:195], v[184:187], v[72:75]
v_max3_f32 v18, v18, v124, v125
v_max3_f32 v19, v19, v126, v127
v_mfma_f32_16x16x32_bf16 v[76:79], a[196:199], v[184:187], v[76:79]
v_max3_f32 v18, v18, v128, v129
v_max3_f32 v19, v19, v130, v131
v_mfma_f32_16x16x32_bf16 v[80:83], v[56:59], v[184:187], v[80:83]
v_max3_f32 v18, v18, v132, v133
v_max3_f32 v19, v19, v134, v135
v_mfma_f32_16x16x32_bf16 v[72:75], a[200:203], v[192:195], v[72:75]
v_max3_f32 v18, v18, v136, v137
v_max3_f32 v19, v19, v138, v139
v_mfma_f32_16x16x32_bf16 v[76:79], a[204:207], v[192:195], v[76:79]
v_max3_f32 v18, v18, v140, v141
v_max3_f32 v19, v19, v142, v143
v_mfma_f32_16x16x32_bf16 v[80:83], v[56:59], v[192:195], v[80:83]
v_max3_f32 v18, v18, v144, v145
v_max3_f32 v19, v19, v146, v147
v_mfma_f32_16x16x32_bf16 v[72:75], a[208:211], v[200:203], v[72:75]
v_max3_f32 v18, v18, v148, v149
v_max3_f32 v19, v19, v150, v151
v_mfma_f32_16x16x32_bf16 v[76:79], a[212:215], v[200:203], v[76:79]
v_max3_f32 v18, v18, v152, v153
v_max3_f32 v19, v19, v154, v155
v_mfma_f32_16x16x32_bf16 v[80:83], v[56:59], v[200:203], v[80:83]
v_max3_f32 v18, v18, v156, v157
v_max3_f32 v19, v19, v158, v159
v_mfma_f32_16x16x32_bf16 v[72:75], a[216:219], v[208:211], v[72:75]
v_max3_f32 v18, v18, v160, v161
v_max3_f32 v19, v19, v162, v163
v_max_f32 v18, v18, v19
v_mov_b32 v19, v18
s_nop 1
v_permlane32_swap_b32 v19, v18
v_max_f32 v18, v18, v19
v_mov_b32 v19, v18
s_nop 1
v_permlane16_swap_b32 v19, v18
v_max_f32 v18, v18, v19
v_mul_f32 v18, s46, v18
v_pk_fma_f32 v[96:97], v[96:97], s[46:47], v[18:19] op_sel_hi:[1,1,0] neg_lo:[0,0,1] neg_hi:[0,0,1]
v_pk_fma_f32 v[98:99], v[98:99], s[46:47], v[18:19] op_sel_hi:[1,1,0] neg_lo:[0,0,1] neg_hi:[0,0,1]
v_pk_fma_f32 v[100:101], v[100:101], s[46:47], v[18:19] op_sel_hi:[1,1,0] neg_lo:[0,0,1] neg_hi:[0,0,1]
s_add_u32 m0, s44, 256
s_nop 0
buffer_load_dwordx4 v84, s[72:75], s76 offen offset:0 lds
v_pk_fma_f32 v[102:103], v[102:103], s[46:47], v[18:19] op_sel_hi:[1,1,0] neg_lo:[0,0,1] neg_hi:[0,0,1]
v_pk_fma_f32 v[104:105], v[104:105], s[46:47], v[18:19] op_sel_hi:[1,1,0] neg_lo:[0,0,1] neg_hi:[0,0,1]
v_pk_fma_f32 v[106:107], v[106:107], s[46:47], v[18:19] op_sel_hi:[1,1,0] neg_lo:[0,0,1] neg_hi:[0,0,1]
v_pk_fma_f32 v[108:109], v[108:109], s[46:47], v[18:19] op_sel_hi:[1,1,0] neg_lo:[0,0,1] neg_hi:[0,0,1]
v_pk_fma_f32 v[110:111], v[110:111], s[46:47], v[18:19] op_sel_hi:[1,1,0] neg_lo:[0,0,1] neg_hi:[0,0,1]
v_pk_fma_f32 v[112:113], v[112:113], s[46:47], v[18:19] op_sel_hi:[1,1,0] neg_lo:[0,0,1] neg_hi:[0,0,1]
v_pk_fma_f32 v[114:115], v[114:115], s[46:47], v[18:19] op_sel_hi:[1,1,0] neg_lo:[0,0,1] neg_hi:[0,0,1]
v_pk_fma_f32 v[116:117], v[116:117], s[46:47], v[18:19] op_sel_hi:[1,1,0] neg_lo:[0,0,1] neg_hi:[0,0,1]
v_pk_fma_f32 v[118:119], v[118:119], s[46:47], v[18:19] op_sel_hi:[1,1,0] neg_lo:[0,0,1] neg_hi:[0,0,1]
v_pk_fma_f32 v[120:121], v[120:121], s[46:47], v[18:19] op_sel_hi:[1,1,0] neg_lo:[0,0,1] neg_hi:[0,0,1]
v_pk_fma_f32 v[122:123], v[122:123], s[46:47], v[18:19] op_sel_hi:[1,1,0] neg_lo:[0,0,1] neg_hi:[0,0,1]
v_pk_fma_f32 v[124:125], v[124:125], s[46:47], v[18:19] op_sel_hi:[1,1,0] neg_lo:[0,0,1] neg_hi:[0,0,1]
v_pk_fma_f32 v[126:127], v[126:127], s[46:47], v[18:19] op_sel_hi:[1,1,0] neg_lo:[0,0,1] neg_hi:[0,0,1]
v_pk_fma_f32 v[128:129], v[128:129], s[46:47], v[18:19] op_sel_hi:[1,1,0] neg_lo:[0,0,1] neg_hi:[0,0,1]
v_pk_fma_f32 v[130:131], v[130:131], s[46:47], v[18:19] op_sel_hi:[1,1,0] neg_lo:[0,0,1] neg_hi:[0,0,1]
v_pk_fma_f32 v[132:133], v[132:133], s[46:47], v[18:19] op_sel_hi:[1,1,0] neg_lo:[0,0,1] neg_hi:[0,0,1]
v_pk_fma_f32 v[134:135], v[134:135], s[46:47], v[18:19] op_sel_hi:[1,1,0] neg_lo:[0,0,1] neg_hi:[0,0,1]
buffer_load_dwordx4 v85, s[72:75], s76 offen offset:1024 lds
v_pk_fma_f32 v[136:137], v[136:137], s[46:47], v[18:19] op_sel_hi:[1,1,0] neg_lo:[0,0,1] neg_hi:[0,0,1]
v_pk_fma_f32 v[138:139], v[138:139], s[46:47], v[18:19] op_sel_hi:[1,1,0] neg_lo:[0,0,1] neg_hi:[0,0,1]
v_pk_fma_f32 v[140:141], v[140:141], s[46:47], v[18:19] op_sel_hi:[1,1,0] neg_lo:[0,0,1] neg_hi:[0,0,1]
v_pk_fma_f32 v[142:143], v[142:143], s[46:47], v[18:19] op_sel_hi:[1,1,0] neg_lo:[0,0,1] neg_hi:[0,0,1]
v_pk_fma_f32 v[144:145], v[144:145], s[46:47], v[18:19] op_sel_hi:[1,1,0] neg_lo:[0,0,1] neg_hi:[0,0,1]
v_pk_fma_f32 v[146:147], v[146:147], s[46:47], v[18:19] op_sel_hi:[1,1,0] neg_lo:[0,0,1] neg_hi:[0,0,1]
v_pk_fma_f32 v[148:149], v[148:149], s[46:47], v[18:19] op_sel_hi:[1,1,0] neg_lo:[0,0,1] neg_hi:[0,0,1]
v_pk_fma_f32 v[150:151], v[150:151], s[46:47], v[18:19] op_sel_hi:[1,1,0] neg_lo:[0,0,1] neg_hi:[0,0,1]
v_pk_fma_f32 v[152:153], v[152:153], s[46:47], v[18:19] op_sel_hi:[1,1,0] neg_lo:[0,0,1] neg_hi:[0,0,1]
v_pk_fma_f32 v[154:155], v[154:155], s[46:47], v[18:19] op_sel_hi:[1,1,0] neg_lo:[0,0,1] neg_hi:[0,0,1]
v_pk_fma_f32 v[156:157], v[156:157], s[46:47], v[18:19] op_sel_hi:[1,1,0] neg_lo:[0,0,1] neg_hi:[0,0,1]
v_pk_fma_f32 v[158:159], v[158:159], s[46:47], v[18:19] op_sel_hi:[1,1,0] neg_lo:[0,0,1] neg_hi:[0,0,1]
v_pk_fma_f32 v[160:161], v[160:161], s[46:47], v[18:19] op_sel_hi:[1,1,0] neg_lo:[0,0,1] neg_hi:[0,0,1]
v_pk_fma_f32 v[162:163], v[162:163], s[46:47], v[18:19] op_sel_hi:[1,1,0] neg_lo:[0,0,1] neg_hi:[0,0,1]
v_exp_f32 v96, v96
v_mfma_f32_16x16x32_bf16 v[76:79], a[220:223], v[208:211], v[76:79]
v_exp_f32 v97, v97
v_exp_f32 v98, v98
buffer_load_dwordx4 v86, s[72:75], s76 offen offset:2048 lds
v_exp_f32 v99, v99
v_mfma_f32_16x16x32_bf16 v[80:83], v[56:59], v[208:211], v[80:83]
v_exp_f32 v100, v100
v_exp_f32 v101, v101
v_exp_f32 v102, v102
v_mfma_f32_16x16x32_bf16 v[72:75], a[224:227], v[216:219], v[72:75]
v_exp_f32_e64 v103, v103
v_cvt_pk_bf16_f32 v96, v96, v97
v_cvt_pk_bf16_f32 v97, v98, v99
v_mfma_f32_16x16x32_bf16 v[76:79], a[228:231], v[216:219], v[76:79]
v_exp_f32 v104, v104
v_exp_f32 v105, v105
v_exp_f32_e64 v106, v106
v_mfma_f32_16x16x32_bf16 v[80:83], v[56:59], v[216:219], v[80:83]
v_exp_f32_e64 v107, v107
v_cvt_pk_bf16_f32 v98, v100, v101
v_cvt_pk_bf16_f32 v99, v102, v103
v_mfma_f32_16x16x32_bf16 v[72:75], a[232:235], v[224:227], v[72:75]
v_exp_f32 v108, v108
v_exp_f32 v109, v109
v_exp_f32_e64 v110, v110
v_mfma_f32_16x16x32_bf16 v[76:79], a[236:239], v[224:227], v[76:79]
buffer_load_dwordx4 v87, s[72:75], s76 offen offset:3072 lds
v_exp_f32_e64 v111, v111
v_cvt_pk_bf16_f32 v104, v104, v105
v_cvt_pk_bf16_f32 v105, v106, v107
v_mfma_f32_16x16x32_bf16 v[80:83], v[56:59], v[224:227], v[80:83]
v_exp_f32 v112, v112
v_exp_f32 v113, v113
v_exp_f32 v114, v114
v_mfma_f32_16x16x32_bf16 v[72:75], a[240:243], v[232:235], v[72:75]
v_exp_f32 v115, v115
v_cvt_pk_bf16_f32 v106, v108, v109
v_cvt_pk_bf16_f32 v107, v110, v111
v_mfma_f32_16x16x32_bf16 v[76:79], a[244:247], v[232:235], v[76:79]
v_exp_f32 v116, v116
v_exp_f32 v117, v117
v_exp_f32 v118, v118
v_mfma_f32_16x16x32_bf16 v[80:83], v[56:59], v[232:235], v[80:83]
v_exp_f32 v119, v119
v_cvt_pk_bf16_f32 v112, v112, v113
v_cvt_pk_bf16_f32 v113, v114, v115
v_mfma_f32_16x16x32_bf16 v[172:175], a[108:111], v[44:47], v[48:51]
v_exp_f32 v120, v120
s_add_u32 m0, s44, 4352
s_nop 0
buffer_load_dwordx4 v84, s[72:75], s79 offen offset:0 lds
v_exp_f32 v121, v121
v_exp_f32 v122, v122
v_mfma_f32_16x16x32_bf16 v[176:179], a[112:115], v[44:47], v[244:247]
v_exp_f32_e64 v123, v123
v_cvt_pk_bf16_f32 v114, v116, v117
v_cvt_pk_bf16_f32 v115, v118, v119
v_mfma_f32_16x16x32_bf16 v[180:183], a[116:119], v[44:47], v[244:247]
v_exp_f32 v124, v124
v_exp_f32 v125, v125
v_exp_f32_e64 v126, v126
v_mfma_f32_16x16x32_bf16 v[184:187], a[120:123], v[44:47], v[244:247]
v_rcp_f32 v20, v80
v_exp_f32 v127, v127
v_cvt_pk_bf16_f32 v120, v120, v121
v_cvt_pk_bf16_f32 v121, v122, v123
v_mfma_f32_16x16x32_bf16 v[188:191], a[124:127], v[44:47], v[244:247]
v_mul_f32 v72, v20, v72
v_exp_f32 v128, v128
v_exp_f32 v129, v129
v_exp_f32 v130, v130
v_mfma_f32_16x16x32_bf16 v[192:195], a[128:131], v[44:47], v[248:251]
v_mul_f32 v73, v20, v73
v_exp_f32 v131, v131
v_cvt_pk_bf16_f32 v122, v124, v125
buffer_load_dwordx4 v85, s[72:75], s79 offen offset:1024 lds
v_cvt_pk_bf16_f32 v123, v126, v127
v_mfma_f32_16x16x32_bf16 v[196:199], a[132:135], v[44:47], v[248:251]
v_mul_f32 v74, v20, v74
v_exp_f32 v132, v132
v_exp_f32 v133, v133
v_exp_f32 v134, v134
v_mfma_f32_16x16x32_bf16 v[200:203], a[136:139], v[44:47], v[248:251]
v_mul_f32 v75, v20, v75
v_exp_f32 v135, v135
v_cvt_pk_bf16_f32 v128, v128, v129
v_cvt_pk_bf16_f32 v129, v130, v131
v_mfma_f32_16x16x32_bf16 v[204:207], a[140:143], v[44:47], v[248:251]
v_mul_f32 v76, v20, v76
v_exp_f32 v136, v136
v_exp_f32 v137, v137
v_exp_f32 v138, v138
v_mfma_f32_16x16x32_bf16 v[208:211], a[144:147], v[44:47], v[252:255]
v_mul_f32 v77, v20, v77
v_exp_f32 v139, v139
v_cvt_pk_bf16_f32 v130, v132, v133
v_cvt_pk_bf16_f32 v131, v134, v135
v_mfma_f32_16x16x32_bf16 v[212:215], a[148:151], v[44:47], v[252:255]
v_mul_f32 v78, v20, v78
v_exp_f32 v140, v140
v_exp_f32 v141, v141
v_exp_f32 v142, v142
v_mfma_f32_16x16x32_bf16 v[216:219], a[152:155], v[44:47], v[252:255]
v_mul_f32 v79, v20, v79
buffer_load_dwordx4 v86, s[72:75], s79 offen offset:2048 lds
v_exp_f32 v143, v143
v_cvt_pk_bf16_f32 v136, v136, v137
v_cvt_pk_bf16_f32 v137, v138, v139
v_mfma_f32_16x16x32_bf16 v[220:223], a[156:159], v[44:47], v[252:255]
v_cvt_pk_bf16_f32 v10, v72, v73
v_exp_f32 v144, v144
v_exp_f32 v145, v145
v_exp_f32 v146, v146
v_mfma_f32_16x16x32_bf16 v[224:227], a[160:163], v[44:47], 0
v_cvt_pk_bf16_f32 v11, v74, v75
v_exp_f32 v147, v147
v_cvt_pk_bf16_f32 v138, v140, v141
v_cvt_pk_bf16_f32 v139, v142, v143
v_mfma_f32_16x16x32_bf16 v[228:231], a[164:167], v[44:47], 0
v_cvt_pk_bf16_f32 v12, v76, v77
v_exp_f32 v148, v148
v_exp_f32 v149, v149
v_exp_f32 v150, v150
v_mfma_f32_16x16x32_bf16 v[232:235], a[168:171], v[44:47], 0
v_cvt_pk_bf16_f32 v13, v78, v79
v_exp_f32 v151, v151
v_cvt_pk_bf16_f32 v144, v144, v145
v_cvt_pk_bf16_f32 v145, v146, v147
v_mfma_f32_16x16x32_bf16 v[236:239], a[172:175], v[44:47], v[52:55]
buffer_store_dwordx4 v[10:13], v2, s[20:23], s9 offen sc1
v_exp_f32 v152, v152
buffer_load_dwordx4 v87, s[72:75], s79 offen offset:3072 lds
s_add_u32 s76, s76, 262144
s_add_u32 s79, s79, 262144
v_exp_f32 v153, v153
v_exp_f32 v154, v154
v_exp_f32 v155, v155
v_cvt_pk_bf16_f32 v146, v148, v149
v_cvt_pk_bf16_f32 v147, v150, v151
v_exp_f32 v156, v156
v_exp_f32 v157, v157
v_exp_f32 v158, v158
v_exp_f32 v159, v159
v_cvt_pk_bf16_f32 v152, v152, v153
v_cvt_pk_bf16_f32 v153, v154, v155
v_exp_f32 v160, v160
v_exp_f32 v161, v161
v_exp_f32 v162, v162
v_exp_f32 v163, v163
v_cvt_pk_bf16_f32 v154, v156, v157
v_cvt_pk_bf16_f32 v155, v158, v159
v_cvt_pk_bf16_f32 v160, v160, v161
v_cvt_pk_bf16_f32 v161, v162, v163
v_mov_b32 v162, 0
v_mov_b32 v163, 0
v_max_f32 v18, v172, v173
v_max_f32 v19, v174, v175
v_mfma_f32_16x16x32_bf16 v[60:63], a[184:187], v[96:99], 0
v_max3_f32 v18, v18, v176, v177
v_max3_f32 v19, v19, v178, v179
v_mfma_f32_16x16x32_bf16 v[64:67], a[188:191], v[96:99], 0
v_max3_f32 v18, v18, v180, v181
v_max3_f32 v19, v19, v182, v183
v_mfma_f32_16x16x32_bf16 v[68:71], v[56:59], v[96:99], 0
v_max3_f32 v18, v18, v184, v185
v_max3_f32 v19, v19, v186, v187
v_mfma_f32_16x16x32_bf16 v[60:63], a[192:195], v[104:107], v[60:63]
v_max3_f32 v18, v18, v188, v189
v_max3_f32 v19, v19, v190, v191
v_mfma_f32_16x16x32_bf16 v[64:67], a[196:199], v[104:107], v[64:67]
v_max3_f32 v18, v18, v192, v193
v_max3_f32 v19, v19, v194, v195
v_mfma_f32_16x16x32_bf16 v[68:71], v[56:59], v[104:107], v[68:71]
v_max3_f32 v18, v18, v196, v197
v_max3_f32 v19, v19, v198, v199
v_mfma_f32_16x16x32_bf16 v[60:63], a[200:203], v[112:115], v[60:63]
v_max3_f32 v18, v18, v200, v201
v_max3_f32 v19, v19, v202, v203
v_mfma_f32_16x16x32_bf16 v[64:67], a[204:207], v[112:115], v[64:67]
v_max3_f32 v18, v18, v204, v205
v_max3_f32 v19, v19, v206, v207
v_mfma_f32_16x16x32_bf16 v[68:71], v[56:59], v[112:115], v[68:71]
v_max3_f32 v18, v18, v208, v209
v_max3_f32 v19, v19, v210, v211
v_mfma_f32_16x16x32_bf16 v[60:63], a[208:211], v[120:123], v[60:63]
v_max3_f32 v18, v18, v212, v213
v_max3_f32 v19, v19, v214, v215
v_mfma_f32_16x16x32_bf16 v[64:67], a[212:215], v[120:123], v[64:67]
v_max3_f32 v18, v18, v216, v217
v_max3_f32 v19, v19, v218, v219
v_mfma_f32_16x16x32_bf16 v[68:71], v[56:59], v[120:123], v[68:71]
v_max3_f32 v18, v18, v220, v221
v_max3_f32 v19, v19, v222, v223
v_mfma_f32_16x16x32_bf16 v[60:63], a[216:219], v[128:131], v[60:63]
v_max3_f32 v18, v18, v224, v225
v_max3_f32 v19, v19, v226, v227
v_mfma_f32_16x16x32_bf16 v[64:67], a[220:223], v[128:131], v[64:67]
v_max3_f32 v18, v18, v228, v229
v_max3_f32 v19, v19, v230, v231
v_mfma_f32_16x16x32_bf16 v[68:71], v[56:59], v[128:131], v[68:71]
v_max3_f32 v18, v18, v232, v233
v_max3_f32 v19, v19, v234, v235
v_mfma_f32_16x16x32_bf16 v[60:63], a[224:227], v[136:139], v[60:63]
v_max3_f32 v18, v18, v236, v237
v_max3_f32 v19, v19, v238, v239
v_max_f32 v18, v18, v19
v_mov_b32 v19, v18
s_nop 1
v_permlane32_swap_b32 v19, v18
v_max_f32 v18, v18, v19
v_mov_b32 v19, v18
s_nop 1
v_permlane16_swap_b32 v19, v18
v_max_f32 v18, v18, v19
v_mul_f32 v18, s46, v18
v_pk_fma_f32 v[172:173], v[172:173], s[46:47], v[18:19] op_sel_hi:[1,1,0] neg_lo:[0,0,1] neg_hi:[0,0,1]
v_pk_fma_f32 v[174:175], v[174:175], s[46:47], v[18:19] op_sel_hi:[1,1,0] neg_lo:[0,0,1] neg_hi:[0,0,1]
v_pk_fma_f32 v[176:177], v[176:177], s[46:47], v[18:19] op_sel_hi:[1,1,0] neg_lo:[0,0,1] neg_hi:[0,0,1]
buffer_load_dword v23, v88, s[32:35], s45 offen sc1
s_mul_i32 s6, s14, 589824
s_mul_i32 s7, s78, 36864
s_add_u32 s6, s6, s7
s_mov_b32 s5, s15
v_pk_fma_f32 v[178:179], v[178:179], s[46:47], v[18:19] op_sel_hi:[1,1,0] neg_lo:[0,0,1] neg_hi:[0,0,1]
v_pk_fma_f32 v[180:181], v[180:181], s[46:47], v[18:19] op_sel_hi:[1,1,0] neg_lo:[0,0,1] neg_hi:[0,0,1]
v_pk_fma_f32 v[182:183], v[182:183], s[46:47], v[18:19] op_sel_hi:[1,1,0] neg_lo:[0,0,1] neg_hi:[0,0,1]
v_pk_fma_f32 v[184:185], v[184:185], s[46:47], v[18:19] op_sel_hi:[1,1,0] neg_lo:[0,0,1] neg_hi:[0,0,1]
v_pk_fma_f32 v[186:187], v[186:187], s[46:47], v[18:19] op_sel_hi:[1,1,0] neg_lo:[0,0,1] neg_hi:[0,0,1]
s_lshl_b32 s40, s14, 17
s_add_u32 s40, s40, s15
s_lshl_b32 s7, s78, 6
s_add_u32 s40, s40, s7
s_add_u32 s41, s40, 0x8000
s_add_u32 s42, s40, 0x10000
s_add_u32 s43, s40, 0x18000
v_pk_fma_f32 v[188:189], v[188:189], s[46:47], v[18:19] op_sel_hi:[1,1,0] neg_lo:[0,0,1] neg_hi:[0,0,1]
v_pk_fma_f32 v[190:191], v[190:191], s[46:47], v[18:19] op_sel_hi:[1,1,0] neg_lo:[0,0,1] neg_hi:[0,0,1]
v_pk_fma_f32 v[192:193], v[192:193], s[46:47], v[18:19] op_sel_hi:[1,1,0] neg_lo:[0,0,1] neg_hi:[0,0,1]
v_pk_fma_f32 v[194:195], v[194:195], s[46:47], v[18:19] op_sel_hi:[1,1,0] neg_lo:[0,0,1] neg_hi:[0,0,1]
v_pk_fma_f32 v[196:197], v[196:197], s[46:47], v[18:19] op_sel_hi:[1,1,0] neg_lo:[0,0,1] neg_hi:[0,0,1]
s_add_u32 s12, s66, 4194304
s_addc_u32 s13, s67, 0
s_add_u32 s12, s12, s6
s_addc_u32 s13, s13, 0
s_and_b32 s13, s13, 0xffff
s_mov_b32 s14, 479232
s_mov_b32 s15, 0x20000
s_mov_b32 s36, 0
s_mov_b32 s37, 147456
s_mov_b32 s38, 294912
s_mov_b32 s39, 442368
v_pk_fma_f32 v[198:199], v[198:199], s[46:47], v[18:19] op_sel_hi:[1,1,0] neg_lo:[0,0,1] neg_hi:[0,0,1]
v_pk_fma_f32 v[200:201], v[200:201], s[46:47], v[18:19] op_sel_hi:[1,1,0] neg_lo:[0,0,1] neg_hi:[0,0,1]
v_pk_fma_f32 v[202:203], v[202:203], s[46:47], v[18:19] op_sel_hi:[1,1,0] neg_lo:[0,0,1] neg_hi:[0,0,1]
v_pk_fma_f32 v[204:205], v[204:205], s[46:47], v[18:19] op_sel_hi:[1,1,0] neg_lo:[0,0,1] neg_hi:[0,0,1]
v_pk_fma_f32 v[206:207], v[206:207], s[46:47], v[18:19] op_sel_hi:[1,1,0] neg_lo:[0,0,1] neg_hi:[0,0,1]
s_add_u32 m0, s44, 33024
s_nop 0
buffer_load_dwordx4 v84, s[72:75], s76 offen offset:0 lds
v_pk_fma_f32 v[208:209], v[208:209], s[46:47], v[18:19] op_sel_hi:[1,1,0] neg_lo:[0,0,1] neg_hi:[0,0,1]
v_pk_fma_f32 v[210:211], v[210:211], s[46:47], v[18:19] op_sel_hi:[1,1,0] neg_lo:[0,0,1] neg_hi:[0,0,1]
v_pk_fma_f32 v[212:213], v[212:213], s[46:47], v[18:19] op_sel_hi:[1,1,0] neg_lo:[0,0,1] neg_hi:[0,0,1]
v_pk_fma_f32 v[214:215], v[214:215], s[46:47], v[18:19] op_sel_hi:[1,1,0] neg_lo:[0,0,1] neg_hi:[0,0,1]
v_pk_fma_f32 v[216:217], v[216:217], s[46:47], v[18:19] op_sel_hi:[1,1,0] neg_lo:[0,0,1] neg_hi:[0,0,1]
buffer_load_dwordx4 v85, s[72:75], s76 offen offset:1024 lds
v_pk_fma_f32 v[218:219], v[218:219], s[46:47], v[18:19] op_sel_hi:[1,1,0] neg_lo:[0,0,1] neg_hi:[0,0,1]
v_pk_fma_f32 v[220:221], v[220:221], s[46:47], v[18:19] op_sel_hi:[1,1,0] neg_lo:[0,0,1] neg_hi:[0,0,1]
v_pk_fma_f32 v[222:223], v[222:223], s[46:47], v[18:19] op_sel_hi:[1,1,0] neg_lo:[0,0,1] neg_hi:[0,0,1]
v_pk_fma_f32 v[224:225], v[224:225], s[46:47], v[18:19] op_sel_hi:[1,1,0] neg_lo:[0,0,1] neg_hi:[0,0,1]
v_pk_fma_f32 v[226:227], v[226:227], s[46:47], v[18:19] op_sel_hi:[1,1,0] neg_lo:[0,0,1] neg_hi:[0,0,1]
v_lshrrev_b32 v24, 2, v1
v_and_b32 v25, 3, v1
v_and_b32 v26, 7, v24
v_lshlrev_b32_e64 v27, 8, v24
v_lshl_add_u32 v27, v25, 3, v27
v_add_u32 v27, 0x10100, v27
v_xor_b32_e64 v24, 0, v26
v_lshl_add_u32 v240, v24, 5, v27
v_pk_fma_f32 v[228:229], v[228:229], s[46:47], v[18:19] op_sel_hi:[1,1,0] neg_lo:[0,0,1] neg_hi:[0,0,1]
v_pk_fma_f32 v[230:231], v[230:231], s[46:47], v[18:19] op_sel_hi:[1,1,0] neg_lo:[0,0,1] neg_hi:[0,0,1]
v_pk_fma_f32 v[232:233], v[232:233], s[46:47], v[18:19] op_sel_hi:[1,1,0] neg_lo:[0,0,1] neg_hi:[0,0,1]
v_pk_fma_f32 v[234:235], v[234:235], s[46:47], v[18:19] op_sel_hi:[1,1,0] neg_lo:[0,0,1] neg_hi:[0,0,1]
v_pk_fma_f32 v[236:237], v[236:237], s[46:47], v[18:19] op_sel_hi:[1,1,0] neg_lo:[0,0,1] neg_hi:[0,0,1]
v_pk_fma_f32 v[238:239], v[238:239], s[46:47], v[18:19] op_sel_hi:[1,1,0] neg_lo:[0,0,1] neg_hi:[0,0,1]
v_exp_f32 v172, v172
v_mfma_f32_16x16x32_bf16 v[64:67], a[228:231], v[136:139], v[64:67]
v_exp_f32 v173, v173
v_exp_f32 v174, v174
v_xor_b32 v24, 1, v26
v_lshl_add_u32 v241, v24, 5, v27
v_xor_b32 v24, 2, v26
v_lshl_add_u32 v242, v24, 5, v27
v_xor_b32 v24, 3, v26
v_lshl_add_u32 v243, v24, 5, v27
v_xor_b32 v24, 4, v26
v_lshl_add_u32 v244, v24, 5, v27
v_exp_f32 v175, v175
v_mfma_f32_16x16x32_bf16 v[68:71], v[56:59], v[136:139], v[68:71]
v_mov_b32 v168, 0
v_mov_b32 v169, 0
v_exp_f32 v176, v176
v_mfma_f32_16x16x32_bf16 v[60:63], a[232:235], v[144:147], v[60:63]
v_xor_b32 v24, 5, v26
v_lshl_add_u32 v245, v24, 5, v27
v_xor_b32 v24, 6, v26
v_lshl_add_u32 v246, v24, 5, v27
v_xor_b32 v24, 7, v26
v_lshl_add_u32 v247, v24, 5, v27
v_exp_f32 v177, v177
v_exp_f32 v178, v178
v_exp_f32 v179, v179
v_mfma_f32_16x16x32_bf16 v[64:67], a[236:239], v[144:147], v[64:67]
v_cvt_pk_bf16_f32 v170, v172, v173
s_waitcnt vmcnt(2)
v_cmp_ne_u32 vcc, s68, v23
s_nop 4
s_cbranch_vccz L_ph_ok
s_mov_b32 s6, 0
L_ph_chk:
buffer_load_dword v0, v88, s[32:35], s45 offen sc1
s_add_u32 s6, s6, 1
s_waitcnt vmcnt(0)
v_cmp_ne_u32 vcc, s68, v0
s_nop 4
s_cbranch_vccz L_ph_ok
s_cmp_lt_u32 s6, 0x20000
s_cbranch_scc1 L_ph_chk
L_ph_ok:
v_cvt_pk_bf16_f32 v171, v174, v175
v_exp_f32_e64 v180, v180
v_mfma_f32_16x16x32_bf16 v[68:71], v[56:59], v[144:147], v[68:71]
v_exp_f32 v181, v181
v_exp_f32 v182, v182
buffer_load_dwordx4 a[0:3], v2, s[12:15], s36 offen offset:0 sc1
v_exp_f32_e64 v183, v183
v_mfma_f32_16x16x32_bf16 v[60:63], a[240:243], v[152:155], v[60:63]
v_cvt_pk_bf16_f32 v176, v176, v177
v_cvt_pk_bf16_f32 v177, v178, v179
v_exp_f32_e64 v184, v184
v_mfma_f32_16x16x32_bf16 v[64:67], a[244:247], v[152:155], v[64:67]
buffer_load_dwordx4 v86, s[72:75], s76 offen offset:2048 lds
v_exp_f32 v185, v185
v_exp_f32 v186, v186
v_exp_f32_e64 v187, v187
v_mfma_f32_16x16x32_bf16 v[68:71], v[56:59], v[152:155], v[68:71]
v_cvt_pk_bf16_f32 v178, v180, v181
buffer_load_dwordx4 a[4:7], v2, s[12:15], s37 offen offset:0 sc1
v_cvt_pk_bf16_f32 v179, v182, v183
v_exp_f32 v188, v188
v_mfma_f32_16x16x32_bf16 v[60:63], a[248:251], v[160:163], v[60:63]
v_exp_f32 v189, v189
v_exp_f32 v190, v190
buffer_load_dwordx4 v87, s[72:75], s76 offen offset:3072 lds
v_exp_f32 v191, v191
v_mfma_f32_16x16x32_bf16 v[64:67], a[252:255], v[160:163], v[64:67]
v_cvt_pk_bf16_f32 v184, v184, v185
v_cvt_pk_bf16_f32 v185, v186, v187
v_exp_f32_e64 v192, v192
v_mfma_f32_16x16x32_bf16 v[68:71], v[56:59], v[160:163], v[68:71]
buffer_load_dwordx4 a[8:11], v2, s[12:15], s38 offen offset:0 sc1
v_exp_f32 v193, v193
v_exp_f32 v194, v194
v_exp_f32_e64 v195, v195
v_cvt_pk_bf16_f32 v186, v188, v189
s_add_u32 m0, s44, 37120
s_nop 0
buffer_load_dwordx4 v84, s[72:75], s79 offen offset:0 lds
v_cvt_pk_bf16_f32 v187, v190, v191
v_exp_f32 v196, v196
v_exp_f32 v197, v197
v_exp_f32 v198, v198
buffer_load_dwordx4 a[12:15], v2, s[12:15], s39 offen offset:0 sc1
v_exp_f32_e64 v199, v199
v_cvt_pk_bf16_f32 v192, v192, v193
v_cvt_pk_bf16_f32 v193, v194, v195
v_exp_f32 v200, v200
v_rcp_f32 v20, v68
buffer_load_dwordx4 v85, s[72:75], s79 offen offset:1024 lds
v_exp_f32 v201, v201
v_exp_f32 v202, v202
v_exp_f32 v203, v203
v_mul_f32 v60, v20, v60
v_cvt_pk_bf16_f32 v194, v196, v197
buffer_load_dwordx4 a[16:19], v2, s[12:15], s36 offen offset:1024 sc1
v_cvt_pk_bf16_f32 v195, v198, v199
v_exp_f32 v204, v204
v_mul_f32 v61, v20, v61
v_exp_f32 v205, v205
v_exp_f32 v206, v206
buffer_load_dwordx4 v86, s[72:75], s79 offen offset:2048 lds
v_exp_f32 v207, v207
v_mul_f32 v62, v20, v62
v_cvt_pk_bf16_f32 v200, v200, v201
v_cvt_pk_bf16_f32 v201, v202, v203
v_exp_f32 v208, v208
v_mul_f32 v63, v20, v63
buffer_load_dwordx4 a[20:23], v2, s[12:15], s37 offen offset:1024 sc1
v_exp_f32 v209, v209
v_exp_f32 v210, v210
v_exp_f32 v211, v211
v_mul_f32 v64, v20, v64
v_cvt_pk_bf16_f32 v202, v204, v205
buffer_load_dwordx4 v87, s[72:75], s79 offen offset:3072 lds
s_add_u32 s76, s76, 262144
s_add_u32 s79, s79, 262144
v_cvt_pk_bf16_f32 v203, v206, v207
v_exp_f32 v212, v212
v_mul_f32 v65, v20, v65
v_exp_f32 v213, v213
v_exp_f32 v214, v214
buffer_load_dwordx4 a[24:27], v2, s[12:15], s38 offen offset:1024 sc1
v_exp_f32 v215, v215
v_mul_f32 v66, v20, v66
v_cvt_pk_bf16_f32 v208, v208, v209
v_cvt_pk_bf16_f32 v209, v210, v211
v_exp_f32 v216, v216
v_mul_f32 v67, v20, v67
buffer_load_dwordx4 a[28:31], v2, s[12:15], s39 offen offset:1024 sc1
v_exp_f32 v217, v217
v_exp_f32 v218, v218
v_exp_f32_e64 v219, v219
v_cvt_pk_bf16_f32 v4, v60, v61
v_cvt_pk_bf16_f32 v210, v212, v213
buffer_load_dwordx4 a[32:35], v2, s[12:15], s36 offen offset:2048 sc1
v_cvt_pk_bf16_f32 v211, v214, v215
v_exp_f32 v220, v220
v_cvt_pk_bf16_f32 v5, v62, v63
v_exp_f32 v221, v221
v_exp_f32 v222, v222
buffer_load_dwordx4 a[36:39], v2, s[12:15], s37 offen offset:2048 sc1
v_exp_f32 v223, v223
v_cvt_pk_bf16_f32 v6, v64, v65
v_cvt_pk_bf16_f32 v216, v216, v217
v_cvt_pk_bf16_f32 v217, v218, v219
v_exp_f32 v224, v224
v_cvt_pk_bf16_f32 v7, v66, v67
buffer_load_dwordx4 a[40:43], v2, s[12:15], s38 offen offset:2048 sc1
v_exp_f32 v225, v225
v_exp_f32 v226, v226
v_exp_f32 v227, v227
buffer_store_dwordx4 v[4:7], v2, s[20:23], s10 offen sc1
v_cvt_pk_bf16_f32 v218, v220, v221
buffer_load_dwordx4 a[44:47], v2, s[12:15], s39 offen offset:2048 sc1
v_cvt_pk_bf16_f32 v219, v222, v223
v_exp_f32 v228, v228
v_exp_f32 v229, v229
v_exp_f32 v230, v230
v_exp_f32 v231, v231
v_cvt_pk_bf16_f32 v224, v224, v225
v_cvt_pk_bf16_f32 v225, v226, v227
v_exp_f32 v232, v232
v_exp_f32 v233, v233
v_exp_f32 v234, v234
v_exp_f32 v235, v235
v_cvt_pk_bf16_f32 v226, v228, v229
v_cvt_pk_bf16_f32 v227, v230, v231
v_exp_f32 v236, v236
v_exp_f32 v237, v237
v_exp_f32 v238, v238
v_exp_f32 v239, v239
v_cvt_pk_bf16_f32 v232, v232, v233
v_cvt_pk_bf16_f32 v233, v234, v235
v_cvt_pk_bf16_f32 v234, v236, v237
v_cvt_pk_bf16_f32 v235, v238, v239
s_waitcnt vmcnt(31)
s_barrier
v_mfma_f32_16x16x32_bf16 v[72:75], a[184:187], v[168:171], 0
ds_read_b64_tr_b16 a[160:161], v240 offset:32768
v_mfma_f32_16x16x32_bf16 v[76:79], a[188:191], v[168:171], 0
v_mfma_f32_16x16x32_bf16 v[80:83], v[56:59], v[168:171], 0
ds_read_b64_tr_b16 a[162:163], v240 offset:36864
v_mfma_f32_16x16x32_bf16 v[72:75], a[192:195], v[176:179], v[72:75]
v_mfma_f32_16x16x32_bf16 v[76:79], a[196:199], v[176:179], v[76:79]
ds_read_b64_tr_b16 a[164:165], v241 offset:32768
v_mfma_f32_16x16x32_bf16 v[80:83], v[56:59], v[176:179], v[80:83]
v_mfma_f32_16x16x32_bf16 v[72:75], a[200:203], v[184:187], v[72:75]
ds_read_b64_tr_b16 a[166:167], v241 offset:36864
v_mfma_f32_16x16x32_bf16 v[76:79], a[204:207], v[184:187], v[76:79]
v_mfma_f32_16x16x32_bf16 v[80:83], v[56:59], v[184:187], v[80:83]
ds_read_b64_tr_b16 a[168:169], v242 offset:32768
v_mfma_f32_16x16x32_bf16 v[72:75], a[208:211], v[192:195], v[72:75]
v_mfma_f32_16x16x32_bf16 v[76:79], a[212:215], v[192:195], v[76:79]
ds_read_b64_tr_b16 a[170:171], v242 offset:36864
v_mfma_f32_16x16x32_bf16 v[80:83], v[56:59], v[192:195], v[80:83]
v_mfma_f32_16x16x32_bf16 v[72:75], a[216:219], v[200:203], v[72:75]
ds_read_b64_tr_b16 a[172:173], v243 offset:32768
v_mfma_f32_16x16x32_bf16 v[76:79], a[220:223], v[200:203], v[76:79]
v_mfma_f32_16x16x32_bf16 v[80:83], v[56:59], v[200:203], v[80:83]
ds_read_b64_tr_b16 a[174:175], v243 offset:36864
v_mfma_f32_16x16x32_bf16 v[72:75], a[224:227], v[208:211], v[72:75]
v_mfma_f32_16x16x32_bf16 v[76:79], a[228:231], v[208:211], v[76:79]
v_mfma_f32_16x16x32_bf16 v[80:83], v[56:59], v[208:211], v[80:83]
v_mfma_f32_16x16x32_bf16 v[72:75], a[232:235], v[216:219], v[72:75]
v_mfma_f32_16x16x32_bf16 v[76:79], a[236:239], v[216:219], v[76:79]
v_mfma_f32_16x16x32_bf16 v[80:83], v[56:59], v[216:219], v[80:83]
v_mfma_f32_16x16x32_bf16 v[72:75], a[240:243], v[224:227], v[72:75]
v_mfma_f32_16x16x32_bf16 v[76:79], a[244:247], v[224:227], v[76:79]
v_mfma_f32_16x16x32_bf16 v[80:83], v[56:59], v[224:227], v[80:83]
v_mfma_f32_16x16x32_bf16 v[72:75], a[248:251], v[232:235], v[72:75]
v_mfma_f32_16x16x32_bf16 v[76:79], a[252:255], v[232:235], v[76:79]
v_mfma_f32_16x16x32_bf16 v[80:83], v[56:59], v[232:235], v[80:83]
s_waitcnt vmcnt(12) lgkmcnt(4)
v_mfma_f32_16x16x32_bf16 v[96:99], a[160:163], a[0:3], 0
ds_read_b64_tr_b16 a[176:177], v244 offset:32768
v_mfma_f32_16x16x32_bf16 v[100:103], a[164:167], a[0:3], 0
ds_read_b64_tr_b16 a[178:179], v244 offset:36864
v_mfma_f32_16x16x32_bf16 v[132:135], a[164:167], a[4:7], 0
buffer_load_dwordx2 a[48:49], v9, s[12:15], s36 offen offset:3072 sc1
buffer_load_dwordx2 a[50:51], v9, s[12:15], s36 offen offset:3584 sc1
v_mfma_f32_16x16x32_bf16 v[128:131], a[160:163], a[4:7], 0
v_mfma_f32_16x16x32_bf16 v[160:163], a[160:163], a[8:11], 0
ds_read_b64_tr_b16 a[180:181], v245 offset:32768
v_mfma_f32_16x16x32_bf16 v[164:167], a[164:167], a[8:11], 0
ds_read_b64_tr_b16 a[182:183], v245 offset:36864
v_mfma_f32_16x16x32_bf16 v[196:199], a[164:167], a[12:15], 0
buffer_load_dwordx2 a[52:53], v9, s[12:15], s37 offen offset:3072 sc1
buffer_load_dwordx2 a[54:55], v9, s[12:15], s37 offen offset:3584 sc1
v_mfma_f32_16x16x32_bf16 v[192:195], a[160:163], a[12:15], 0
s_waitcnt lgkmcnt(4)
v_mfma_f32_16x16x32_bf16 v[200:203], a[168:171], a[12:15], 0
ds_read_b64_tr_b16 a[160:161], v246 offset:32768
v_rcp_f32_e64 v20, v80
v_mfma_f32_16x16x32_bf16 v[204:207], a[172:175], a[12:15], 0
ds_read_b64_tr_b16 a[162:163], v246 offset:36864
v_mfma_f32_16x16x32_bf16 v[172:175], a[172:175], a[8:11], 0
buffer_load_dwordx2 a[56:57], v9, s[12:15], s38 offen offset:3072 sc1
buffer_load_dwordx2 a[58:59], v9, s[12:15], s38 offen offset:3584 sc1
v_mfma_f32_16x16x32_bf16 v[168:171], a[168:171], a[8:11], 0
v_mfma_f32_16x16x32_bf16 v[136:139], a[168:171], a[4:7], 0
ds_read_b64_tr_b16 a[164:165], v247 offset:32768
v_mul_f32_e64 v72, v20, v72
v_mfma_f32_16x16x32_bf16 v[140:143], a[172:175], a[4:7], 0
ds_read_b64_tr_b16 a[166:167], v247 offset:36864
v_mfma_f32_16x16x32_bf16 v[108:111], a[172:175], a[0:3], 0
buffer_load_dwordx2 a[60:61], v9, s[12:15], s39 offen offset:3072 sc1
buffer_load_dwordx2 a[62:63], v9, s[12:15], s39 offen offset:3584 sc1
v_mfma_f32_16x16x32_bf16 v[104:107], a[168:171], a[0:3], 0
s_waitcnt lgkmcnt(4)
v_mfma_f32_16x16x32_bf16 v[112:115], a[176:179], a[0:3], 0
ds_read_b64_tr_b16 a[168:169], v240 offset:40960
v_mul_f32 v73, v20, v73
v_mfma_f32_16x16x32_bf16 v[116:119], a[180:183], a[0:3], 0
ds_read_b64_tr_b16 a[170:171], v240 offset:45056
v_mfma_f32_16x16x32_bf16 v[148:151], a[180:183], a[4:7], 0
s_add_u32 s36, s36, 4096
s_add_u32 s37, s37, 4096
s_add_u32 s38, s38, 4096
s_add_u32 s39, s39, 4096
buffer_load_dwordx4 a[64:67], v2, s[12:15], s36 offen offset:0 sc1
v_mfma_f32_16x16x32_bf16 v[144:147], a[176:179], a[4:7], 0
v_mfma_f32_16x16x32_bf16 v[176:179], a[176:179], a[8:11], 0
ds_read_b64_tr_b16 a[172:173], v241 offset:40960
v_mul_f32_e64 v74, v20, v74
v_mfma_f32_16x16x32_bf16 v[180:183], a[180:183], a[8:11], 0
ds_read_b64_tr_b16 a[174:175], v241 offset:45056
v_mfma_f32_16x16x32_bf16 v[212:215], a[180:183], a[12:15], 0
buffer_load_dwordx4 a[68:71], v2, s[12:15], s37 offen offset:0 sc1
v_mfma_f32_16x16x32_bf16 v[208:211], a[176:179], a[12:15], 0
s_waitcnt lgkmcnt(4)
v_mfma_f32_16x16x32_bf16 v[216:219], a[160:163], a[12:15], 0
ds_read_b64_tr_b16 a[176:177], v242 offset:40960
v_mul_f32 v75, v20, v75
v_mfma_f32_16x16x32_bf16 v[220:223], a[164:167], a[12:15], 0
ds_read_b64_tr_b16 a[178:179], v242 offset:45056
v_mfma_f32_16x16x32_bf16 v[188:191], a[164:167], a[8:11], 0
buffer_load_dwordx4 a[72:75], v2, s[12:15], s38 offen offset:0 sc1
v_mfma_f32_16x16x32_bf16 v[184:187], a[160:163], a[8:11], 0
v_mfma_f32_16x16x32_bf16 v[152:155], a[160:163], a[4:7], 0
ds_read_b64_tr_b16 a[180:181], v243 offset:40960
v_mul_f32_e64 v76, v20, v76
v_mfma_f32_16x16x32_bf16 v[156:159], a[164:167], a[4:7], 0
ds_read_b64_tr_b16 a[182:183], v243 offset:45056
v_mfma_f32_16x16x32_bf16 v[124:127], a[164:167], a[0:3], 0
buffer_load_dwordx4 a[76:79], v2, s[12:15], s39 offen offset:0 sc1
v_mfma_f32_16x16x32_bf16 v[120:123], a[160:163], a[0:3], 0
s_waitcnt vmcnt(17) lgkmcnt(4)
v_mfma_f32_16x16x32_bf16 v[96:99], a[168:171], a[16:19], v[96:99]
ds_read_b64_tr_b16 a[160:161], v244 offset:40960
v_mul_f32 v77, v20, v77
v_mfma_f32_16x16x32_bf16 v[100:103], a[172:175], a[16:19], v[100:103]
ds_read_b64_tr_b16 a[162:163], v244 offset:45056
v_mfma_f32_16x16x32_bf16 v[132:135], a[172:175], a[20:23], v[132:135]
buffer_load_dwordx4 a[80:83], v2, s[12:15], s36 offen offset:1024 sc1
v_mfma_f32_16x16x32_bf16 v[128:131], a[168:171], a[20:23], v[128:131]
v_mfma_f32_16x16x32_bf16 v[160:163], a[168:171], a[24:27], v[160:163]
ds_read_b64_tr_b16 a[164:165], v245 offset:40960
v_mul_f32_e64 v78, v20, v78
v_mfma_f32_16x16x32_bf16 v[164:167], a[172:175], a[24:27], v[164:167]
ds_read_b64_tr_b16 a[166:167], v245 offset:45056
v_mfma_f32_16x16x32_bf16 v[196:199], a[172:175], a[28:31], v[196:199]
buffer_load_dwordx4 a[84:87], v2, s[12:15], s37 offen offset:1024 sc1
v_mfma_f32_16x16x32_bf16 v[192:195], a[168:171], a[28:31], v[192:195]
s_waitcnt lgkmcnt(4)
v_mfma_f32_16x16x32_bf16 v[200:203], a[176:179], a[28:31], v[200:203]
ds_read_b64_tr_b16 a[168:169], v246 offset:40960
v_mul_f32 v79, v20, v79
v_mfma_f32_16x16x32_bf16 v[204:207], a[180:183], a[28:31], v[204:207]
ds_read_b64_tr_b16 a[170:171], v246 offset:45056
v_mfma_f32_16x16x32_bf16 v[172:175], a[180:183], a[24:27], v[172:175]
buffer_load_dwordx4 a[88:91], v2, s[12:15], s38 offen offset:1024 sc1
v_mfma_f32_16x16x32_bf16 v[168:171], a[176:179], a[24:27], v[168:171]
v_mfma_f32_16x16x32_bf16 v[136:139], a[176:179], a[20:23], v[136:139]
ds_read_b64_tr_b16 a[172:173], v247 offset:40960
v_cvt_pk_bf16_f32 v10, v72, v73
v_mfma_f32_16x16x32_bf16 v[140:143], a[180:183], a[20:23], v[140:143]
ds_read_b64_tr_b16 a[174:175], v247 offset:45056
v_mfma_f32_16x16x32_bf16 v[108:111], a[180:183], a[16:19], v[108:111]
buffer_load_dwordx4 a[92:95], v2, s[12:15], s39 offen offset:1024 sc1
v_mfma_f32_16x16x32_bf16 v[104:107], a[176:179], a[16:19], v[104:107]
s_waitcnt lgkmcnt(4)
v_mfma_f32_16x16x32_bf16 v[112:115], a[160:163], a[16:19], v[112:115]
ds_read_b64_tr_b16 a[176:177], v240 offset:49152
v_cvt_pk_bf16_f32 v11, v74, v75
v_mfma_f32_16x16x32_bf16 v[116:119], a[164:167], a[16:19], v[116:119]
ds_read_b64_tr_b16 a[178:179], v240 offset:53248
v_mfma_f32_16x16x32_bf16 v[148:151], a[164:167], a[20:23], v[148:151]
buffer_load_dwordx4 a[96:99], v2, s[12:15], s36 offen offset:2048 sc1
v_mfma_f32_16x16x32_bf16 v[144:147], a[160:163], a[20:23], v[144:147]
v_mfma_f32_16x16x32_bf16 v[176:179], a[160:163], a[24:27], v[176:179]
ds_read_b64_tr_b16 a[180:181], v241 offset:49152
v_cvt_pk_bf16_f32 v12, v76, v77
v_mfma_f32_16x16x32_bf16 v[180:183], a[164:167], a[24:27], v[180:183]
ds_read_b64_tr_b16 a[182:183], v241 offset:53248
v_mfma_f32_16x16x32_bf16 v[212:215], a[164:167], a[28:31], v[212:215]
buffer_load_dwordx4 a[100:103], v2, s[12:15], s37 offen offset:2048 sc1
v_mfma_f32_16x16x32_bf16 v[208:211], a[160:163], a[28:31], v[208:211]
s_waitcnt lgkmcnt(4)
v_mfma_f32_16x16x32_bf16 v[216:219], a[168:171], a[28:31], v[216:219]
ds_read_b64_tr_b16 a[160:161], v242 offset:49152
v_cvt_pk_bf16_f32 v13, v78, v79
v_mfma_f32_16x16x32_bf16 v[220:223], a[172:175], a[28:31], v[220:223]
ds_read_b64_tr_b16 a[162:163], v242 offset:53248
v_mfma_f32_16x16x32_bf16 v[188:191], a[172:175], a[24:27], v[188:191]
v_mfma_f32_16x16x32_bf16 v[184:187], a[168:171], a[24:27], v[184:187]
v_mfma_f32_16x16x32_bf16 v[152:155], a[168:171], a[20:23], v[152:155]
ds_read_b64_tr_b16 a[164:165], v243 offset:49152
buffer_store_dwordx4 v[10:13], v2, s[20:23], s11 offen sc1
v_mfma_f32_16x16x32_bf16 v[156:159], a[172:175], a[20:23], v[156:159]
ds_read_b64_tr_b16 a[166:167], v243 offset:53248
v_mfma_f32_16x16x32_bf16 v[124:127], a[172:175], a[16:19], v[124:127]
buffer_load_dwordx4 a[104:107], v2, s[12:15], s38 offen offset:2048 sc1
v_mfma_f32_16x16x32_bf16 v[120:123], a[168:171], a[16:19], v[120:123]
s_waitcnt vmcnt(20) lgkmcnt(4)
v_mfma_f32_16x16x32_bf16 v[96:99], a[176:179], a[32:35], v[96:99]
ds_read_b64_tr_b16 a[168:169], v244 offset:49152
v_mfma_f32_16x16x32_bf16 v[100:103], a[180:183], a[32:35], v[100:103]
ds_read_b64_tr_b16 a[170:171], v244 offset:53248
v_mfma_f32_16x16x32_bf16 v[132:135], a[180:183], a[36:39], v[132:135]
buffer_load_dwordx4 a[108:111], v2, s[12:15], s39 offen offset:2048 sc1
v_mfma_f32_16x16x32_bf16 v[128:131], a[176:179], a[36:39], v[128:131]
v_mfma_f32_16x16x32_bf16 v[160:163], a[176:179], a[40:43], v[160:163]
ds_read_b64_tr_b16 a[172:173], v245 offset:49152
v_mfma_f32_16x16x32_bf16 v[164:167], a[180:183], a[40:43], v[164:167]
ds_read_b64_tr_b16 a[174:175], v245 offset:53248
v_mfma_f32_16x16x32_bf16 v[196:199], a[180:183], a[44:47], v[196:199]
buffer_load_dwordx4 a[112:115], v2, s[12:15], s36 offen offset:3072 sc1
v_mfma_f32_16x16x32_bf16 v[192:195], a[176:179], a[44:47], v[192:195]
s_waitcnt lgkmcnt(4)
v_mfma_f32_16x16x32_bf16 v[200:203], a[160:163], a[44:47], v[200:203]
ds_read_b64_tr_b16 a[176:177], v246 offset:49152
v_mfma_f32_16x16x32_bf16 v[204:207], a[164:167], a[44:47], v[204:207]
ds_read_b64_tr_b16 a[178:179], v246 offset:53248
v_mfma_f32_16x16x32_bf16 v[172:175], a[164:167], a[40:43], v[172:175]
buffer_load_dwordx4 a[116:119], v2, s[12:15], s37 offen offset:3072 sc1
v_mfma_f32_16x16x32_bf16 v[168:171], a[160:163], a[40:43], v[168:171]
v_mfma_f32_16x16x32_bf16 v[136:139], a[160:163], a[36:39], v[136:139]
ds_read_b64_tr_b16 a[180:181], v247 offset:49152
v_mfma_f32_16x16x32_bf16 v[140:143], a[164:167], a[36:39], v[140:143]
ds_read_b64_tr_b16 a[182:183], v247 offset:53248
v_mfma_f32_16x16x32_bf16 v[108:111], a[164:167], a[32:35], v[108:111]
v_mfma_f32_16x16x32_bf16 v[104:107], a[160:163], a[32:35], v[104:107]
s_waitcnt lgkmcnt(4)
v_mfma_f32_16x16x32_bf16 v[112:115], a[168:171], a[32:35], v[112:115]
ds_read_b64_tr_b16 a[160:161], v240 offset:57344
v_mfma_f32_16x16x32_bf16 v[116:119], a[172:175], a[32:35], v[116:119]
ds_read_b64_tr_b16 a[162:163], v240 offset:61440
v_mfma_f32_16x16x32_bf16 v[148:151], a[172:175], a[36:39], v[148:151]
buffer_load_dwordx4 a[120:123], v2, s[12:15], s38 offen offset:3072 sc1
v_mfma_f32_16x16x32_bf16 v[144:147], a[168:171], a[36:39], v[144:147]
v_mfma_f32_16x16x32_bf16 v[176:179], a[168:171], a[40:43], v[176:179]
ds_read_b64_tr_b16 a[164:165], v241 offset:57344
v_mfma_f32_16x16x32_bf16 v[180:183], a[172:175], a[40:43], v[180:183]
ds_read_b64_tr_b16 a[166:167], v241 offset:61440
v_mfma_f32_16x16x32_bf16 v[212:215], a[172:175], a[44:47], v[212:215]
buffer_load_dwordx4 a[124:127], v2, s[12:15], s39 offen offset:3072 sc1
v_mfma_f32_16x16x32_bf16 v[208:211], a[168:171], a[44:47], v[208:211]
s_waitcnt lgkmcnt(4)
v_mfma_f32_16x16x32_bf16 v[216:219], a[176:179], a[44:47], v[216:219]
ds_read_b64_tr_b16 a[168:169], v242 offset:57344
v_mfma_f32_16x16x32_bf16 v[220:223], a[180:183], a[44:47], v[220:223]
ds_read_b64_tr_b16 a[170:171], v242 offset:61440
v_mfma_f32_16x16x32_bf16 v[188:191], a[180:183], a[40:43], v[188:191]
s_add_u32 s36, s36, 4096
s_add_u32 s37, s37, 4096
s_add_u32 s38, s38, 4096
s_add_u32 s39, s39, 4096
buffer_load_dwordx4 a[128:131], v2, s[12:15], s36 offen offset:0 sc1
v_mfma_f32_16x16x32_bf16 v[184:187], a[176:179], a[40:43], v[184:187]
v_mfma_f32_16x16x32_bf16 v[152:155], a[176:179], a[36:39], v[152:155]
ds_read_b64_tr_b16 a[172:173], v243 offset:57344
v_mfma_f32_16x16x32_bf16 v[156:159], a[180:183], a[36:39], v[156:159]
ds_read_b64_tr_b16 a[174:175], v243 offset:61440
v_mfma_f32_16x16x32_bf16 v[124:127], a[180:183], a[32:35], v[124:127]
buffer_load_dwordx4 a[132:135], v2, s[12:15], s37 offen offset:0 sc1
v_mfma_f32_16x16x32_bf16 v[120:123], a[176:179], a[32:35], v[120:123]
s_waitcnt vmcnt(19) lgkmcnt(4)
v_mfma_f32_16x16x32_bf16 v[96:99], a[160:163], a[48:51], v[96:99]
ds_read_b64_tr_b16 a[176:177], v244 offset:57344
v_mfma_f32_16x16x32_bf16 v[100:103], a[164:167], a[48:51], v[100:103]
ds_read_b64_tr_b16 a[178:179], v244 offset:61440
v_mfma_f32_16x16x32_bf16 v[132:135], a[164:167], a[52:55], v[132:135]
v_mfma_f32_16x16x32_bf16 v[128:131], a[160:163], a[52:55], v[128:131]
v_mfma_f32_16x16x32_bf16 v[160:163], a[160:163], a[56:59], v[160:163]
ds_read_b64_tr_b16 a[180:181], v245 offset:57344
v_mfma_f32_16x16x32_bf16 v[164:167], a[164:167], a[56:59], v[164:167]
ds_read_b64_tr_b16 a[182:183], v245 offset:61440
v_mfma_f32_16x16x32_bf16 v[196:199], a[164:167], a[60:63], v[196:199]
buffer_load_dwordx4 a[136:139], v2, s[12:15], s38 offen offset:0 sc1
v_mfma_f32_16x16x32_bf16 v[192:195], a[160:163], a[60:63], v[192:195]
s_waitcnt lgkmcnt(4)
v_mfma_f32_16x16x32_bf16 v[200:203], a[168:171], a[60:63], v[200:203]
ds_read_b64_tr_b16 a[160:161], v246 offset:57344
v_mfma_f32_16x16x32_bf16 v[204:207], a[172:175], a[60:63], v[204:207]
ds_read_b64_tr_b16 a[162:163], v246 offset:61440
v_mfma_f32_16x16x32_bf16 v[172:175], a[172:175], a[56:59], v[172:175]
buffer_load_dwordx4 a[140:143], v2, s[12:15], s39 offen offset:0 sc1
v_mfma_f32_16x16x32_bf16 v[168:171], a[168:171], a[56:59], v[168:171]
s_add_u32 m0, s44, 65792
v_mfma_f32_16x16x32_bf16 v[136:139], a[168:171], a[52:55], v[136:139]
ds_read_b64_tr_b16 a[164:165], v247 offset:57344
v_mfma_f32_16x16x32_bf16 v[140:143], a[172:175], a[52:55], v[140:143]
ds_read_b64_tr_b16 a[166:167], v247 offset:61440
v_mfma_f32_16x16x32_bf16 v[108:111], a[172:175], a[48:51], v[108:111]
buffer_load_dwordx4 v84, s[72:75], s76 offen offset:0 lds
v_mfma_f32_16x16x32_bf16 v[104:107], a[168:171], a[48:51], v[104:107]
s_waitcnt lgkmcnt(4)
v_mfma_f32_16x16x32_bf16 v[112:115], a[176:179], a[48:51], v[112:115]
s_waitcnt vmcnt(52)
s_barrier
v_xor_b32 v240, 0x10000, v240
ds_read_b64_tr_b16 a[168:169], v240 offset:0
v_mfma_f32_16x16x32_bf16 v[116:119], a[180:183], a[48:51], v[116:119]
ds_read_b64_tr_b16 a[170:171], v240 offset:4096
v_mfma_f32_16x16x32_bf16 v[148:151], a[180:183], a[52:55], v[148:151]
buffer_load_dwordx4 v85, s[72:75], s76 offen offset:1024 lds
v_mfma_f32_16x16x32_bf16 v[144:147], a[176:179], a[52:55], v[144:147]
v_mfma_f32_16x16x32_bf16 v[176:179], a[176:179], a[56:59], v[176:179]
v_xor_b32 v241, 0x10000, v241
ds_read_b64_tr_b16 a[172:173], v241 offset:0
v_mfma_f32_16x16x32_bf16 v[180:183], a[180:183], a[56:59], v[180:183]
ds_read_b64_tr_b16 a[174:175], v241 offset:4096
v_mfma_f32_16x16x32_bf16 v[212:215], a[180:183], a[60:63], v[212:215]
v_mfma_f32_16x16x32_bf16 v[208:211], a[176:179], a[60:63], v[208:211]
s_waitcnt lgkmcnt(4)
v_mfma_f32_16x16x32_bf16 v[216:219], a[160:163], a[60:63], v[216:219]
v_xor_b32 v242, 0x10000, v242
ds_read_b64_tr_b16 a[176:177], v242 offset:0
v_mfma_f32_16x16x32_bf16 v[220:223], a[164:167], a[60:63], v[220:223]
ds_read_b64_tr_b16 a[178:179], v242 offset:4096
v_mfma_f32_16x16x32_bf16 v[188:191], a[164:167], a[56:59], v[188:191]
buffer_load_dwordx4 v86, s[72:75], s76 offen offset:2048 lds
v_mfma_f32_16x16x32_bf16 v[184:187], a[160:163], a[56:59], v[184:187]
v_mfma_f32_16x16x32_bf16 v[152:155], a[160:163], a[52:55], v[152:155]
v_xor_b32 v243, 0x10000, v243
ds_read_b64_tr_b16 a[180:181], v243 offset:0
v_mfma_f32_16x16x32_bf16 v[156:159], a[164:167], a[52:55], v[156:159]
ds_read_b64_tr_b16 a[182:183], v243 offset:4096
v_mfma_f32_16x16x32_bf16 v[124:127], a[164:167], a[48:51], v[124:127]
buffer_load_dwordx4 a[144:147], v2, s[12:15], s36 offen offset:1024 sc1
v_mfma_f32_16x16x32_bf16 v[120:123], a[160:163], a[48:51], v[120:123]
s_waitcnt vmcnt(21) lgkmcnt(4)
v_mfma_f32_16x16x32_bf16 v[96:99], a[168:171], a[64:67], v[96:99]
v_xor_b32 v244, 0x10000, v244
ds_read_b64_tr_b16 a[160:161], v244 offset:0
v_mfma_f32_16x16x32_bf16 v[100:103], a[172:175], a[64:67], v[100:103]
ds_read_b64_tr_b16 a[162:163], v244 offset:4096
v_mfma_f32_16x16x32_bf16 v[132:135], a[172:175], a[68:71], v[132:135]
buffer_load_dwordx4 a[148:151], v2, s[12:15], s37 offen offset:1024 sc1
v_mfma_f32_16x16x32_bf16 v[128:131], a[168:171], a[68:71], v[128:131]
v_mfma_f32_16x16x32_bf16 v[160:163], a[168:171], a[72:75], v[160:163]
v_xor_b32 v245, 0x10000, v245
ds_read_b64_tr_b16 a[164:165], v245 offset:0
v_mfma_f32_16x16x32_bf16 v[164:167], a[172:175], a[72:75], v[164:167]
ds_read_b64_tr_b16 a[166:167], v245 offset:4096
v_mfma_f32_16x16x32_bf16 v[196:199], a[172:175], a[76:79], v[196:199]
buffer_load_dwordx4 a[152:155], v2, s[12:15], s38 offen offset:1024 sc1
v_mfma_f32_16x16x32_bf16 v[192:195], a[168:171], a[76:79], v[192:195]
s_waitcnt lgkmcnt(4)
v_mfma_f32_16x16x32_bf16 v[200:203], a[176:179], a[76:79], v[200:203]
v_xor_b32 v246, 0x10000, v246
ds_read_b64_tr_b16 a[168:169], v246 offset:0
v_mfma_f32_16x16x32_bf16 v[204:207], a[180:183], a[76:79], v[204:207]
ds_read_b64_tr_b16 a[170:171], v246 offset:4096
v_mfma_f32_16x16x32_bf16 v[172:175], a[180:183], a[72:75], v[172:175]
v_mfma_f32_16x16x32_bf16 v[168:171], a[176:179], a[72:75], v[168:171]
v_mfma_f32_16x16x32_bf16 v[136:139], a[176:179], a[68:71], v[136:139]
v_xor_b32 v247, 0x10000, v247
ds_read_b64_tr_b16 a[172:173], v247 offset:0
v_mfma_f32_16x16x32_bf16 v[140:143], a[180:183], a[68:71], v[140:143]
ds_read_b64_tr_b16 a[174:175], v247 offset:4096
v_mfma_f32_16x16x32_bf16 v[108:111], a[180:183], a[64:67], v[108:111]
buffer_load_dwordx4 a[156:159], v2, s[12:15], s39 offen offset:1024 sc1
v_mfma_f32_16x16x32_bf16 v[104:107], a[176:179], a[64:67], v[104:107]
s_waitcnt lgkmcnt(4)
v_mfma_f32_16x16x32_bf16 v[112:115], a[160:163], a[64:67], v[112:115]
ds_read_b64_tr_b16 a[176:177], v240 offset:8192
v_mfma_f32_16x16x32_bf16 v[116:119], a[164:167], a[64:67], v[116:119]
ds_read_b64_tr_b16 a[178:179], v240 offset:12288
v_mfma_f32_16x16x32_bf16 v[148:151], a[164:167], a[68:71], v[148:151]
buffer_load_dwordx4 v87, s[72:75], s76 offen offset:3072 lds
v_mfma_f32_16x16x32_bf16 v[144:147], a[160:163], a[68:71], v[144:147]
s_add_u32 m0, s44, 69888
v_mfma_f32_16x16x32_bf16 v[176:179], a[160:163], a[72:75], v[176:179]
ds_read_b64_tr_b16 a[180:181], v241 offset:8192
v_mfma_f32_16x16x32_bf16 v[180:183], a[164:167], a[72:75], v[180:183]
ds_read_b64_tr_b16 a[182:183], v241 offset:12288
v_mfma_f32_16x16x32_bf16 v[212:215], a[164:167], a[76:79], v[212:215]
buffer_load_dwordx4 v84, s[72:75], s79 offen offset:0 lds
v_mfma_f32_16x16x32_bf16 v[208:211], a[160:163], a[76:79], v[208:211]
s_waitcnt lgkmcnt(4)
v_mfma_f32_16x16x32_bf16 v[216:219], a[168:171], a[76:79], v[216:219]
ds_read_b64_tr_b16 a[160:161], v242 offset:8192
v_mfma_f32_16x16x32_bf16 v[220:223], a[172:175], a[76:79], v[220:223]
ds_read_b64_tr_b16 a[162:163], v242 offset:12288
v_mfma_f32_16x16x32_bf16 v[188:191], a[172:175], a[72:75], v[188:191]
buffer_load_dwordx4 v85, s[72:75], s79 offen offset:1024 lds
v_mfma_f32_16x16x32_bf16 v[184:187], a[168:171], a[72:75], v[184:187]
v_mfma_f32_16x16x32_bf16 v[152:155], a[168:171], a[68:71], v[152:155]
ds_read_b64_tr_b16 a[164:165], v243 offset:8192
v_mfma_f32_16x16x32_bf16 v[156:159], a[172:175], a[68:71], v[156:159]
ds_read_b64_tr_b16 a[166:167], v243 offset:12288
v_mfma_f32_16x16x32_bf16 v[124:127], a[172:175], a[64:67], v[124:127]
v_mfma_f32_16x16x32_bf16 v[120:123], a[168:171], a[64:67], v[120:123]
s_waitcnt vmcnt(23) lgkmcnt(4)
v_mfma_f32_16x16x32_bf16 v[96:99], a[176:179], a[80:83], v[96:99]
ds_read_b64_tr_b16 a[168:169], v244 offset:8192
s_waitcnt vmcnt(20)
v_mfma_f32_16x16x32_bf16 v[100:103], a[180:183], a[80:83], v[100:103]
ds_read_b64_tr_b16 a[170:171], v244 offset:12288
buffer_store_dword v28, v29, s[32:35], s70 offen offset:48 sc1
v_mfma_f32_16x16x32_bf16 v[132:135], a[180:183], a[84:87], v[132:135]
buffer_load_dwordx4 v86, s[72:75], s79 offen offset:2048 lds
s_add_u32 s45, s45, 16
v_mfma_f32_16x16x32_bf16 v[128:131], a[176:179], a[84:87], v[128:131]
v_mfma_f32_16x16x32_bf16 v[160:163], a[176:179], a[88:91], v[160:163]
ds_read_b64_tr_b16 a[172:173], v245 offset:8192
v_mfma_f32_16x16x32_bf16 v[164:167], a[180:183], a[88:91], v[164:167]
ds_read_b64_tr_b16 a[174:175], v245 offset:12288
v_mfma_f32_16x16x32_bf16 v[196:199], a[180:183], a[92:95], v[196:199]
buffer_load_dwordx2 a[0:1], v9, s[12:15], s36 offen offset:2048 sc1
buffer_load_dwordx2 a[2:3], v9, s[12:15], s36 offen offset:2560 sc1
v_mfma_f32_16x16x32_bf16 v[192:195], a[176:179], a[92:95], v[192:195]
s_waitcnt lgkmcnt(4)
v_mfma_f32_16x16x32_bf16 v[200:203], a[160:163], a[92:95], v[200:203]
ds_read_b64_tr_b16 a[176:177], v246 offset:8192
v_mfma_f32_16x16x32_bf16 v[204:207], a[164:167], a[92:95], v[204:207]
ds_read_b64_tr_b16 a[178:179], v246 offset:12288
v_mfma_f32_16x16x32_bf16 v[172:175], a[164:167], a[88:91], v[172:175]
buffer_load_dwordx2 a[4:5], v9, s[12:15], s37 offen offset:2048 sc1
buffer_load_dwordx2 a[6:7], v9, s[12:15], s37 offen offset:2560 sc1
v_mfma_f32_16x16x32_bf16 v[168:171], a[160:163], a[88:91], v[168:171]
v_mfma_f32_16x16x32_bf16 v[136:139], a[160:163], a[84:87], v[136:139]
ds_read_b64_tr_b16 a[180:181], v247 offset:8192
v_mfma_f32_16x16x32_bf16 v[140:143], a[164:167], a[84:87], v[140:143]
ds_read_b64_tr_b16 a[182:183], v247 offset:12288
v_mfma_f32_16x16x32_bf16 v[108:111], a[164:167], a[80:83], v[108:111]
buffer_load_dwordx2 a[8:9], v9, s[12:15], s38 offen offset:2048 sc1
buffer_load_dwordx2 a[10:11], v9, s[12:15], s38 offen offset:2560 sc1
v_mfma_f32_16x16x32_bf16 v[104:107], a[160:163], a[80:83], v[104:107]
s_waitcnt lgkmcnt(4)
v_mfma_f32_16x16x32_bf16 v[112:115], a[168:171], a[80:83], v[112:115]
ds_read_b64_tr_b16 a[160:161], v240 offset:16384
s_mov_b32 s16, s48
s_and_b32 s17, s49, 0xffff
v_mfma_f32_16x16x32_bf16 v[116:119], a[172:175], a[80:83], v[116:119]
ds_read_b64_tr_b16 a[162:163], v240 offset:20480
v_mfma_f32_16x16x32_bf16 v[148:151], a[172:175], a[84:87], v[148:151]
v_mfma_f32_16x16x32_bf16 v[144:147], a[168:171], a[84:87], v[144:147]
v_mfma_f32_16x16x32_bf16 v[176:179], a[168:171], a[88:91], v[176:179]
ds_read_b64_tr_b16 a[164:165], v241 offset:16384
v_mfma_f32_16x16x32_bf16 v[180:183], a[172:175], a[88:91], v[180:183]
ds_read_b64_tr_b16 a[166:167], v241 offset:20480
v_mfma_f32_16x16x32_bf16 v[212:215], a[172:175], a[92:95], v[212:215]
buffer_load_dwordx2 a[12:13], v9, s[12:15], s39 offen offset:2048 sc1
buffer_load_dwordx2 a[14:15], v9, s[12:15], s39 offen offset:2560 sc1
v_mfma_f32_16x16x32_bf16 v[208:211], a[168:171], a[92:95], v[208:211]
s_waitcnt lgkmcnt(4)
v_mfma_f32_16x16x32_bf16 v[216:219], a[176:179], a[92:95], v[216:219]
ds_read_b64_tr_b16 a[168:169], v242 offset:16384
v_mfma_f32_16x16x32_bf16 v[220:223], a[180:183], a[92:95], v[220:223]
ds_read_b64_tr_b16 a[170:171], v242 offset:20480
v_mfma_f32_16x16x32_bf16 v[188:191], a[180:183], a[88:91], v[188:191]
buffer_load_dwordx4 v87, s[72:75], s79 offen offset:3072 lds
s_add_u32 s76, s76, 262144
s_add_u32 s79, s79, 262144
v_mfma_f32_16x16x32_bf16 v[184:187], a[176:179], a[88:91], v[184:187]
v_mfma_f32_16x16x32_bf16 v[152:155], a[176:179], a[84:87], v[152:155]
ds_read_b64_tr_b16 a[172:173], v243 offset:16384
s_mov_b32 s18, 4194304
s_mov_b32 s19, 0x20000
v_mfma_f32_16x16x32_bf16 v[156:159], a[180:183], a[84:87], v[156:159]
ds_read_b64_tr_b16 a[174:175], v243 offset:20480
v_mfma_f32_16x16x32_bf16 v[124:127], a[180:183], a[80:83], v[124:127]
buffer_load_dwordx4 a[16:19], v2, s[12:15], s36 offen offset:3072 sc1
v_mfma_f32_16x16x32_bf16 v[120:123], a[176:179], a[80:83], v[120:123]
s_waitcnt vmcnt(30) lgkmcnt(4)
v_mfma_f32_16x16x32_bf16 v[96:99], a[160:163], a[96:99], v[96:99]
ds_read_b64_tr_b16 a[176:177], v244 offset:16384
v_mfma_f32_16x16x32_bf16 v[100:103], a[164:167], a[96:99], v[100:103]
ds_read_b64_tr_b16 a[178:179], v244 offset:20480
v_mfma_f32_16x16x32_bf16 v[132:135], a[164:167], a[100:103], v[132:135]
buffer_load_dwordx4 a[20:23], v2, s[12:15], s37 offen offset:3072 sc1
v_mfma_f32_16x16x32_bf16 v[128:131], a[160:163], a[100:103], v[128:131]
v_mfma_f32_16x16x32_bf16 v[160:163], a[160:163], a[104:107], v[160:163]
ds_read_b64_tr_b16 a[180:181], v245 offset:16384
v_mfma_f32_16x16x32_bf16 v[164:167], a[164:167], a[104:107], v[164:167]
ds_read_b64_tr_b16 a[182:183], v245 offset:20480
v_mfma_f32_16x16x32_bf16 v[196:199], a[164:167], a[108:111], v[196:199]
v_mfma_f32_16x16x32_bf16 v[192:195], a[160:163], a[108:111], v[192:195]
s_waitcnt lgkmcnt(4)
v_mfma_f32_16x16x32_bf16 v[200:203], a[168:171], a[108:111], v[200:203]
ds_read_b64_tr_b16 a[160:161], v246 offset:16384
s_mov_b32 s24, s62
s_and_b32 s25, s63, 0xffff
v_mfma_f32_16x16x32_bf16 v[204:207], a[172:175], a[108:111], v[204:207]
ds_read_b64_tr_b16 a[162:163], v246 offset:20480
v_mfma_f32_16x16x32_bf16 v[172:175], a[172:175], a[104:107], v[172:175]
buffer_load_dwordx4 a[24:27], v2, s[12:15], s38 offen offset:3072 sc1
v_mfma_f32_16x16x32_bf16 v[168:171], a[168:171], a[104:107], v[168:171]
v_mfma_f32_16x16x32_bf16 v[136:139], a[168:171], a[100:103], v[136:139]
ds_read_b64_tr_b16 a[164:165], v247 offset:16384
v_mfma_f32_16x16x32_bf16 v[140:143], a[172:175], a[100:103], v[140:143]
ds_read_b64_tr_b16 a[166:167], v247 offset:20480
v_mfma_f32_16x16x32_bf16 v[108:111], a[172:175], a[96:99], v[108:111]
buffer_load_dwordx4 a[28:31], v2, s[12:15], s39 offen offset:3072 sc1
v_mfma_f32_16x16x32_bf16 v[104:107], a[168:171], a[96:99], v[104:107]
s_waitcnt lgkmcnt(4)
v_mfma_f32_16x16x32_bf16 v[112:115], a[176:179], a[96:99], v[112:115]
ds_read_b64_tr_b16 a[168:169], v240 offset:24576
v_mfma_f32_16x16x32_bf16 v[116:119], a[180:183], a[96:99], v[116:119]
ds_read_b64_tr_b16 a[170:171], v240 offset:28672
v_mfma_f32_16x16x32_bf16 v[148:151], a[180:183], a[100:103], v[148:151]
s_add_u32 s36, s36, 4096
s_add_u32 s37, s37, 4096
s_add_u32 s38, s38, 4096
s_add_u32 s39, s39, 4096
buffer_load_dwordx4 a[32:35], v2, s[12:15], s36 offen offset:0 sc1
v_mfma_f32_16x16x32_bf16 v[144:147], a[176:179], a[100:103], v[144:147]
v_mfma_f32_16x16x32_bf16 v[176:179], a[176:179], a[104:107], v[176:179]
ds_read_b64_tr_b16 a[172:173], v241 offset:24576
s_mov_b32 s26, 4194304
s_mov_b32 s27, 0x20000
v_mfma_f32_16x16x32_bf16 v[180:183], a[180:183], a[104:107], v[180:183]
ds_read_b64_tr_b16 a[174:175], v241 offset:28672
v_mfma_f32_16x16x32_bf16 v[212:215], a[180:183], a[108:111], v[212:215]
buffer_load_dwordx4 a[36:39], v2, s[12:15], s37 offen offset:0 sc1
v_mfma_f32_16x16x32_bf16 v[208:211], a[176:179], a[108:111], v[208:211]
s_waitcnt lgkmcnt(4)
v_mfma_f32_16x16x32_bf16 v[216:219], a[160:163], a[108:111], v[216:219]
ds_read_b64_tr_b16 a[176:177], v242 offset:24576
v_mfma_f32_16x16x32_bf16 v[220:223], a[164:167], a[108:111], v[220:223]
ds_read_b64_tr_b16 a[178:179], v242 offset:28672
v_mfma_f32_16x16x32_bf16 v[188:191], a[164:167], a[104:107], v[188:191]
v_mfma_f32_16x16x32_bf16 v[184:187], a[160:163], a[104:107], v[184:187]
v_mfma_f32_16x16x32_bf16 v[152:155], a[160:163], a[100:103], v[152:155]
ds_read_b64_tr_b16 a[180:181], v243 offset:24576
v_mfma_f32_16x16x32_bf16 v[156:159], a[164:167], a[100:103], v[156:159]
ds_read_b64_tr_b16 a[182:183], v243 offset:28672
v_mfma_f32_16x16x32_bf16 v[124:127], a[164:167], a[96:99], v[124:127]
buffer_load_dwordx4 a[40:43], v2, s[12:15], s38 offen offset:0 sc1
v_mfma_f32_16x16x32_bf16 v[120:123], a[160:163], a[96:99], v[120:123]
s_waitcnt vmcnt(32) lgkmcnt(4)
v_mfma_f32_16x16x32_bf16 v[96:99], a[168:171], a[112:115], v[96:99]
ds_read_b64_tr_b16 a[160:161], v244 offset:24576
s_add_u32 s28, s66, 41943040
s_addc_u32 s29, s67, 0
v_mfma_f32_16x16x32_bf16 v[100:103], a[172:175], a[112:115], v[100:103]
ds_read_b64_tr_b16 a[162:163], v244 offset:28672
v_mfma_f32_16x16x32_bf16 v[132:135], a[172:175], a[116:119], v[132:135]
buffer_load_dwordx4 a[44:47], v2, s[12:15], s39 offen offset:0 sc1
v_mfma_f32_16x16x32_bf16 v[128:131], a[168:171], a[116:119], v[128:131]
s_add_u32 m0, s44, 98560
v_mfma_f32_16x16x32_bf16 v[160:163], a[168:171], a[120:123], v[160:163]
ds_read_b64_tr_b16 a[164:165], v245 offset:24576
v_mfma_f32_16x16x32_bf16 v[164:167], a[172:175], a[120:123], v[164:167]
ds_read_b64_tr_b16 a[166:167], v245 offset:28672
v_mfma_f32_16x16x32_bf16 v[196:199], a[172:175], a[124:127], v[196:199]
buffer_load_dwordx4 v84, s[72:75], s76 offen offset:0 lds
v_mfma_f32_16x16x32_bf16 v[192:195], a[168:171], a[124:127], v[192:195]
s_waitcnt lgkmcnt(4)
v_mfma_f32_16x16x32_bf16 v[200:203], a[176:179], a[124:127], v[200:203]
ds_read_b64_tr_b16 a[168:169], v246 offset:24576
v_mfma_f32_16x16x32_bf16 v[204:207], a[180:183], a[124:127], v[204:207]
ds_read_b64_tr_b16 a[170:171], v246 offset:28672
v_mfma_f32_16x16x32_bf16 v[172:175], a[180:183], a[120:123], v[172:175]
buffer_load_dwordx4 v85, s[72:75], s76 offen offset:1024 lds
v_mfma_f32_16x16x32_bf16 v[168:171], a[176:179], a[120:123], v[168:171]
v_mfma_f32_16x16x32_bf16 v[136:139], a[176:179], a[116:119], v[136:139]
ds_read_b64_tr_b16 a[172:173], v247 offset:24576
s_and_b32 s29, s29, 0xffff
s_mov_b32 s30, 12582912
v_mfma_f32_16x16x32_bf16 v[140:143], a[180:183], a[116:119], v[140:143]
ds_read_b64_tr_b16 a[174:175], v247 offset:28672
v_mfma_f32_16x16x32_bf16 v[108:111], a[180:183], a[112:115], v[108:111]
v_mfma_f32_16x16x32_bf16 v[104:107], a[176:179], a[112:115], v[104:107]
s_waitcnt lgkmcnt(4)
v_mfma_f32_16x16x32_bf16 v[112:115], a[160:163], a[112:115], v[112:115]
s_nop 0
s_barrier
ds_read_b64_tr_b16 a[176:177], v240 offset:32768
v_mfma_f32_16x16x32_bf16 v[116:119], a[164:167], a[112:115], v[116:119]
ds_read_b64_tr_b16 a[178:179], v240 offset:36864
v_mfma_f32_16x16x32_bf16 v[148:151], a[164:167], a[116:119], v[148:151]
buffer_load_dwordx4 v86, s[72:75], s76 offen offset:2048 lds
v_mfma_f32_16x16x32_bf16 v[144:147], a[160:163], a[116:119], v[144:147]
v_mfma_f32_16x16x32_bf16 v[176:179], a[160:163], a[120:123], v[176:179]
ds_read_b64_tr_b16 a[180:181], v241 offset:32768
v_mfma_f32_16x16x32_bf16 v[180:183], a[164:167], a[120:123], v[180:183]
ds_read_b64_tr_b16 a[182:183], v241 offset:36864
v_mfma_f32_16x16x32_bf16 v[212:215], a[164:167], a[124:127], v[212:215]
buffer_load_dwordx4 a[48:51], v2, s[12:15], s36 offen offset:1024 sc1
v_mfma_f32_16x16x32_bf16 v[208:211], a[160:163], a[124:127], v[208:211]
s_waitcnt lgkmcnt(4)
v_mfma_f32_16x16x32_bf16 v[216:219], a[168:171], a[124:127], v[216:219]
ds_read_b64_tr_b16 a[160:161], v242 offset:32768
s_mov_b32 s31, 0x20000
s_lshl_b32 s6, s2, 2
v_mfma_f32_16x16x32_bf16 v[220:223], a[172:175], a[124:127], v[220:223]
ds_read_b64_tr_b16 a[162:163], v242 offset:36864
v_mfma_f32_16x16x32_bf16 v[188:191], a[172:175], a[120:123], v[188:191]
buffer_load_dwordx4 a[52:55], v2, s[12:15], s37 offen offset:1024 sc1
v_mfma_f32_16x16x32_bf16 v[184:187], a[168:171], a[120:123], v[184:187]
v_mfma_f32_16x16x32_bf16 v[152:155], a[168:171], a[116:119], v[152:155]
ds_read_b64_tr_b16 a[164:165], v243 offset:32768
v_mfma_f32_16x16x32_bf16 v[156:159], a[172:175], a[116:119], v[156:159]
ds_read_b64_tr_b16 a[166:167], v243 offset:36864
v_mfma_f32_16x16x32_bf16 v[124:127], a[172:175], a[112:115], v[124:127]
buffer_load_dwordx4 a[56:59], v2, s[12:15], s38 offen offset:1024 sc1
v_mfma_f32_16x16x32_bf16 v[120:123], a[168:171], a[112:115], v[120:123]
s_waitcnt vmcnt(35) lgkmcnt(4)
v_mfma_f32_16x16x32_bf16 v[96:99], a[176:179], a[128:131], v[96:99]
ds_read_b64_tr_b16 a[168:169], v244 offset:32768
v_mfma_f32_16x16x32_bf16 v[100:103], a[180:183], a[128:131], v[100:103]
ds_read_b64_tr_b16 a[170:171], v244 offset:36864
v_mfma_f32_16x16x32_bf16 v[132:135], a[180:183], a[132:135], v[132:135]
v_mfma_f32_16x16x32_bf16 v[128:131], a[176:179], a[132:135], v[128:131]
v_mfma_f32_16x16x32_bf16 v[160:163], a[176:179], a[136:139], v[160:163]
ds_read_b64_tr_b16 a[172:173], v245 offset:32768
s_add_u32 s6, s6, s3
s_mul_i32 s69, s6, 12288
v_mfma_f32_16x16x32_bf16 v[164:167], a[180:183], a[136:139], v[164:167]
ds_read_b64_tr_b16 a[174:175], v245 offset:36864
v_mfma_f32_16x16x32_bf16 v[196:199], a[180:183], a[140:143], v[196:199]
buffer_load_dwordx4 a[60:63], v2, s[12:15], s39 offen offset:1024 sc1
v_mfma_f32_16x16x32_bf16 v[192:195], a[176:179], a[140:143], v[192:195]
s_waitcnt lgkmcnt(4)
v_mfma_f32_16x16x32_bf16 v[200:203], a[160:163], a[140:143], v[200:203]
ds_read_b64_tr_b16 a[176:177], v246 offset:32768
v_mfma_f32_16x16x32_bf16 v[204:207], a[164:167], a[140:143], v[204:207]
ds_read_b64_tr_b16 a[178:179], v246 offset:36864
v_mfma_f32_16x16x32_bf16 v[172:175], a[164:167], a[136:139], v[172:175]
buffer_load_dwordx4 v87, s[72:75], s76 offen offset:3072 lds
v_mfma_f32_16x16x32_bf16 v[168:171], a[160:163], a[136:139], v[168:171]
s_add_u32 m0, s44, 102656
v_mfma_f32_16x16x32_bf16 v[136:139], a[160:163], a[132:135], v[136:139]
ds_read_b64_tr_b16 a[180:181], v247 offset:32768
v_mfma_f32_16x16x32_bf16 v[140:143], a[164:167], a[132:135], v[140:143]
ds_read_b64_tr_b16 a[182:183], v247 offset:36864
v_mfma_f32_16x16x32_bf16 v[108:111], a[164:167], a[128:131], v[108:111]
buffer_load_dwordx4 v84, s[72:75], s79 offen offset:0 lds
v_mfma_f32_16x16x32_bf16 v[104:107], a[160:163], a[128:131], v[104:107]
s_waitcnt lgkmcnt(4)
v_mfma_f32_16x16x32_bf16 v[112:115], a[168:171], a[128:131], v[112:115]
ds_read_b64_tr_b16 a[160:161], v240 offset:40960
s_xor_b32 s7, s2, 2
s_lshl_b32 s6, s7, 2
v_mfma_f32_16x16x32_bf16 v[116:119], a[172:175], a[128:131], v[116:119]
ds_read_b64_tr_b16 a[162:163], v240 offset:45056
v_mfma_f32_16x16x32_bf16 v[148:151], a[172:175], a[132:135], v[148:151]
buffer_load_dwordx4 v85, s[72:75], s79 offen offset:1024 lds
v_mfma_f32_16x16x32_bf16 v[144:147], a[168:171], a[132:135], v[144:147]
v_mfma_f32_16x16x32_bf16 v[176:179], a[168:171], a[136:139], v[176:179]
ds_read_b64_tr_b16 a[164:165], v241 offset:40960
v_mfma_f32_16x16x32_bf16 v[180:183], a[172:175], a[136:139], v[180:183]
ds_read_b64_tr_b16 a[166:167], v241 offset:45056
v_mfma_f32_16x16x32_bf16 v[212:215], a[172:175], a[140:143], v[212:215]
v_mfma_f32_16x16x32_bf16 v[208:211], a[168:171], a[140:143], v[208:211]
s_waitcnt lgkmcnt(4)
v_mfma_f32_16x16x32_bf16 v[216:219], a[176:179], a[140:143], v[216:219]
ds_read_b64_tr_b16 a[168:169], v242 offset:40960
v_mfma_f32_16x16x32_bf16 v[220:223], a[180:183], a[140:143], v[220:223]
ds_read_b64_tr_b16 a[170:171], v242 offset:45056
v_mfma_f32_16x16x32_bf16 v[188:191], a[180:183], a[136:139], v[188:191]
buffer_load_dwordx4 v86, s[72:75], s79 offen offset:2048 lds
v_mfma_f32_16x16x32_bf16 v[184:187], a[176:179], a[136:139], v[184:187]
v_mfma_f32_16x16x32_bf16 v[152:155], a[176:179], a[132:135], v[152:155]
ds_read_b64_tr_b16 a[172:173], v243 offset:40960
s_add_u32 s6, s6, s3
s_mul_i32 s6, s6, 12288
v_mfma_f32_16x16x32_bf16 v[156:159], a[180:183], a[132:135], v[156:159]
ds_read_b64_tr_b16 a[174:175], v243 offset:45056
v_mfma_f32_16x16x32_bf16 v[124:127], a[180:183], a[128:131], v[124:127]
buffer_load_dwordx4 a[64:67], v2, s[12:15], s36 offen offset:2048 sc1
v_mfma_f32_16x16x32_bf16 v[120:123], a[176:179], a[128:131], v[120:123]
s_waitcnt vmcnt(34) lgkmcnt(4)
v_mfma_f32_16x16x32_bf16 v[96:99], a[160:163], a[144:147], v[96:99]
ds_read_b64_tr_b16 a[176:177], v244 offset:40960
v_mfma_f32_16x16x32_bf16 v[100:103], a[164:167], a[144:147], v[100:103]
ds_read_b64_tr_b16 a[178:179], v244 offset:45056
v_mfma_f32_16x16x32_bf16 v[132:135], a[164:167], a[148:151], v[132:135]
buffer_load_dwordx4 a[68:71], v2, s[12:15], s37 offen offset:2048 sc1
v_mfma_f32_16x16x32_bf16 v[128:131], a[160:163], a[148:151], v[128:131]
v_mfma_f32_16x16x32_bf16 v[160:163], a[160:163], a[152:155], v[160:163]
ds_read_b64_tr_b16 a[180:181], v245 offset:40960
v_mfma_f32_16x16x32_bf16 v[164:167], a[164:167], a[152:155], v[164:167]
ds_read_b64_tr_b16 a[182:183], v245 offset:45056
v_mfma_f32_16x16x32_bf16 v[196:199], a[164:167], a[156:159], v[196:199]
buffer_load_dwordx4 a[72:75], v2, s[12:15], s38 offen offset:2048 sc1
v_mfma_f32_16x16x32_bf16 v[192:195], a[160:163], a[156:159], v[192:195]
s_waitcnt lgkmcnt(4)
v_mfma_f32_16x16x32_bf16 v[200:203], a[168:171], a[156:159], v[200:203]
ds_read_b64_tr_b16 a[160:161], v246 offset:40960
s_add_u32 s8, s6, 0
s_lshl_b32 s7, s7, 7
v_mfma_f32_16x16x32_bf16 v[204:207], a[172:175], a[156:159], v[204:207]
ds_read_b64_tr_b16 a[162:163], v246 offset:45056
v_mfma_f32_16x16x32_bf16 v[172:175], a[172:175], a[152:155], v[172:175]
v_mfma_f32_16x16x32_bf16 v[168:171], a[168:171], a[152:155], v[168:171]
v_mfma_f32_16x16x32_bf16 v[136:139], a[168:171], a[148:151], v[136:139]
ds_read_b64_tr_b16 a[164:165], v247 offset:40960
v_mfma_f32_16x16x32_bf16 v[140:143], a[172:175], a[148:151], v[140:143]
ds_read_b64_tr_b16 a[166:167], v247 offset:45056
v_mfma_f32_16x16x32_bf16 v[108:111], a[172:175], a[144:147], v[108:111]
buffer_load_dwordx4 a[76:79], v2, s[12:15], s39 offen offset:2048 sc1
v_mfma_f32_16x16x32_bf16 v[104:107], a[168:171], a[144:147], v[104:107]
s_waitcnt lgkmcnt(4)
v_mfma_f32_16x16x32_bf16 v[112:115], a[176:179], a[144:147], v[112:115]
ds_read_b64_tr_b16 a[168:169], v240 offset:49152
v_mfma_f32_16x16x32_bf16 v[116:119], a[180:183], a[144:147], v[116:119]
ds_read_b64_tr_b16 a[170:171], v240 offset:53248
v_mfma_f32_16x16x32_bf16 v[148:151], a[180:183], a[148:151], v[148:151]
buffer_load_dwordx4 v87, s[72:75], s79 offen offset:3072 lds
s_add_u32 s76, s76, 262144
s_add_u32 s79, s79, 262144
v_mfma_f32_16x16x32_bf16 v[144:147], a[176:179], a[148:151], v[144:147]
v_mfma_f32_16x16x32_bf16 v[176:179], a[176:179], a[152:155], v[176:179]
ds_read_b64_tr_b16 a[172:173], v241 offset:49152
s_lshl_b32 s6, s3, 2
s_add_u32 s6, s6, s7
v_mfma_f32_16x16x32_bf16 v[180:183], a[180:183], a[152:155], v[180:183]
ds_read_b64_tr_b16 a[174:175], v241 offset:53248
v_mfma_f32_16x16x32_bf16 v[212:215], a[180:183], a[156:159], v[212:215]
buffer_load_dwordx4 a[80:83], v2, s[12:15], s36 offen offset:3072 sc1
v_mfma_f32_16x16x32_bf16 v[208:211], a[176:179], a[156:159], v[208:211]
s_waitcnt lgkmcnt(4)
v_mfma_f32_16x16x32_bf16 v[216:219], a[160:163], a[156:159], v[216:219]
ds_read_b64_tr_b16 a[176:177], v242 offset:49152
v_mfma_f32_16x16x32_bf16 v[220:223], a[164:167], a[156:159], v[220:223]
ds_read_b64_tr_b16 a[178:179], v242 offset:53248
v_mfma_f32_16x16x32_bf16 v[188:191], a[164:167], a[152:155], v[188:191]
buffer_load_dwordx4 a[84:87], v2, s[12:15], s37 offen offset:3072 sc1
v_mfma_f32_16x16x32_bf16 v[184:187], a[160:163], a[152:155], v[184:187]
v_mfma_f32_16x16x32_bf16 v[152:155], a[160:163], a[148:151], v[152:155]
ds_read_b64_tr_b16 a[180:181], v243 offset:49152
v_mfma_f32_16x16x32_bf16 v[156:159], a[164:167], a[148:151], v[156:159]
ds_read_b64_tr_b16 a[182:183], v243 offset:53248
v_mfma_f32_16x16x32_bf16 v[124:127], a[164:167], a[144:147], v[124:127]
v_mfma_f32_16x16x32_bf16 v[120:123], a[160:163], a[144:147], v[120:123]
s_waitcnt vmcnt(27) lgkmcnt(4)
v_mfma_f32_16x16x32_bf16 v[96:99], a[168:171], a[0:3], v[96:99]
ds_read_b64_tr_b16 a[160:161], v244 offset:49152
s_add_u32 s20, s6, 64
v_mfma_f32_16x16x32_bf16 v[100:103], a[172:175], a[0:3], v[100:103]
ds_read_b64_tr_b16 a[162:163], v244 offset:53248
v_mfma_f32_16x16x32_bf16 v[132:135], a[172:175], a[4:7], v[132:135]
buffer_load_dwordx4 a[88:91], v2, s[12:15], s38 offen offset:3072 sc1
v_mfma_f32_16x16x32_bf16 v[128:131], a[168:171], a[4:7], v[128:131]
v_mfma_f32_16x16x32_bf16 v[160:163], a[168:171], a[8:11], v[160:163]
ds_read_b64_tr_b16 a[164:165], v245 offset:49152
v_mfma_f32_16x16x32_bf16 v[164:167], a[172:175], a[8:11], v[164:167]
ds_read_b64_tr_b16 a[166:167], v245 offset:53248
v_mfma_f32_16x16x32_bf16 v[196:199], a[172:175], a[12:15], v[196:199]
buffer_load_dwordx4 a[92:95], v2, s[12:15], s39 offen offset:3072 sc1
v_mfma_f32_16x16x32_bf16 v[192:195], a[168:171], a[12:15], v[192:195]
s_waitcnt lgkmcnt(4)
v_mfma_f32_16x16x32_bf16 v[200:203], a[176:179], a[12:15], v[200:203]
ds_read_b64_tr_b16 a[168:169], v246 offset:49152
v_mfma_f32_16x16x32_bf16 v[204:207], a[180:183], a[12:15], v[204:207]
ds_read_b64_tr_b16 a[170:171], v246 offset:53248
v_mfma_f32_16x16x32_bf16 v[172:175], a[180:183], a[8:11], v[172:175]
s_add_u32 s36, s36, 4096
s_add_u32 s37, s37, 4096
s_add_u32 s38, s38, 4096
s_add_u32 s39, s39, 4096
buffer_load_dwordx4 a[96:99], v2, s[12:15], s36 offen offset:0 sc1
v_mfma_f32_16x16x32_bf16 v[168:171], a[176:179], a[8:11], v[168:171]
v_mfma_f32_16x16x32_bf16 v[136:139], a[176:179], a[4:7], v[136:139]
ds_read_b64_tr_b16 a[172:173], v247 offset:49152
s_xor_b32 s7, s2, 4
s_lshl_b32 s6, s7, 2
v_mfma_f32_16x16x32_bf16 v[140:143], a[180:183], a[4:7], v[140:143]
ds_read_b64_tr_b16 a[174:175], v247 offset:53248
v_mfma_f32_16x16x32_bf16 v[108:111], a[180:183], a[0:3], v[108:111]
buffer_load_dwordx4 a[100:103], v2, s[12:15], s37 offen offset:0 sc1
v_mfma_f32_16x16x32_bf16 v[104:107], a[176:179], a[0:3], v[104:107]
s_waitcnt lgkmcnt(4)
v_mfma_f32_16x16x32_bf16 v[112:115], a[160:163], a[0:3], v[112:115]
ds_read_b64_tr_b16 a[176:177], v240 offset:57344
v_mfma_f32_16x16x32_bf16 v[116:119], a[164:167], a[0:3], v[116:119]
ds_read_b64_tr_b16 a[178:179], v240 offset:61440
v_mfma_f32_16x16x32_bf16 v[148:151], a[164:167], a[4:7], v[148:151]
v_mfma_f32_16x16x32_bf16 v[144:147], a[160:163], a[4:7], v[144:147]
v_mfma_f32_16x16x32_bf16 v[176:179], a[160:163], a[8:11], v[176:179]
ds_read_b64_tr_b16 a[180:181], v241 offset:57344
v_mfma_f32_16x16x32_bf16 v[180:183], a[164:167], a[8:11], v[180:183]
ds_read_b64_tr_b16 a[182:183], v241 offset:61440
v_mfma_f32_16x16x32_bf16 v[212:215], a[164:167], a[12:15], v[212:215]
buffer_load_dwordx4 a[104:107], v2, s[12:15], s38 offen offset:0 sc1
v_mfma_f32_16x16x32_bf16 v[208:211], a[160:163], a[12:15], v[208:211]
s_waitcnt lgkmcnt(4)
v_mfma_f32_16x16x32_bf16 v[216:219], a[168:171], a[12:15], v[216:219]
ds_read_b64_tr_b16 a[160:161], v242 offset:57344
s_add_u32 s6, s6, s3
s_mul_i32 s6, s6, 12288
v_mfma_f32_16x16x32_bf16 v[220:223], a[172:175], a[12:15], v[220:223]
ds_read_b64_tr_b16 a[162:163], v242 offset:61440
v_mfma_f32_16x16x32_bf16 v[188:191], a[172:175], a[8:11], v[188:191]
buffer_load_dwordx4 a[108:111], v2, s[12:15], s39 offen offset:0 sc1
v_mfma_f32_16x16x32_bf16 v[184:187], a[168:171], a[8:11], v[184:187]
s_add_u32 m0, s44, 256
v_mfma_f32_16x16x32_bf16 v[152:155], a[168:171], a[4:7], v[152:155]
ds_read_b64_tr_b16 a[164:165], v243 offset:57344
v_mfma_f32_16x16x32_bf16 v[156:159], a[172:175], a[4:7], v[156:159]
ds_read_b64_tr_b16 a[166:167], v243 offset:61440
v_mfma_f32_16x16x32_bf16 v[124:127], a[172:175], a[0:3], v[124:127]
buffer_load_dwordx4 v84, s[72:75], s76 offen offset:0 lds
v_mfma_f32_16x16x32_bf16 v[120:123], a[168:171], a[0:3], v[120:123]
s_waitcnt vmcnt(29) lgkmcnt(4)
v_mfma_f32_16x16x32_bf16 v[96:99], a[176:179], a[16:19], v[96:99]
ds_read_b64_tr_b16 a[168:169], v244 offset:57344
v_mfma_f32_16x16x32_bf16 v[100:103], a[180:183], a[16:19], v[100:103]
ds_read_b64_tr_b16 a[170:171], v244 offset:61440
v_mfma_f32_16x16x32_bf16 v[132:135], a[180:183], a[20:23], v[132:135]
buffer_load_dwordx4 v85, s[72:75], s76 offen offset:1024 lds
v_mfma_f32_16x16x32_bf16 v[128:131], a[176:179], a[20:23], v[128:131]
v_mfma_f32_16x16x32_bf16 v[160:163], a[176:179], a[24:27], v[160:163]
ds_read_b64_tr_b16 a[172:173], v245 offset:57344
s_add_u32 s9, s6, 4096
s_lshl_b32 s7, s7, 7
v_mfma_f32_16x16x32_bf16 v[164:167], a[180:183], a[24:27], v[164:167]
ds_read_b64_tr_b16 a[174:175], v245 offset:61440
v_mfma_f32_16x16x32_bf16 v[196:199], a[180:183], a[28:31], v[196:199]
v_mfma_f32_16x16x32_bf16 v[192:195], a[176:179], a[28:31], v[192:195]
s_waitcnt lgkmcnt(4)
v_mfma_f32_16x16x32_bf16 v[200:203], a[160:163], a[28:31], v[200:203]
ds_read_b64_tr_b16 a[176:177], v246 offset:57344
v_mfma_f32_16x16x32_bf16 v[204:207], a[164:167], a[28:31], v[204:207]
ds_read_b64_tr_b16 a[178:179], v246 offset:61440
v_mfma_f32_16x16x32_bf16 v[172:175], a[164:167], a[24:27], v[172:175]
buffer_load_dwordx4 v86, s[72:75], s76 offen offset:2048 lds
v_mfma_f32_16x16x32_bf16 v[168:171], a[160:163], a[24:27], v[168:171]
v_mfma_f32_16x16x32_bf16 v[136:139], a[160:163], a[20:23], v[136:139]
ds_read_b64_tr_b16 a[180:181], v247 offset:57344
v_mfma_f32_16x16x32_bf16 v[140:143], a[164:167], a[20:23], v[140:143]
ds_read_b64_tr_b16 a[182:183], v247 offset:61440
v_mfma_f32_16x16x32_bf16 v[108:111], a[164:167], a[16:19], v[108:111]
buffer_load_dwordx2 a[112:113], v9, s[12:15], s36 offen offset:1024 sc1
buffer_load_dwordx2 a[114:115], v9, s[12:15], s36 offen offset:1536 sc1
v_mfma_f32_16x16x32_bf16 v[104:107], a[160:163], a[16:19], v[104:107]
s_waitcnt lgkmcnt(4)
v_mfma_f32_16x16x32_bf16 v[112:115], a[168:171], a[16:19], v[112:115]
s_waitcnt vmcnt(37)
s_barrier
v_xor_b32 v240, 0x10000, v240
ds_read_b64_tr_b16 a[160:161], v240 offset:0
s_lshl_b32 s6, s3, 2
s_add_u32 s6, s6, s7
v_mfma_f32_16x16x32_bf16 v[116:119], a[172:175], a[16:19], v[116:119]
ds_read_b64_tr_b16 a[162:163], v240 offset:4096
v_mfma_f32_16x16x32_bf16 v[148:151], a[172:175], a[20:23], v[148:151]
buffer_load_dwordx2 a[116:117], v9, s[12:15], s37 offen offset:1024 sc1
buffer_load_dwordx2 a[118:119], v9, s[12:15], s37 offen offset:1536 sc1
v_mfma_f32_16x16x32_bf16 v[144:147], a[168:171], a[20:23], v[144:147]
v_mfma_f32_16x16x32_bf16 v[176:179], a[168:171], a[24:27], v[176:179]
v_xor_b32 v241, 0x10000, v241
ds_read_b64_tr_b16 a[164:165], v241 offset:0
v_mfma_f32_16x16x32_bf16 v[180:183], a[172:175], a[24:27], v[180:183]
ds_read_b64_tr_b16 a[166:167], v241 offset:4096
v_mfma_f32_16x16x32_bf16 v[212:215], a[172:175], a[28:31], v[212:215]
buffer_load_dwordx2 a[120:121], v9, s[12:15], s38 offen offset:1024 sc1
buffer_load_dwordx2 a[122:123], v9, s[12:15], s38 offen offset:1536 sc1
v_mfma_f32_16x16x32_bf16 v[208:211], a[168:171], a[28:31], v[208:211]
s_waitcnt lgkmcnt(4)
v_mfma_f32_16x16x32_bf16 v[216:219], a[176:179], a[28:31], v[216:219]
v_xor_b32 v242, 0x10000, v242
ds_read_b64_tr_b16 a[168:169], v242 offset:0
v_mfma_f32_16x16x32_bf16 v[220:223], a[180:183], a[28:31], v[220:223]
ds_read_b64_tr_b16 a[170:171], v242 offset:4096
v_mfma_f32_16x16x32_bf16 v[188:191], a[180:183], a[24:27], v[188:191]
v_mfma_f32_16x16x32_bf16 v[184:187], a[176:179], a[24:27], v[184:187]
v_mfma_f32_16x16x32_bf16 v[152:155], a[176:179], a[20:23], v[152:155]
v_xor_b32 v243, 0x10000, v243
ds_read_b64_tr_b16 a[172:173], v243 offset:0
s_add_u32 s21, s6, 80
v_mfma_f32_16x16x32_bf16 v[156:159], a[180:183], a[20:23], v[156:159]
ds_read_b64_tr_b16 a[174:175], v243 offset:4096
v_mfma_f32_16x16x32_bf16 v[124:127], a[180:183], a[16:19], v[124:127]
buffer_load_dwordx2 a[124:125], v9, s[12:15], s39 offen offset:1024 sc1
buffer_load_dwordx2 a[126:127], v9, s[12:15], s39 offen offset:1536 sc1
v_mfma_f32_16x16x32_bf16 v[120:123], a[176:179], a[16:19], v[120:123]
s_waitcnt vmcnt(35) lgkmcnt(4)
v_mfma_f32_16x16x32_bf16 v[96:99], a[160:163], a[32:35], v[96:99]
v_xor_b32 v244, 0x10000, v244
ds_read_b64_tr_b16 a[176:177], v244 offset:0
v_mfma_f32_16x16x32_bf16 v[100:103], a[164:167], a[32:35], v[100:103]
ds_read_b64_tr_b16 a[178:179], v244 offset:4096
v_mfma_f32_16x16x32_bf16 v[132:135], a[164:167], a[36:39], v[132:135]
buffer_load_dwordx4 v87, s[72:75], s76 offen offset:3072 lds
v_mfma_f32_16x16x32_bf16 v[128:131], a[160:163], a[36:39], v[128:131]
s_add_u32 m0, s44, 4352
v_mfma_f32_16x16x32_bf16 v[160:163], a[160:163], a[40:43], v[160:163]
v_xor_b32 v245, 0x10000, v245
ds_read_b64_tr_b16 a[180:181], v245 offset:0
v_mfma_f32_16x16x32_bf16 v[164:167], a[164:167], a[40:43], v[164:167]
ds_read_b64_tr_b16 a[182:183], v245 offset:4096
v_mfma_f32_16x16x32_bf16 v[196:199], a[164:167], a[44:47], v[196:199]
buffer_load_dwordx4 v84, s[72:75], s79 offen offset:0 lds
v_mfma_f32_16x16x32_bf16 v[192:195], a[160:163], a[44:47], v[192:195]
s_waitcnt lgkmcnt(4)
v_mfma_f32_16x16x32_bf16 v[200:203], a[168:171], a[44:47], v[200:203]
v_xor_b32 v246, 0x10000, v246
ds_read_b64_tr_b16 a[160:161], v246 offset:0
s_xor_b32 s7, s2, 6
s_lshl_b32 s6, s7, 2
v_mfma_f32_16x16x32_bf16 v[204:207], a[172:175], a[44:47], v[204:207]
ds_read_b64_tr_b16 a[162:163], v246 offset:4096
v_mfma_f32_16x16x32_bf16 v[172:175], a[172:175], a[40:43], v[172:175]
buffer_load_dwordx4 v85, s[72:75], s79 offen offset:1024 lds
v_mfma_f32_16x16x32_bf16 v[168:171], a[168:171], a[40:43], v[168:171]
v_mfma_f32_16x16x32_bf16 v[136:139], a[168:171], a[36:39], v[136:139]
v_xor_b32 v247, 0x10000, v247
ds_read_b64_tr_b16 a[164:165], v247 offset:0
v_mfma_f32_16x16x32_bf16 v[140:143], a[172:175], a[36:39], v[140:143]
ds_read_b64_tr_b16 a[166:167], v247 offset:4096
v_mfma_f32_16x16x32_bf16 v[108:111], a[172:175], a[32:35], v[108:111]
v_mfma_f32_16x16x32_bf16 v[104:107], a[168:171], a[32:35], v[104:107]
s_waitcnt lgkmcnt(4)
v_mfma_f32_16x16x32_bf16 v[112:115], a[176:179], a[32:35], v[112:115]
ds_read_b64_tr_b16 a[168:169], v240 offset:8192
v_mfma_f32_16x16x32_bf16 v[116:119], a[180:183], a[32:35], v[116:119]
ds_read_b64_tr_b16 a[170:171], v240 offset:12288
v_mfma_f32_16x16x32_bf16 v[148:151], a[180:183], a[36:39], v[148:151]
buffer_load_dwordx4 v86, s[72:75], s79 offen offset:2048 lds
v_mfma_f32_16x16x32_bf16 v[144:147], a[176:179], a[36:39], v[144:147]
v_mfma_f32_16x16x32_bf16 v[176:179], a[176:179], a[40:43], v[176:179]
ds_read_b64_tr_b16 a[172:173], v241 offset:8192
s_add_u32 s6, s6, s3
s_mul_i32 s6, s6, 12288
v_mfma_f32_16x16x32_bf16 v[180:183], a[180:183], a[40:43], v[180:183]
ds_read_b64_tr_b16 a[174:175], v241 offset:12288
v_mfma_f32_16x16x32_bf16 v[212:215], a[180:183], a[44:47], v[212:215]
buffer_load_dwordx4 a[128:131], v2, s[12:15], s36 offen offset:2048 sc1
v_mfma_f32_16x16x32_bf16 v[208:211], a[176:179], a[44:47], v[208:211]
s_waitcnt lgkmcnt(4)
v_mfma_f32_16x16x32_bf16 v[216:219], a[160:163], a[44:47], v[216:219]
ds_read_b64_tr_b16 a[176:177], v242 offset:8192
v_mfma_f32_16x16x32_bf16 v[220:223], a[164:167], a[44:47], v[220:223]
ds_read_b64_tr_b16 a[178:179], v242 offset:12288
v_mfma_f32_16x16x32_bf16 v[188:191], a[164:167], a[40:43], v[188:191]
buffer_load_dwordx4 a[132:135], v2, s[12:15], s37 offen offset:2048 sc1
v_mfma_f32_16x16x32_bf16 v[184:187], a[160:163], a[40:43], v[184:187]
v_mfma_f32_16x16x32_bf16 v[152:155], a[160:163], a[36:39], v[152:155]
ds_read_b64_tr_b16 a[180:181], v243 offset:8192
v_mfma_f32_16x16x32_bf16 v[156:159], a[164:167], a[36:39], v[156:159]
ds_read_b64_tr_b16 a[182:183], v243 offset:12288
v_mfma_f32_16x16x32_bf16 v[124:127], a[164:167], a[32:35], v[124:127]
buffer_load_dwordx4 a[136:139], v2, s[12:15], s38 offen offset:2048 sc1
v_mfma_f32_16x16x32_bf16 v[120:123], a[160:163], a[32:35], v[120:123]
s_waitcnt vmcnt(35) lgkmcnt(4)
v_mfma_f32_16x16x32_bf16 v[96:99], a[168:171], a[48:51], v[96:99]
ds_read_b64_tr_b16 a[160:161], v244 offset:8192
s_add_u32 s10, s6, 8192
s_lshl_b32 s7, s7, 7
v_mfma_f32_16x16x32_bf16 v[100:103], a[172:175], a[48:51], v[100:103]
ds_read_b64_tr_b16 a[162:163], v244 offset:12288
v_mfma_f32_16x16x32_bf16 v[132:135], a[172:175], a[52:55], v[132:135]
v_mfma_f32_16x16x32_bf16 v[128:131], a[168:171], a[52:55], v[128:131]
v_mfma_f32_16x16x32_bf16 v[160:163], a[168:171], a[56:59], v[160:163]
ds_read_b64_tr_b16 a[164:165], v245 offset:8192
v_mfma_f32_16x16x32_bf16 v[164:167], a[172:175], a[56:59], v[164:167]
ds_read_b64_tr_b16 a[166:167], v245 offset:12288
v_mfma_f32_16x16x32_bf16 v[196:199], a[172:175], a[60:63], v[196:199]
buffer_load_dwordx4 a[140:143], v2, s[12:15], s39 offen offset:2048 sc1
v_mfma_f32_16x16x32_bf16 v[192:195], a[168:171], a[60:63], v[192:195]
s_waitcnt lgkmcnt(4)
v_mfma_f32_16x16x32_bf16 v[200:203], a[176:179], a[60:63], v[200:203]
ds_read_b64_tr_b16 a[168:169], v246 offset:8192
v_mfma_f32_16x16x32_bf16 v[204:207], a[180:183], a[60:63], v[204:207]
ds_read_b64_tr_b16 a[170:171], v246 offset:12288
v_mfma_f32_16x16x32_bf16 v[172:175], a[180:183], a[56:59], v[172:175]
buffer_load_dwordx4 v87, s[72:75], s79 offen offset:3072 lds
s_add_u32 s76, s76, 262144
s_add_u32 s79, s79, 262144
v_mfma_f32_16x16x32_bf16 v[168:171], a[176:179], a[56:59], v[168:171]
v_mfma_f32_16x16x32_bf16 v[136:139], a[176:179], a[52:55], v[136:139]
ds_read_b64_tr_b16 a[172:173], v247 offset:8192
s_lshl_b32 s6, s3, 2
s_add_u32 s6, s6, s7
v_mfma_f32_16x16x32_bf16 v[140:143], a[180:183], a[52:55], v[140:143]
ds_read_b64_tr_b16 a[174:175], v247 offset:12288
v_mfma_f32_16x16x32_bf16 v[108:111], a[180:183], a[48:51], v[108:111]
buffer_load_dwordx4 a[144:147], v2, s[12:15], s36 offen offset:3072 sc1
v_mfma_f32_16x16x32_bf16 v[104:107], a[176:179], a[48:51], v[104:107]
s_waitcnt lgkmcnt(4)
v_mfma_f32_16x16x32_bf16 v[112:115], a[160:163], a[48:51], v[112:115]
ds_read_b64_tr_b16 a[176:177], v240 offset:16384
v_mfma_f32_16x16x32_bf16 v[116:119], a[164:167], a[48:51], v[116:119]
ds_read_b64_tr_b16 a[178:179], v240 offset:20480
v_mfma_f32_16x16x32_bf16 v[148:151], a[164:167], a[52:55], v[148:151]
buffer_load_dwordx4 a[148:151], v2, s[12:15], s37 offen offset:3072 sc1
v_mfma_f32_16x16x32_bf16 v[144:147], a[160:163], a[52:55], v[144:147]
v_mfma_f32_16x16x32_bf16 v[176:179], a[160:163], a[56:59], v[176:179]
ds_read_b64_tr_b16 a[180:181], v241 offset:16384
v_mfma_f32_16x16x32_bf16 v[180:183], a[164:167], a[56:59], v[180:183]
ds_read_b64_tr_b16 a[182:183], v241 offset:20480
v_mfma_f32_16x16x32_bf16 v[212:215], a[164:167], a[60:63], v[212:215]
v_mfma_f32_16x16x32_bf16 v[208:211], a[160:163], a[60:63], v[208:211]
s_waitcnt lgkmcnt(4)
v_mfma_f32_16x16x32_bf16 v[216:219], a[168:171], a[60:63], v[216:219]
ds_read_b64_tr_b16 a[160:161], v242 offset:16384
s_add_u32 s22, s6, 96
v_mfma_f32_16x16x32_bf16 v[220:223], a[172:175], a[60:63], v[220:223]
ds_read_b64_tr_b16 a[162:163], v242 offset:20480
v_mfma_f32_16x16x32_bf16 v[188:191], a[172:175], a[56:59], v[188:191]
buffer_load_dwordx4 a[152:155], v2, s[12:15], s38 offen offset:3072 sc1
v_mfma_f32_16x16x32_bf16 v[184:187], a[168:171], a[56:59], v[184:187]
v_mfma_f32_16x16x32_bf16 v[152:155], a[168:171], a[52:55], v[152:155]
ds_read_b64_tr_b16 a[164:165], v243 offset:16384
v_mfma_f32_16x16x32_bf16 v[156:159], a[172:175], a[52:55], v[156:159]
ds_read_b64_tr_b16 a[166:167], v243 offset:20480
v_mfma_f32_16x16x32_bf16 v[124:127], a[172:175], a[48:51], v[124:127]
buffer_load_dwordx4 a[156:159], v2, s[12:15], s39 offen offset:3072 sc1
v_mfma_f32_16x16x32_bf16 v[120:123], a[168:171], a[48:51], v[120:123]
s_waitcnt vmcnt(33) lgkmcnt(4)
v_mfma_f32_16x16x32_bf16 v[96:99], a[176:179], a[64:67], v[96:99]
ds_read_b64_tr_b16 a[168:169], v244 offset:16384
v_mfma_f32_16x16x32_bf16 v[100:103], a[180:183], a[64:67], v[100:103]
ds_read_b64_tr_b16 a[170:171], v244 offset:20480
v_mfma_f32_16x16x32_bf16 v[132:135], a[180:183], a[68:71], v[132:135]
s_add_u32 s36, s36, 4096
s_add_u32 s37, s37, 4096
s_add_u32 s38, s38, 4096
s_add_u32 s39, s39, 4096
buffer_load_dwordx4 a[0:3], v2, s[12:15], s36 offen offset:0 sc1
buffer_load_dword v23, v88, s[32:35], s45 offen sc1
v_mfma_f32_16x16x32_bf16 v[128:131], a[176:179], a[68:71], v[128:131]
v_mfma_f32_16x16x32_bf16 v[160:163], a[176:179], a[72:75], v[160:163]
ds_read_b64_tr_b16 a[172:173], v245 offset:16384
s_lshl_b32 s6, s2, 7
s_lshl_b32 s7, s3, 2
v_mfma_f32_16x16x32_bf16 v[164:167], a[180:183], a[72:75], v[164:167]
ds_read_b64_tr_b16 a[174:175], v245 offset:20480
v_mfma_f32_16x16x32_bf16 v[196:199], a[180:183], a[76:79], v[196:199]
buffer_load_dwordx4 a[4:7], v2, s[12:15], s37 offen offset:0 sc1
v_mfma_f32_16x16x32_bf16 v[192:195], a[176:179], a[76:79], v[192:195]
s_waitcnt lgkmcnt(4)
v_mfma_f32_16x16x32_bf16 v[200:203], a[160:163], a[76:79], v[200:203]
ds_read_b64_tr_b16 a[176:177], v246 offset:16384
v_mfma_f32_16x16x32_bf16 v[204:207], a[164:167], a[76:79], v[204:207]
ds_read_b64_tr_b16 a[178:179], v246 offset:20480
v_mfma_f32_16x16x32_bf16 v[172:175], a[164:167], a[72:75], v[172:175]
v_mfma_f32_16x16x32_bf16 v[168:171], a[160:163], a[72:75], v[168:171]
v_mfma_f32_16x16x32_bf16 v[136:139], a[160:163], a[68:71], v[136:139]
ds_read_b64_tr_b16 a[180:181], v247 offset:16384
v_mfma_f32_16x16x32_bf16 v[140:143], a[164:167], a[68:71], v[140:143]
ds_read_b64_tr_b16 a[182:183], v247 offset:20480
v_mfma_f32_16x16x32_bf16 v[108:111], a[164:167], a[64:67], v[108:111]
buffer_load_dwordx4 a[8:11], v2, s[12:15], s38 offen offset:0 sc1
v_mfma_f32_16x16x32_bf16 v[104:107], a[160:163], a[64:67], v[104:107]
s_waitcnt lgkmcnt(4)
v_mfma_f32_16x16x32_bf16 v[112:115], a[168:171], a[64:67], v[112:115]
ds_read_b64_tr_b16 a[160:161], v240 offset:24576
s_add_u32 s71, s6, s7
s_add_u32 s71, s71, 64
v_mfma_f32_16x16x32_bf16 v[116:119], a[172:175], a[64:67], v[116:119]
ds_read_b64_tr_b16 a[162:163], v240 offset:28672
v_mfma_f32_16x16x32_bf16 v[148:151], a[172:175], a[68:71], v[148:151]
buffer_load_dwordx4 a[12:15], v2, s[12:15], s39 offen offset:0 sc1
v_mfma_f32_16x16x32_bf16 v[144:147], a[168:171], a[68:71], v[144:147]
s_add_u32 m0, s44, 33024
v_mfma_f32_16x16x32_bf16 v[176:179], a[168:171], a[72:75], v[176:179]
ds_read_b64_tr_b16 a[164:165], v241 offset:24576
v_mfma_f32_16x16x32_bf16 v[180:183], a[172:175], a[72:75], v[180:183]
ds_read_b64_tr_b16 a[166:167], v241 offset:28672
v_mfma_f32_16x16x32_bf16 v[212:215], a[172:175], a[76:79], v[212:215]
buffer_load_dwordx4 v84, s[72:75], s76 offen offset:0 lds
v_mfma_f32_16x16x32_bf16 v[208:211], a[168:171], a[76:79], v[208:211]
s_waitcnt lgkmcnt(4)
v_mfma_f32_16x16x32_bf16 v[216:219], a[176:179], a[76:79], v[216:219]
ds_read_b64_tr_b16 a[168:169], v242 offset:24576
v_mfma_f32_16x16x32_bf16 v[220:223], a[180:183], a[76:79], v[220:223]
ds_read_b64_tr_b16 a[170:171], v242 offset:28672
v_mfma_f32_16x16x32_bf16 v[188:191], a[180:183], a[72:75], v[188:191]
buffer_load_dwordx4 v85, s[72:75], s76 offen offset:1024 lds
v_mfma_f32_16x16x32_bf16 v[184:187], a[176:179], a[72:75], v[184:187]
v_mfma_f32_16x16x32_bf16 v[152:155], a[176:179], a[68:71], v[152:155]
ds_read_b64_tr_b16 a[172:173], v243 offset:24576
v_mfma_f32_16x16x32_bf16 v[156:159], a[180:183], a[68:71], v[156:159]
ds_read_b64_tr_b16 a[174:175], v243 offset:28672
v_mfma_f32_16x16x32_bf16 v[124:127], a[180:183], a[64:67], v[124:127]
v_mfma_f32_16x16x32_bf16 v[120:123], a[176:179], a[64:67], v[120:123]
s_waitcnt vmcnt(35) lgkmcnt(4)
v_mfma_f32_16x16x32_bf16 v[96:99], a[160:163], a[80:83], v[96:99]
ds_read_b64_tr_b16 a[176:177], v244 offset:24576
v_mfma_f32_16x16x32_bf16 v[100:103], a[164:167], a[80:83], v[100:103]
ds_read_b64_tr_b16 a[178:179], v244 offset:28672
v_mfma_f32_16x16x32_bf16 v[132:135], a[164:167], a[84:87], v[132:135]
buffer_load_dwordx4 v86, s[72:75], s76 offen offset:2048 lds
v_mfma_f32_16x16x32_bf16 v[128:131], a[160:163], a[84:87], v[128:131]
v_mfma_f32_16x16x32_bf16 v[160:163], a[160:163], a[88:91], v[160:163]
ds_read_b64_tr_b16 a[180:181], v245 offset:24576
v_mfma_f32_16x16x32_bf16 v[164:167], a[164:167], a[88:91], v[164:167]
ds_read_b64_tr_b16 a[182:183], v245 offset:28672
v_mfma_f32_16x16x32_bf16 v[196:199], a[164:167], a[92:95], v[196:199]
buffer_load_dwordx4 a[16:19], v2, s[12:15], s36 offen offset:1024 sc1
v_mfma_f32_16x16x32_bf16 v[192:195], a[160:163], a[92:95], v[192:195]
s_waitcnt lgkmcnt(4)
v_mfma_f32_16x16x32_bf16 v[200:203], a[168:171], a[92:95], v[200:203]
ds_read_b64_tr_b16 a[160:161], v246 offset:24576
v_mfma_f32_16x16x32_bf16 v[204:207], a[172:175], a[92:95], v[204:207]
ds_read_b64_tr_b16 a[162:163], v246 offset:28672
v_mfma_f32_16x16x32_bf16 v[172:175], a[172:175], a[88:91], v[172:175]
buffer_load_dwordx4 a[20:23], v2, s[12:15], s37 offen offset:1024 sc1
v_mfma_f32_16x16x32_bf16 v[168:171], a[168:171], a[88:91], v[168:171]
v_mfma_f32_16x16x32_bf16 v[136:139], a[168:171], a[84:87], v[136:139]
ds_read_b64_tr_b16 a[164:165], v247 offset:24576
v_mfma_f32_16x16x32_bf16 v[140:143], a[172:175], a[84:87], v[140:143]
ds_read_b64_tr_b16 a[166:167], v247 offset:28672
v_mfma_f32_16x16x32_bf16 v[108:111], a[172:175], a[80:83], v[108:111]
buffer_load_dwordx4 a[24:27], v2, s[12:15], s38 offen offset:1024 sc1
v_mfma_f32_16x16x32_bf16 v[104:107], a[168:171], a[80:83], v[104:107]
s_waitcnt lgkmcnt(4)
v_mfma_f32_16x16x32_bf16 v[112:115], a[176:179], a[80:83], v[112:115]
s_waitcnt vmcnt(43)
s_barrier
ds_read_b64_tr_b16 a[168:169], v240 offset:32768
v_mfma_f32_16x16x32_bf16 v[116:119], a[180:183], a[80:83], v[116:119]
ds_read_b64_tr_b16 a[170:171], v240 offset:36864
v_mfma_f32_16x16x32_bf16 v[148:151], a[180:183], a[84:87], v[148:151]
v_mfma_f32_16x16x32_bf16 v[144:147], a[176:179], a[84:87], v[144:147]
v_mfma_f32_16x16x32_bf16 v[176:179], a[176:179], a[88:91], v[176:179]
ds_read_b64_tr_b16 a[172:173], v241 offset:32768
v_mfma_f32_16x16x32_bf16 v[180:183], a[180:183], a[88:91], v[180:183]
ds_read_b64_tr_b16 a[174:175], v241 offset:36864
v_mfma_f32_16x16x32_bf16 v[212:215], a[180:183], a[92:95], v[212:215]
buffer_load_dwordx4 a[28:31], v2, s[12:15], s39 offen offset:1024 sc1
v_mfma_f32_16x16x32_bf16 v[208:211], a[176:179], a[92:95], v[208:211]
s_waitcnt lgkmcnt(4)
v_mfma_f32_16x16x32_bf16 v[216:219], a[160:163], a[92:95], v[216:219]
ds_read_b64_tr_b16 a[176:177], v242 offset:32768
v_mfma_f32_16x16x32_bf16 v[220:223], a[164:167], a[92:95], v[220:223]
ds_read_b64_tr_b16 a[178:179], v242 offset:36864
v_mfma_f32_16x16x32_bf16 v[188:191], a[164:167], a[88:91], v[188:191]
buffer_load_dwordx4 v87, s[72:75], s76 offen offset:3072 lds
v_mfma_f32_16x16x32_bf16 v[184:187], a[160:163], a[88:91], v[184:187]
s_add_u32 m0, s44, 37120
v_mfma_f32_16x16x32_bf16 v[152:155], a[160:163], a[84:87], v[152:155]
ds_read_b64_tr_b16 a[180:181], v243 offset:32768
v_mfma_f32_16x16x32_bf16 v[156:159], a[164:167], a[84:87], v[156:159]
ds_read_b64_tr_b16 a[182:183], v243 offset:36864
v_mfma_f32_16x16x32_bf16 v[124:127], a[164:167], a[80:83], v[124:127]
buffer_load_dwordx4 v84, s[72:75], s79 offen offset:0 lds
v_mfma_f32_16x16x32_bf16 v[120:123], a[160:163], a[80:83], v[120:123]
s_waitcnt vmcnt(38) lgkmcnt(4)
v_mfma_f32_16x16x32_bf16 v[96:99], a[168:171], a[96:99], v[96:99]
ds_read_b64_tr_b16 a[160:161], v244 offset:32768
v_mfma_f32_16x16x32_bf16 v[100:103], a[172:175], a[96:99], v[100:103]
ds_read_b64_tr_b16 a[162:163], v244 offset:36864
v_mfma_f32_16x16x32_bf16 v[132:135], a[172:175], a[100:103], v[132:135]
buffer_load_dwordx4 v85, s[72:75], s79 offen offset:1024 lds
v_mfma_f32_16x16x32_bf16 v[128:131], a[168:171], a[100:103], v[128:131]
v_mfma_f32_16x16x32_bf16 v[160:163], a[168:171], a[104:107], v[160:163]
ds_read_b64_tr_b16 a[164:165], v245 offset:32768
v_mfma_f32_16x16x32_bf16 v[164:167], a[172:175], a[104:107], v[164:167]
ds_read_b64_tr_b16 a[166:167], v245 offset:36864
v_mfma_f32_16x16x32_bf16 v[196:199], a[172:175], a[108:111], v[196:199]
v_mfma_f32_16x16x32_bf16 v[192:195], a[168:171], a[108:111], v[192:195]
s_waitcnt lgkmcnt(4)
v_mfma_f32_16x16x32_bf16 v[200:203], a[176:179], a[108:111], v[200:203]
ds_read_b64_tr_b16 a[168:169], v246 offset:32768
v_mfma_f32_16x16x32_bf16 v[204:207], a[180:183], a[108:111], v[204:207]
ds_read_b64_tr_b16 a[170:171], v246 offset:36864
v_mfma_f32_16x16x32_bf16 v[172:175], a[180:183], a[104:107], v[172:175]
buffer_load_dwordx4 v86, s[72:75], s79 offen offset:2048 lds
v_mfma_f32_16x16x32_bf16 v[168:171], a[176:179], a[104:107], v[168:171]
v_mfma_f32_16x16x32_bf16 v[136:139], a[176:179], a[100:103], v[136:139]
ds_read_b64_tr_b16 a[172:173], v247 offset:32768
v_mfma_f32_16x16x32_bf16 v[140:143], a[180:183], a[100:103], v[140:143]
ds_read_b64_tr_b16 a[174:175], v247 offset:36864
v_mfma_f32_16x16x32_bf16 v[108:111], a[180:183], a[96:99], v[108:111]
buffer_load_dwordx4 a[32:35], v2, s[12:15], s36 offen offset:2048 sc1
v_mfma_f32_16x16x32_bf16 v[104:107], a[176:179], a[96:99], v[104:107]
s_waitcnt lgkmcnt(4)
v_mfma_f32_16x16x32_bf16 v[112:115], a[160:163], a[96:99], v[112:115]
ds_read_b64_tr_b16 a[176:177], v240 offset:40960
v_mfma_f32_16x16x32_bf16 v[116:119], a[164:167], a[96:99], v[116:119]
ds_read_b64_tr_b16 a[178:179], v240 offset:45056
v_mfma_f32_16x16x32_bf16 v[148:151], a[164:167], a[100:103], v[148:151]
buffer_load_dwordx4 a[36:39], v2, s[12:15], s37 offen offset:2048 sc1
v_mfma_f32_16x16x32_bf16 v[144:147], a[160:163], a[100:103], v[144:147]
s_waitcnt vmcnt(16)
v_cmp_ne_u32 vcc, s68, v23
s_nop 4
s_cbranch_vccz L_po_ok
s_mov_b32 s6, 0
L_po_chk:
buffer_load_dword v0, v88, s[32:35], s45 offen sc1
s_add_u32 s6, s6, 1
s_waitcnt vmcnt(0)
v_cmp_ne_u32 vcc, s68, v0
s_nop 4
s_cbranch_vccz L_po_ok
s_cmp_lt_u32 s6, 0x20000
s_cbranch_scc1 L_po_chk
L_po_ok:
v_mfma_f32_16x16x32_bf16 v[176:179], a[160:163], a[104:107], v[176:179]
ds_read_b64_tr_b16 a[180:181], v241 offset:40960
v_mfma_f32_16x16x32_bf16 v[180:183], a[164:167], a[104:107], v[180:183]
ds_read_b64_tr_b16 a[182:183], v241 offset:45056
v_mfma_f32_16x16x32_bf16 v[212:215], a[164:167], a[108:111], v[212:215]
buffer_load_dwordx4 a[40:43], v2, s[12:15], s38 offen offset:2048 sc1
v_mfma_f32_16x16x32_bf16 v[208:211], a[160:163], a[108:111], v[208:211]
s_waitcnt lgkmcnt(4)
v_mfma_f32_16x16x32_bf16 v[216:219], a[168:171], a[108:111], v[216:219]
ds_read_b64_tr_b16 a[160:161], v242 offset:40960
v_mfma_f32_16x16x32_bf16 v[220:223], a[172:175], a[108:111], v[220:223]
ds_read_b64_tr_b16 a[162:163], v242 offset:45056
v_mfma_f32_16x16x32_bf16 v[188:191], a[172:175], a[104:107], v[188:191]
v_mfma_f32_16x16x32_bf16 v[184:187], a[168:171], a[104:107], v[184:187]
v_mfma_f32_16x16x32_bf16 v[152:155], a[168:171], a[100:103], v[152:155]
ds_read_b64_tr_b16 a[164:165], v243 offset:40960
v_mfma_f32_16x16x32_bf16 v[156:159], a[172:175], a[100:103], v[156:159]
ds_read_b64_tr_b16 a[166:167], v243 offset:45056
v_mfma_f32_16x16x32_bf16 v[124:127], a[172:175], a[96:99], v[124:127]
buffer_load_dwordx4 a[44:47], v2, s[12:15], s39 offen offset:2048 sc1
v_mfma_f32_16x16x32_bf16 v[120:123], a[168:171], a[96:99], v[120:123]
s_waitcnt vmcnt(33) lgkmcnt(4)
v_mfma_f32_16x16x32_bf16 v[96:99], a[176:179], a[112:115], v[96:99]
ds_read_b64_tr_b16 a[168:169], v244 offset:40960
v_mfma_f32_16x16x32_bf16 v[100:103], a[180:183], a[112:115], v[100:103]
ds_read_b64_tr_b16 a[170:171], v244 offset:45056
v_mfma_f32_16x16x32_bf16 v[132:135], a[180:183], a[116:119], v[132:135]
buffer_load_dwordx4 v87, s[72:75], s79 offen offset:3072 lds
s_add_u32 s76, s76, 262144
s_add_u32 s79, s79, 262144
v_mfma_f32_16x16x32_bf16 v[128:131], a[176:179], a[116:119], v[128:131]
v_mfma_f32_16x16x32_bf16 v[160:163], a[176:179], a[120:123], v[160:163]
ds_read_b64_tr_b16 a[172:173], v245 offset:40960
v_mfma_f32_16x16x32_bf16 v[164:167], a[180:183], a[120:123], v[164:167]
ds_read_b64_tr_b16 a[174:175], v245 offset:45056
v_mfma_f32_16x16x32_bf16 v[196:199], a[180:183], a[124:127], v[196:199]
buffer_load_dwordx4 a[48:51], v2, s[12:15], s36 offen offset:3072 sc1
v_mfma_f32_16x16x32_bf16 v[192:195], a[176:179], a[124:127], v[192:195]
s_waitcnt lgkmcnt(4)
v_mfma_f32_16x16x32_bf16 v[200:203], a[160:163], a[124:127], v[200:203]
ds_read_b64_tr_b16 a[176:177], v246 offset:40960
v_mfma_f32_16x16x32_bf16 v[204:207], a[164:167], a[124:127], v[204:207]
ds_read_b64_tr_b16 a[178:179], v246 offset:45056
v_mfma_f32_16x16x32_bf16 v[172:175], a[164:167], a[120:123], v[172:175]
buffer_load_dwordx4 a[52:55], v2, s[12:15], s37 offen offset:3072 sc1
v_mfma_f32_16x16x32_bf16 v[168:171], a[160:163], a[120:123], v[168:171]
v_mfma_f32_16x16x32_bf16 v[136:139], a[160:163], a[116:119], v[136:139]
ds_read_b64_tr_b16 a[180:181], v247 offset:40960
v_mfma_f32_16x16x32_bf16 v[140:143], a[164:167], a[116:119], v[140:143]
ds_read_b64_tr_b16 a[182:183], v247 offset:45056
v_mfma_f32_16x16x32_bf16 v[108:111], a[164:167], a[112:115], v[108:111]
v_mfma_f32_16x16x32_bf16 v[104:107], a[160:163], a[112:115], v[104:107]
s_waitcnt lgkmcnt(4)
v_mfma_f32_16x16x32_bf16 v[112:115], a[168:171], a[112:115], v[112:115]
ds_read_b64_tr_b16 a[160:161], v240 offset:49152
v_mfma_f32_16x16x32_bf16 v[116:119], a[172:175], a[112:115], v[116:119]
ds_read_b64_tr_b16 a[162:163], v240 offset:53248
v_mfma_f32_16x16x32_bf16 v[148:151], a[172:175], a[116:119], v[148:151]
buffer_load_dwordx4 a[56:59], v2, s[12:15], s38 offen offset:3072 sc1
v_mfma_f32_16x16x32_bf16 v[144:147], a[168:171], a[116:119], v[144:147]
v_mfma_f32_16x16x32_bf16 v[176:179], a[168:171], a[120:123], v[176:179]
ds_read_b64_tr_b16 a[164:165], v241 offset:49152
v_mfma_f32_16x16x32_bf16 v[180:183], a[172:175], a[120:123], v[180:183]
ds_read_b64_tr_b16 a[166:167], v241 offset:53248
v_mfma_f32_16x16x32_bf16 v[212:215], a[172:175], a[124:127], v[212:215]
buffer_load_dwordx4 a[60:63], v2, s[12:15], s39 offen offset:3072 sc1
v_mfma_f32_16x16x32_bf16 v[208:211], a[168:171], a[124:127], v[208:211]
s_waitcnt lgkmcnt(4)
v_mfma_f32_16x16x32_bf16 v[216:219], a[176:179], a[124:127], v[216:219]
ds_read_b64_tr_b16 a[168:169], v242 offset:49152
v_mfma_f32_16x16x32_bf16 v[220:223], a[180:183], a[124:127], v[220:223]
ds_read_b64_tr_b16 a[170:171], v242 offset:53248
v_mfma_f32_16x16x32_bf16 v[188:191], a[180:183], a[120:123], v[188:191]
s_add_u32 s36, s36, 4096
s_add_u32 s37, s37, 4096
s_add_u32 s38, s38, 4096
s_add_u32 s39, s39, 4096
buffer_load_dwordx2 a[64:65], v9, s[12:15], s36 offen offset:0 sc1
buffer_load_dwordx2 a[66:67], v9, s[12:15], s36 offen offset:512 sc1
v_mfma_f32_16x16x32_bf16 v[184:187], a[176:179], a[120:123], v[184:187]
v_mfma_f32_16x16x32_bf16 v[152:155], a[176:179], a[116:119], v[152:155]
ds_read_b64_tr_b16 a[172:173], v243 offset:49152
v_mfma_f32_16x16x32_bf16 v[156:159], a[180:183], a[116:119], v[156:159]
ds_read_b64_tr_b16 a[174:175], v243 offset:53248
v_mfma_f32_16x16x32_bf16 v[124:127], a[180:183], a[112:115], v[124:127]
buffer_load_dwordx2 a[68:69], v9, s[12:15], s37 offen offset:0 sc1
buffer_load_dwordx2 a[70:71], v9, s[12:15], s37 offen offset:512 sc1
v_mfma_f32_16x16x32_bf16 v[120:123], a[176:179], a[112:115], v[120:123]
s_waitcnt vmcnt(34) lgkmcnt(4)
v_mfma_f32_16x16x32_bf16 v[96:99], a[160:163], a[128:131], v[96:99]
ds_read_b64_tr_b16 a[176:177], v244 offset:49152
v_mfma_f32_16x16x32_bf16 v[100:103], a[164:167], a[128:131], v[100:103]
ds_read_b64_tr_b16 a[178:179], v244 offset:53248
v_mfma_f32_16x16x32_bf16 v[132:135], a[164:167], a[132:135], v[132:135]
v_mfma_f32_16x16x32_bf16 v[128:131], a[160:163], a[132:135], v[128:131]
v_mfma_f32_16x16x32_bf16 v[160:163], a[160:163], a[136:139], v[160:163]
ds_read_b64_tr_b16 a[180:181], v245 offset:49152
v_mfma_f32_16x16x32_bf16 v[164:167], a[164:167], a[136:139], v[164:167]
ds_read_b64_tr_b16 a[182:183], v245 offset:53248
v_mfma_f32_16x16x32_bf16 v[196:199], a[164:167], a[140:143], v[196:199]
buffer_load_dwordx2 a[72:73], v9, s[12:15], s38 offen offset:0 sc1
buffer_load_dwordx2 a[74:75], v9, s[12:15], s38 offen offset:512 sc1
v_mfma_f32_16x16x32_bf16 v[192:195], a[160:163], a[140:143], v[192:195]
s_waitcnt lgkmcnt(4)
v_mfma_f32_16x16x32_bf16 v[200:203], a[168:171], a[140:143], v[200:203]
ds_read_b64_tr_b16 a[160:161], v246 offset:49152
v_mfma_f32_16x16x32_bf16 v[204:207], a[172:175], a[140:143], v[204:207]
ds_read_b64_tr_b16 a[162:163], v246 offset:53248
v_mfma_f32_16x16x32_bf16 v[172:175], a[172:175], a[136:139], v[172:175]
buffer_load_dwordx2 a[76:77], v9, s[12:15], s39 offen offset:0 sc1
buffer_load_dwordx2 a[78:79], v9, s[12:15], s39 offen offset:512 sc1
v_mfma_f32_16x16x32_bf16 v[168:171], a[168:171], a[136:139], v[168:171]
s_add_u32 s72, s52, s5
s_addc_u32 s73, s53, 0
s_and_b32 s73, s73, 0xffff
s_sub_u32 s74, 2097152, s5
s_lshl_b32 s76, s78, 19
s_add_u32 s76, s76, s77
s_add_u32 s79, s76, 0x8000
s_add_u32 m0, s44, 65792
v_mfma_f32_16x16x32_bf16 v[136:139], a[168:171], a[132:135], v[136:139]
ds_read_b64_tr_b16 a[164:165], v247 offset:49152
v_mfma_f32_16x16x32_bf16 v[140:143], a[172:175], a[132:135], v[140:143]
ds_read_b64_tr_b16 a[166:167], v247 offset:53248
v_mfma_f32_16x16x32_bf16 v[108:111], a[172:175], a[128:131], v[108:111]
buffer_load_dwordx4 v84, s[72:75], s76 offen offset:0 lds
v_mfma_f32_16x16x32_bf16 v[104:107], a[168:171], a[128:131], v[104:107]
s_waitcnt lgkmcnt(4)
v_mfma_f32_16x16x32_bf16 v[112:115], a[176:179], a[128:131], v[112:115]
ds_read_b64_tr_b16 a[168:169], v240 offset:57344
v_mfma_f32_16x16x32_bf16 v[116:119], a[180:183], a[128:131], v[116:119]
ds_read_b64_tr_b16 a[170:171], v240 offset:61440
v_mfma_f32_16x16x32_bf16 v[148:151], a[180:183], a[132:135], v[148:151]
buffer_load_dwordx4 v85, s[72:75], s76 offen offset:1024 lds
v_mfma_f32_16x16x32_bf16 v[144:147], a[176:179], a[132:135], v[144:147]
v_mfma_f32_16x16x32_bf16 v[176:179], a[176:179], a[136:139], v[176:179]
ds_read_b64_tr_b16 a[172:173], v241 offset:57344
v_mfma_f32_16x16x32_bf16 v[180:183], a[180:183], a[136:139], v[180:183]
ds_read_b64_tr_b16 a[174:175], v241 offset:61440
v_mfma_f32_16x16x32_bf16 v[212:215], a[180:183], a[140:143], v[212:215]
v_mfma_f32_16x16x32_bf16 v[208:211], a[176:179], a[140:143], v[208:211]
s_waitcnt lgkmcnt(4)
v_mfma_f32_16x16x32_bf16 v[216:219], a[160:163], a[140:143], v[216:219]
ds_read_b64_tr_b16 a[176:177], v242 offset:57344
v_mfma_f32_16x16x32_bf16 v[220:223], a[164:167], a[140:143], v[220:223]
ds_read_b64_tr_b16 a[178:179], v242 offset:61440
v_mfma_f32_16x16x32_bf16 v[188:191], a[164:167], a[136:139], v[188:191]
buffer_load_dwordx4 v86, s[72:75], s76 offen offset:2048 lds
v_mfma_f32_16x16x32_bf16 v[184:187], a[160:163], a[136:139], v[184:187]
v_mfma_f32_16x16x32_bf16 v[152:155], a[160:163], a[132:135], v[152:155]
ds_read_b64_tr_b16 a[180:181], v243 offset:57344
v_mfma_f32_16x16x32_bf16 v[156:159], a[164:167], a[132:135], v[156:159]
ds_read_b64_tr_b16 a[182:183], v243 offset:61440
v_mfma_f32_16x16x32_bf16 v[124:127], a[164:167], a[128:131], v[124:127]
buffer_load_dwordx4 a[80:83], v2, s[12:15], s36 offen offset:1024 sc1
v_mfma_f32_16x16x32_bf16 v[120:123], a[160:163], a[128:131], v[120:123]
s_waitcnt vmcnt(37) lgkmcnt(4)
v_mfma_f32_16x16x32_bf16 v[96:99], a[168:171], a[144:147], v[96:99]
ds_read_b64_tr_b16 a[160:161], v244 offset:57344
v_mfma_f32_16x16x32_bf16 v[100:103], a[172:175], a[144:147], v[100:103]
ds_read_b64_tr_b16 a[162:163], v244 offset:61440
v_mfma_f32_16x16x32_bf16 v[132:135], a[172:175], a[148:151], v[132:135]
buffer_load_dwordx4 a[84:87], v2, s[12:15], s37 offen offset:1024 sc1
v_mfma_f32_16x16x32_bf16 v[128:131], a[168:171], a[148:151], v[128:131]
v_mfma_f32_16x16x32_bf16 v[160:163], a[168:171], a[152:155], v[160:163]
ds_read_b64_tr_b16 a[164:165], v245 offset:57344
v_mfma_f32_16x16x32_bf16 v[164:167], a[172:175], a[152:155], v[164:167]
ds_read_b64_tr_b16 a[166:167], v245 offset:61440
v_mfma_f32_16x16x32_bf16 v[196:199], a[172:175], a[156:159], v[196:199]
buffer_load_dwordx4 a[88:91], v2, s[12:15], s38 offen offset:1024 sc1
v_mfma_f32_16x16x32_bf16 v[192:195], a[168:171], a[156:159], v[192:195]
s_waitcnt lgkmcnt(4)
v_mfma_f32_16x16x32_bf16 v[200:203], a[176:179], a[156:159], v[200:203]
ds_read_b64_tr_b16 a[168:169], v246 offset:57344
v_mfma_f32_16x16x32_bf16 v[204:207], a[180:183], a[156:159], v[204:207]
ds_read_b64_tr_b16 a[170:171], v246 offset:61440
v_mfma_f32_16x16x32_bf16 v[172:175], a[180:183], a[152:155], v[172:175]
v_mfma_f32_16x16x32_bf16 v[168:171], a[176:179], a[152:155], v[168:171]
v_mfma_f32_16x16x32_bf16 v[136:139], a[176:179], a[148:151], v[136:139]
ds_read_b64_tr_b16 a[172:173], v247 offset:57344
v_mfma_f32_16x16x32_bf16 v[140:143], a[180:183], a[148:151], v[140:143]
ds_read_b64_tr_b16 a[174:175], v247 offset:61440
v_mfma_f32_16x16x32_bf16 v[108:111], a[180:183], a[144:147], v[108:111]
buffer_load_dwordx4 a[92:95], v2, s[12:15], s39 offen offset:1024 sc1
v_mfma_f32_16x16x32_bf16 v[104:107], a[176:179], a[144:147], v[104:107]
s_waitcnt lgkmcnt(4)
v_mfma_f32_16x16x32_bf16 v[112:115], a[160:163], a[144:147], v[112:115]
s_waitcnt vmcnt(44)
s_barrier
v_xor_b32 v240, 0x10000, v240
ds_read_b64_tr_b16 a[176:177], v240 offset:0
v_mfma_f32_16x16x32_bf16 v[116:119], a[164:167], a[144:147], v[116:119]
ds_read_b64_tr_b16 a[178:179], v240 offset:4096
v_mfma_f32_16x16x32_bf16 v[148:151], a[164:167], a[148:151], v[148:151]
buffer_load_dwordx4 v87, s[72:75], s76 offen offset:3072 lds
v_mfma_f32_16x16x32_bf16 v[144:147], a[160:163], a[148:151], v[144:147]
s_add_u32 m0, s44, 69888
v_mfma_f32_16x16x32_bf16 v[176:179], a[160:163], a[152:155], v[176:179]
v_xor_b32 v241, 0x10000, v241
ds_read_b64_tr_b16 a[180:181], v241 offset:0
v_mfma_f32_16x16x32_bf16 v[180:183], a[164:167], a[152:155], v[180:183]
ds_read_b64_tr_b16 a[182:183], v241 offset:4096
v_mfma_f32_16x16x32_bf16 v[212:215], a[164:167], a[156:159], v[212:215]
buffer_load_dwordx4 v84, s[72:75], s79 offen offset:0 lds
v_mfma_f32_16x16x32_bf16 v[208:211], a[160:163], a[156:159], v[208:211]
s_waitcnt lgkmcnt(4)
v_mfma_f32_16x16x32_bf16 v[216:219], a[168:171], a[156:159], v[216:219]
v_xor_b32 v242, 0x10000, v242
ds_read_b64_tr_b16 a[160:161], v242 offset:0
v_mfma_f32_16x16x32_bf16 v[220:223], a[172:175], a[156:159], v[220:223]
ds_read_b64_tr_b16 a[162:163], v242 offset:4096
v_mfma_f32_16x16x32_bf16 v[188:191], a[172:175], a[152:155], v[188:191]
v_mfma_f32_16x16x32_bf16 v[184:187], a[168:171], a[152:155], v[184:187]
v_mfma_f32_16x16x32_bf16 v[152:155], a[168:171], a[148:151], v[152:155]
v_xor_b32 v243, 0x10000, v243
ds_read_b64_tr_b16 a[164:165], v243 offset:0
v_mfma_f32_16x16x32_bf16 v[156:159], a[172:175], a[148:151], v[156:159]
ds_read_b64_tr_b16 a[166:167], v243 offset:4096
v_mfma_f32_16x16x32_bf16 v[124:127], a[172:175], a[144:147], v[124:127]
v_mfma_f32_16x16x32_bf16 v[120:123], a[168:171], a[144:147], v[120:123]
s_waitcnt vmcnt(37) lgkmcnt(4)
v_mfma_f32_16x16x32_bf16 v[96:99], a[176:179], a[0:3], v[96:99]
v_xor_b32 v244, 0x10000, v244
ds_read_b64_tr_b16 a[168:169], v244 offset:0
v_mfma_f32_16x16x32_bf16 v[100:103], a[180:183], a[0:3], v[100:103]
ds_read_b64_tr_b16 a[170:171], v244 offset:4096
v_mfma_f32_16x16x32_bf16 v[132:135], a[180:183], a[4:7], v[132:135]
buffer_load_dwordx4 v85, s[72:75], s79 offen offset:1024 lds
v_mfma_f32_16x16x32_bf16 v[128:131], a[176:179], a[4:7], v[128:131]
v_mfma_f32_16x16x32_bf16 v[160:163], a[176:179], a[8:11], v[160:163]
v_xor_b32 v245, 0x10000, v245
ds_read_b64_tr_b16 a[172:173], v245 offset:0
v_mfma_f32_16x16x32_bf16 v[164:167], a[180:183], a[8:11], v[164:167]
ds_read_b64_tr_b16 a[174:175], v245 offset:4096
v_mfma_f32_16x16x32_bf16 v[196:199], a[180:183], a[12:15], v[196:199]
v_mfma_f32_16x16x32_bf16 v[192:195], a[176:179], a[12:15], v[192:195]
s_waitcnt lgkmcnt(4)
v_mfma_f32_16x16x32_bf16 v[200:203], a[160:163], a[12:15], v[200:203]
v_xor_b32 v246, 0x10000, v246
ds_read_b64_tr_b16 a[176:177], v246 offset:0
v_mfma_f32_16x16x32_bf16 v[204:207], a[164:167], a[12:15], v[204:207]
ds_read_b64_tr_b16 a[178:179], v246 offset:4096
v_mfma_f32_16x16x32_bf16 v[172:175], a[164:167], a[8:11], v[172:175]
buffer_load_dwordx4 v86, s[72:75], s79 offen offset:2048 lds
v_mfma_f32_16x16x32_bf16 v[168:171], a[160:163], a[8:11], v[168:171]
v_mfma_f32_16x16x32_bf16 v[136:139], a[160:163], a[4:7], v[136:139]
v_xor_b32 v247, 0x10000, v247
ds_read_b64_tr_b16 a[180:181], v247 offset:0
v_mfma_f32_16x16x32_bf16 v[140:143], a[164:167], a[4:7], v[140:143]
ds_read_b64_tr_b16 a[182:183], v247 offset:4096
v_mfma_f32_16x16x32_bf16 v[108:111], a[164:167], a[0:3], v[108:111]
v_mfma_f32_16x16x32_bf16 v[104:107], a[160:163], a[0:3], v[104:107]
s_waitcnt lgkmcnt(4)
v_mfma_f32_16x16x32_bf16 v[112:115], a[168:171], a[0:3], v[112:115]
ds_read_b64_tr_b16 a[160:161], v240 offset:8192
v_mfma_f32_16x16x32_bf16 v[116:119], a[172:175], a[0:3], v[116:119]
ds_read_b64_tr_b16 a[162:163], v240 offset:12288
v_mfma_f32_16x16x32_bf16 v[148:151], a[172:175], a[4:7], v[148:151]
v_mfma_f32_16x16x32_bf16 v[144:147], a[168:171], a[4:7], v[144:147]
v_mfma_f32_16x16x32_bf16 v[176:179], a[168:171], a[8:11], v[176:179]
ds_read_b64_tr_b16 a[164:165], v241 offset:8192
v_mfma_f32_16x16x32_bf16 v[180:183], a[172:175], a[8:11], v[180:183]
ds_read_b64_tr_b16 a[166:167], v241 offset:12288
v_mfma_f32_16x16x32_bf16 v[212:215], a[172:175], a[12:15], v[212:215]
buffer_load_dwordx4 a[96:99], v2, s[12:15], s36 offen offset:2048 sc1
v_mfma_f32_16x16x32_bf16 v[208:211], a[168:171], a[12:15], v[208:211]
s_waitcnt lgkmcnt(4)
v_mfma_f32_16x16x32_bf16 v[216:219], a[176:179], a[12:15], v[216:219]
ds_read_b64_tr_b16 a[168:169], v242 offset:8192
v_mfma_f32_16x16x32_bf16 v[220:223], a[180:183], a[12:15], v[220:223]
ds_read_b64_tr_b16 a[170:171], v242 offset:12288
v_mfma_f32_16x16x32_bf16 v[188:191], a[180:183], a[8:11], v[188:191]
buffer_load_dwordx4 a[100:103], v2, s[12:15], s37 offen offset:2048 sc1
v_mfma_f32_16x16x32_bf16 v[184:187], a[176:179], a[8:11], v[184:187]
v_mfma_f32_16x16x32_bf16 v[152:155], a[176:179], a[4:7], v[152:155]
ds_read_b64_tr_b16 a[172:173], v243 offset:8192
v_mfma_f32_16x16x32_bf16 v[156:159], a[180:183], a[4:7], v[156:159]
ds_read_b64_tr_b16 a[174:175], v243 offset:12288
v_mfma_f32_16x16x32_bf16 v[124:127], a[180:183], a[0:3], v[124:127]
buffer_load_dwordx4 a[104:107], v2, s[12:15], s38 offen offset:2048 sc1
v_mfma_f32_16x16x32_bf16 v[120:123], a[176:179], a[0:3], v[120:123]
s_waitcnt vmcnt(35) lgkmcnt(4)
v_mfma_f32_16x16x32_bf16 v[96:99], a[160:163], a[16:19], v[96:99]
ds_read_b64_tr_b16 a[176:177], v244 offset:8192
v_mfma_f32_16x16x32_bf16 v[100:103], a[164:167], a[16:19], v[100:103]
ds_read_b64_tr_b16 a[178:179], v244 offset:12288
v_mfma_f32_16x16x32_bf16 v[132:135], a[164:167], a[20:23], v[132:135]
buffer_load_dwordx4 a[108:111], v2, s[12:15], s39 offen offset:2048 sc1
v_mfma_f32_16x16x32_bf16 v[128:131], a[160:163], a[20:23], v[128:131]
v_mfma_f32_16x16x32_bf16 v[160:163], a[160:163], a[24:27], v[160:163]
ds_read_b64_tr_b16 a[180:181], v245 offset:8192
v_mfma_f32_16x16x32_bf16 v[164:167], a[164:167], a[24:27], v[164:167]
ds_read_b64_tr_b16 a[182:183], v245 offset:12288
v_mfma_f32_16x16x32_bf16 v[196:199], a[164:167], a[28:31], v[196:199]
v_mfma_f32_16x16x32_bf16 v[192:195], a[160:163], a[28:31], v[192:195]
s_waitcnt lgkmcnt(4)
v_mfma_f32_16x16x32_bf16 v[200:203], a[168:171], a[28:31], v[200:203]
ds_read_b64_tr_b16 a[160:161], v246 offset:8192
v_mfma_f32_16x16x32_bf16 v[204:207], a[172:175], a[28:31], v[204:207]
ds_read_b64_tr_b16 a[162:163], v246 offset:12288
v_mfma_f32_16x16x32_bf16 v[172:175], a[172:175], a[24:27], v[172:175]
buffer_load_dwordx4 v87, s[72:75], s79 offen offset:3072 lds
s_add_u32 s76, s76, 262144
s_add_u32 s79, s79, 262144
v_mfma_f32_16x16x32_bf16 v[168:171], a[168:171], a[24:27], v[168:171]
s_add_u32 m0, s44, 98560
v_mfma_f32_16x16x32_bf16 v[136:139], a[168:171], a[20:23], v[136:139]
ds_read_b64_tr_b16 a[164:165], v247 offset:8192
v_mfma_f32_16x16x32_bf16 v[140:143], a[172:175], a[20:23], v[140:143]
ds_read_b64_tr_b16 a[166:167], v247 offset:12288
v_mfma_f32_16x16x32_bf16 v[108:111], a[172:175], a[16:19], v[108:111]
buffer_load_dwordx4 v84, s[72:75], s76 offen offset:0 lds
v_mfma_f32_16x16x32_bf16 v[104:107], a[168:171], a[16:19], v[104:107]
s_waitcnt lgkmcnt(4)
v_mfma_f32_16x16x32_bf16 v[112:115], a[176:179], a[16:19], v[112:115]
ds_read_b64_tr_b16 a[168:169], v240 offset:16384
v_mfma_f32_16x16x32_bf16 v[116:119], a[180:183], a[16:19], v[116:119]
ds_read_b64_tr_b16 a[170:171], v240 offset:20480
v_mfma_f32_16x16x32_bf16 v[148:151], a[180:183], a[20:23], v[148:151]
buffer_load_dwordx4 v85, s[72:75], s76 offen offset:1024 lds
v_mfma_f32_16x16x32_bf16 v[144:147], a[176:179], a[20:23], v[144:147]
v_mfma_f32_16x16x32_bf16 v[176:179], a[176:179], a[24:27], v[176:179]
ds_read_b64_tr_b16 a[172:173], v241 offset:16384
v_mfma_f32_16x16x32_bf16 v[180:183], a[180:183], a[24:27], v[180:183]
ds_read_b64_tr_b16 a[174:175], v241 offset:20480
v_mfma_f32_16x16x32_bf16 v[212:215], a[180:183], a[28:31], v[212:215]
buffer_load_dwordx4 v86, s[72:75], s76 offen offset:2048 lds
v_mfma_f32_16x16x32_bf16 v[208:211], a[176:179], a[28:31], v[208:211]
s_waitcnt lgkmcnt(4)
v_mfma_f32_16x16x32_bf16 v[216:219], a[160:163], a[28:31], v[216:219]
ds_read_b64_tr_b16 a[176:177], v242 offset:16384
v_mfma_f32_16x16x32_bf16 v[220:223], a[164:167], a[28:31], v[220:223]
ds_read_b64_tr_b16 a[178:179], v242 offset:20480
v_mfma_f32_16x16x32_bf16 v[188:191], a[164:167], a[24:27], v[188:191]
buffer_load_dwordx4 v87, s[72:75], s76 offen offset:3072 lds
v_mfma_f32_16x16x32_bf16 v[184:187], a[160:163], a[24:27], v[184:187]
s_add_u32 m0, s44, 102656
v_mfma_f32_16x16x32_bf16 v[152:155], a[160:163], a[20:23], v[152:155]
ds_read_b64_tr_b16 a[180:181], v243 offset:16384
v_mfma_f32_16x16x32_bf16 v[156:159], a[164:167], a[20:23], v[156:159]
ds_read_b64_tr_b16 a[182:183], v243 offset:20480
v_mfma_f32_16x16x32_bf16 v[124:127], a[164:167], a[16:19], v[124:127]
buffer_load_dwordx4 v84, s[72:75], s79 offen offset:0 lds
v_mfma_f32_16x16x32_bf16 v[120:123], a[160:163], a[16:19], v[120:123]
s_waitcnt vmcnt(34) lgkmcnt(4)
v_mfma_f32_16x16x32_bf16 v[96:99], a[168:171], a[32:35], v[96:99]
ds_read_b64_tr_b16 a[160:161], v244 offset:16384
v_mfma_f32_16x16x32_bf16 v[100:103], a[172:175], a[32:35], v[100:103]
ds_read_b64_tr_b16 a[162:163], v244 offset:20480
v_mfma_f32_16x16x32_bf16 v[132:135], a[172:175], a[36:39], v[132:135]
buffer_load_dwordx4 v85, s[72:75], s79 offen offset:1024 lds
v_mfma_f32_16x16x32_bf16 v[128:131], a[168:171], a[36:39], v[128:131]
v_mfma_f32_16x16x32_bf16 v[160:163], a[168:171], a[40:43], v[160:163]
ds_read_b64_tr_b16 a[164:165], v245 offset:16384
v_mfma_f32_16x16x32_bf16 v[164:167], a[172:175], a[40:43], v[164:167]
ds_read_b64_tr_b16 a[166:167], v245 offset:20480
v_mfma_f32_16x16x32_bf16 v[196:199], a[172:175], a[44:47], v[196:199]
buffer_load_dwordx4 v86, s[72:75], s79 offen offset:2048 lds
v_mfma_f32_16x16x32_bf16 v[192:195], a[168:171], a[44:47], v[192:195]
s_waitcnt lgkmcnt(4)
v_mfma_f32_16x16x32_bf16 v[200:203], a[176:179], a[44:47], v[200:203]
ds_read_b64_tr_b16 a[168:169], v246 offset:16384
v_mfma_f32_16x16x32_bf16 v[204:207], a[180:183], a[44:47], v[204:207]
ds_read_b64_tr_b16 a[170:171], v246 offset:20480
v_mfma_f32_16x16x32_bf16 v[172:175], a[180:183], a[40:43], v[172:175]
buffer_load_dwordx4 a[112:115], v2, s[12:15], s36 offen offset:3072 sc1
v_mfma_f32_16x16x32_bf16 v[168:171], a[176:179], a[40:43], v[168:171]
v_mfma_f32_16x16x32_bf16 v[136:139], a[176:179], a[36:39], v[136:139]
ds_read_b64_tr_b16 a[172:173], v247 offset:16384
v_mfma_f32_16x16x32_bf16 v[140:143], a[180:183], a[36:39], v[140:143]
ds_read_b64_tr_b16 a[174:175], v247 offset:20480
v_mfma_f32_16x16x32_bf16 v[108:111], a[180:183], a[32:35], v[108:111]
buffer_load_dwordx4 a[116:119], v2, s[12:15], s37 offen offset:3072 sc1
v_mfma_f32_16x16x32_bf16 v[104:107], a[176:179], a[32:35], v[104:107]
s_waitcnt lgkmcnt(4)
v_mfma_f32_16x16x32_bf16 v[112:115], a[160:163], a[32:35], v[112:115]
ds_read_b64_tr_b16 a[176:177], v240 offset:24576
v_mfma_f32_16x16x32_bf16 v[116:119], a[164:167], a[32:35], v[116:119]
ds_read_b64_tr_b16 a[178:179], v240 offset:28672
v_mfma_f32_16x16x32_bf16 v[148:151], a[164:167], a[36:39], v[148:151]
buffer_load_dwordx4 a[120:123], v2, s[12:15], s38 offen offset:3072 sc1
v_mfma_f32_16x16x32_bf16 v[144:147], a[160:163], a[36:39], v[144:147]
v_mfma_f32_16x16x32_bf16 v[176:179], a[160:163], a[40:43], v[176:179]
ds_read_b64_tr_b16 a[180:181], v241 offset:24576
v_mfma_f32_16x16x32_bf16 v[180:183], a[164:167], a[40:43], v[180:183]
ds_read_b64_tr_b16 a[182:183], v241 offset:28672
v_mfma_f32_16x16x32_bf16 v[212:215], a[164:167], a[44:47], v[212:215]
buffer_load_dwordx4 a[124:127], v2, s[12:15], s39 offen offset:3072 sc1
v_mfma_f32_16x16x32_bf16 v[208:211], a[160:163], a[44:47], v[208:211]
s_waitcnt lgkmcnt(4)
v_mfma_f32_16x16x32_bf16 v[216:219], a[168:171], a[44:47], v[216:219]
ds_read_b64_tr_b16 a[160:161], v242 offset:24576
v_mfma_f32_16x16x32_bf16 v[220:223], a[172:175], a[44:47], v[220:223]
ds_read_b64_tr_b16 a[162:163], v242 offset:28672
v_mfma_f32_16x16x32_bf16 v[188:191], a[172:175], a[40:43], v[188:191]
buffer_load_dwordx4 v87, s[72:75], s79 offen offset:3072 lds
s_add_u32 s76, s76, 262144
s_add_u32 s79, s79, 262144
v_mfma_f32_16x16x32_bf16 v[184:187], a[168:171], a[40:43], v[184:187]
v_mfma_f32_16x16x32_bf16 v[152:155], a[168:171], a[36:39], v[152:155]
ds_read_b64_tr_b16 a[164:165], v243 offset:24576
v_mfma_f32_16x16x32_bf16 v[156:159], a[172:175], a[36:39], v[156:159]
ds_read_b64_tr_b16 a[166:167], v243 offset:28672
v_mfma_f32_16x16x32_bf16 v[124:127], a[172:175], a[32:35], v[124:127]
s_add_u32 s36, s36, 4096
s_add_u32 s37, s37, 4096
s_add_u32 s38, s38, 4096
s_add_u32 s39, s39, 4096
buffer_load_dwordx4 a[128:131], v2, s[12:15], s36 offen offset:0 sc1
v_mfma_f32_16x16x32_bf16 v[120:123], a[168:171], a[32:35], v[120:123]
s_waitcnt vmcnt(37) lgkmcnt(4)
v_mfma_f32_16x16x32_bf16 v[96:99], a[176:179], a[48:51], v[96:99]
ds_read_b64_tr_b16 a[168:169], v244 offset:24576
v_mfma_f32_16x16x32_bf16 v[100:103], a[180:183], a[48:51], v[100:103]
ds_read_b64_tr_b16 a[170:171], v244 offset:28672
v_mfma_f32_16x16x32_bf16 v[132:135], a[180:183], a[52:55], v[132:135]
buffer_load_dwordx4 a[132:135], v2, s[12:15], s37 offen offset:0 sc1
v_mfma_f32_16x16x32_bf16 v[128:131], a[176:179], a[52:55], v[128:131]
v_mfma_f32_16x16x32_bf16 v[160:163], a[176:179], a[56:59], v[160:163]
ds_read_b64_tr_b16 a[172:173], v245 offset:24576
v_mfma_f32_16x16x32_bf16 v[164:167], a[180:183], a[56:59], v[164:167]
ds_read_b64_tr_b16 a[174:175], v245 offset:28672
v_mfma_f32_16x16x32_bf16 v[196:199], a[180:183], a[60:63], v[196:199]
buffer_load_dwordx4 a[136:139], v2, s[12:15], s38 offen offset:0 sc1
v_mfma_f32_16x16x32_bf16 v[192:195], a[176:179], a[60:63], v[192:195]
s_waitcnt lgkmcnt(4)
v_mfma_f32_16x16x32_bf16 v[200:203], a[160:163], a[60:63], v[200:203]
ds_read_b64_tr_b16 a[176:177], v246 offset:24576
v_mfma_f32_16x16x32_bf16 v[204:207], a[164:167], a[60:63], v[204:207]
ds_read_b64_tr_b16 a[178:179], v246 offset:28672
v_mfma_f32_16x16x32_bf16 v[172:175], a[164:167], a[56:59], v[172:175]
buffer_load_dwordx4 a[140:143], v2, s[12:15], s39 offen offset:0 sc1
v_mfma_f32_16x16x32_bf16 v[168:171], a[160:163], a[56:59], v[168:171]
v_mfma_f32_16x16x32_bf16 v[136:139], a[160:163], a[52:55], v[136:139]
ds_read_b64_tr_b16 a[180:181], v247 offset:24576
v_mfma_f32_16x16x32_bf16 v[140:143], a[164:167], a[52:55], v[140:143]
ds_read_b64_tr_b16 a[182:183], v247 offset:28672
v_mfma_f32_16x16x32_bf16 v[108:111], a[164:167], a[48:51], v[108:111]
buffer_load_dwordx4 a[144:147], v2, s[12:15], s36 offen offset:1024 sc1
v_mfma_f32_16x16x32_bf16 v[104:107], a[160:163], a[48:51], v[104:107]
s_waitcnt lgkmcnt(4)
v_mfma_f32_16x16x32_bf16 v[112:115], a[168:171], a[48:51], v[112:115]
s_waitcnt vmcnt(45)
s_barrier
ds_read_b64_tr_b16 a[160:161], v240 offset:32768
v_mfma_f32_16x16x32_bf16 v[116:119], a[172:175], a[48:51], v[116:119]
ds_read_b64_tr_b16 a[162:163], v240 offset:36864
v_mfma_f32_16x16x32_bf16 v[148:151], a[172:175], a[52:55], v[148:151]
buffer_load_dwordx4 a[148:151], v2, s[12:15], s37 offen offset:1024 sc1
v_mfma_f32_16x16x32_bf16 v[144:147], a[168:171], a[52:55], v[144:147]
v_mfma_f32_16x16x32_bf16 v[176:179], a[168:171], a[56:59], v[176:179]
ds_read_b64_tr_b16 a[164:165], v241 offset:32768
v_mfma_f32_16x16x32_bf16 v[180:183], a[172:175], a[56:59], v[180:183]
ds_read_b64_tr_b16 a[166:167], v241 offset:36864
v_mfma_f32_16x16x32_bf16 v[212:215], a[172:175], a[60:63], v[212:215]
v_mfma_f32_16x16x32_bf16 v[208:211], a[168:171], a[60:63], v[208:211]
s_waitcnt lgkmcnt(4)
v_mfma_f32_16x16x32_bf16 v[216:219], a[176:179], a[60:63], v[216:219]
ds_read_b64_tr_b16 a[168:169], v242 offset:32768
v_mfma_f32_16x16x32_bf16 v[220:223], a[180:183], a[60:63], v[220:223]
ds_read_b64_tr_b16 a[170:171], v242 offset:36864
v_mfma_f32_16x16x32_bf16 v[188:191], a[180:183], a[56:59], v[188:191]
buffer_load_dwordx4 a[152:155], v2, s[12:15], s38 offen offset:1024 sc1
v_mfma_f32_16x16x32_bf16 v[184:187], a[176:179], a[56:59], v[184:187]
v_mfma_f32_16x16x32_bf16 v[152:155], a[176:179], a[52:55], v[152:155]
ds_read_b64_tr_b16 a[172:173], v243 offset:32768
v_mfma_f32_16x16x32_bf16 v[156:159], a[180:183], a[52:55], v[156:159]
ds_read_b64_tr_b16 a[174:175], v243 offset:36864
v_mfma_f32_16x16x32_bf16 v[124:127], a[180:183], a[48:51], v[124:127]
buffer_load_dwordx4 a[156:159], v2, s[12:15], s39 offen offset:1024 sc1
v_mfma_f32_16x16x32_bf16 v[120:123], a[176:179], a[48:51], v[120:123]
s_waitcnt vmcnt(36) lgkmcnt(4)
v_mfma_f32_16x16x32_bf16 v[96:99], a[160:163], a[64:67], v[96:99]
ds_read_b64_tr_b16 a[176:177], v244 offset:32768
v_mfma_f32_16x16x32_bf16 v[100:103], a[164:167], a[64:67], v[100:103]
ds_read_b64_tr_b16 a[178:179], v244 offset:36864
v_mfma_f32_16x16x32_bf16 v[132:135], a[164:167], a[68:71], v[132:135]
buffer_load_dwordx4 a[0:3], v2, s[12:15], s36 offen offset:2048 sc1
v_mfma_f32_16x16x32_bf16 v[128:131], a[160:163], a[68:71], v[128:131]
v_mfma_f32_16x16x32_bf16 v[160:163], a[160:163], a[72:75], v[160:163]
ds_read_b64_tr_b16 a[180:181], v245 offset:32768
v_mfma_f32_16x16x32_bf16 v[164:167], a[164:167], a[72:75], v[164:167]
ds_read_b64_tr_b16 a[182:183], v245 offset:36864
v_mfma_f32_16x16x32_bf16 v[196:199], a[164:167], a[76:79], v[196:199]
buffer_load_dwordx4 a[4:7], v2, s[12:15], s37 offen offset:2048 sc1
v_mfma_f32_16x16x32_bf16 v[192:195], a[160:163], a[76:79], v[192:195]
s_waitcnt lgkmcnt(4)
v_mfma_f32_16x16x32_bf16 v[200:203], a[168:171], a[76:79], v[200:203]
ds_read_b64_tr_b16 a[160:161], v246 offset:32768
v_mfma_f32_16x16x32_bf16 v[204:207], a[172:175], a[76:79], v[204:207]
ds_read_b64_tr_b16 a[162:163], v246 offset:36864
v_mfma_f32_16x16x32_bf16 v[172:175], a[172:175], a[72:75], v[172:175]
v_mfma_f32_16x16x32_bf16 v[168:171], a[168:171], a[72:75], v[168:171]
v_mfma_f32_16x16x32_bf16 v[136:139], a[168:171], a[68:71], v[136:139]
ds_read_b64_tr_b16 a[164:165], v247 offset:32768
v_mfma_f32_16x16x32_bf16 v[140:143], a[172:175], a[68:71], v[140:143]
ds_read_b64_tr_b16 a[166:167], v247 offset:36864
v_mfma_f32_16x16x32_bf16 v[108:111], a[172:175], a[64:67], v[108:111]
buffer_load_dwordx4 a[8:11], v2, s[12:15], s38 offen offset:2048 sc1
v_mfma_f32_16x16x32_bf16 v[104:107], a[168:171], a[64:67], v[104:107]
s_waitcnt lgkmcnt(4)
v_mfma_f32_16x16x32_bf16 v[112:115], a[176:179], a[64:67], v[112:115]
ds_read_b64_tr_b16 a[168:169], v240 offset:40960
v_mfma_f32_16x16x32_bf16 v[116:119], a[180:183], a[64:67], v[116:119]
ds_read_b64_tr_b16 a[170:171], v240 offset:45056
v_mfma_f32_16x16x32_bf16 v[148:151], a[180:183], a[68:71], v[148:151]
buffer_load_dwordx4 a[12:15], v2, s[12:15], s39 offen offset:2048 sc1
v_mfma_f32_16x16x32_bf16 v[144:147], a[176:179], a[68:71], v[144:147]
v_mfma_f32_16x16x32_bf16 v[176:179], a[176:179], a[72:75], v[176:179]
ds_read_b64_tr_b16 a[172:173], v241 offset:40960
v_mfma_f32_16x16x32_bf16 v[180:183], a[180:183], a[72:75], v[180:183]
ds_read_b64_tr_b16 a[174:175], v241 offset:45056
v_mfma_f32_16x16x32_bf16 v[212:215], a[180:183], a[76:79], v[212:215]
buffer_load_dwordx4 a[16:19], v2, s[12:15], s36 offen offset:3072 sc1
v_mfma_f32_16x16x32_bf16 v[208:211], a[176:179], a[76:79], v[208:211]
s_waitcnt lgkmcnt(4)
v_mfma_f32_16x16x32_bf16 v[216:219], a[160:163], a[76:79], v[216:219]
ds_read_b64_tr_b16 a[176:177], v242 offset:40960
v_mfma_f32_16x16x32_bf16 v[220:223], a[164:167], a[76:79], v[220:223]
ds_read_b64_tr_b16 a[178:179], v242 offset:45056
v_mfma_f32_16x16x32_bf16 v[188:191], a[164:167], a[72:75], v[188:191]
buffer_load_dwordx4 a[20:23], v2, s[12:15], s37 offen offset:3072 sc1
v_mfma_f32_16x16x32_bf16 v[184:187], a[160:163], a[72:75], v[184:187]
v_mfma_f32_16x16x32_bf16 v[152:155], a[160:163], a[68:71], v[152:155]
ds_read_b64_tr_b16 a[180:181], v243 offset:40960
v_mfma_f32_16x16x32_bf16 v[156:159], a[164:167], a[68:71], v[156:159]
ds_read_b64_tr_b16 a[182:183], v243 offset:45056
v_mfma_f32_16x16x32_bf16 v[124:127], a[164:167], a[64:67], v[124:127]
v_mfma_f32_16x16x32_bf16 v[120:123], a[160:163], a[64:67], v[120:123]
s_waitcnt vmcnt(35) lgkmcnt(4)
v_mfma_f32_16x16x32_bf16 v[96:99], a[168:171], a[80:83], v[96:99]
ds_read_b64_tr_b16 a[160:161], v244 offset:40960
v_mfma_f32_16x16x32_bf16 v[100:103], a[172:175], a[80:83], v[100:103]
ds_read_b64_tr_b16 a[162:163], v244 offset:45056
v_mfma_f32_16x16x32_bf16 v[132:135], a[172:175], a[84:87], v[132:135]
buffer_load_dwordx4 a[24:27], v2, s[12:15], s38 offen offset:3072 sc1
v_mfma_f32_16x16x32_bf16 v[128:131], a[168:171], a[84:87], v[128:131]
v_mfma_f32_16x16x32_bf16 v[160:163], a[168:171], a[88:91], v[160:163]
ds_read_b64_tr_b16 a[164:165], v245 offset:40960
v_mfma_f32_16x16x32_bf16 v[164:167], a[172:175], a[88:91], v[164:167]
ds_read_b64_tr_b16 a[166:167], v245 offset:45056
v_mfma_f32_16x16x32_bf16 v[196:199], a[172:175], a[92:95], v[196:199]
buffer_load_dwordx4 a[28:31], v2, s[12:15], s39 offen offset:3072 sc1
v_mfma_f32_16x16x32_bf16 v[192:195], a[168:171], a[92:95], v[192:195]
s_waitcnt lgkmcnt(4)
v_mfma_f32_16x16x32_bf16 v[200:203], a[176:179], a[92:95], v[200:203]
ds_read_b64_tr_b16 a[168:169], v246 offset:40960
v_mfma_f32_16x16x32_bf16 v[204:207], a[180:183], a[92:95], v[204:207]
ds_read_b64_tr_b16 a[170:171], v246 offset:45056
v_mfma_f32_16x16x32_bf16 v[172:175], a[180:183], a[88:91], v[172:175]
s_add_u32 s36, s36, 4096
s_add_u32 s37, s37, 4096
s_add_u32 s38, s38, 4096
s_add_u32 s39, s39, 4096
buffer_load_dwordx4 a[32:35], v2, s[12:15], s36 offen offset:0 sc1
v_mfma_f32_16x16x32_bf16 v[168:171], a[176:179], a[88:91], v[168:171]
v_mfma_f32_16x16x32_bf16 v[136:139], a[176:179], a[84:87], v[136:139]
ds_read_b64_tr_b16 a[172:173], v247 offset:40960
v_mfma_f32_16x16x32_bf16 v[140:143], a[180:183], a[84:87], v[140:143]
ds_read_b64_tr_b16 a[174:175], v247 offset:45056
v_mfma_f32_16x16x32_bf16 v[108:111], a[180:183], a[80:83], v[108:111]
buffer_load_dwordx4 a[36:39], v2, s[12:15], s37 offen offset:0 sc1
v_mfma_f32_16x16x32_bf16 v[104:107], a[176:179], a[80:83], v[104:107]
s_waitcnt lgkmcnt(4)
v_mfma_f32_16x16x32_bf16 v[112:115], a[160:163], a[80:83], v[112:115]
ds_read_b64_tr_b16 a[176:177], v240 offset:49152
v_mfma_f32_16x16x32_bf16 v[116:119], a[164:167], a[80:83], v[116:119]
ds_read_b64_tr_b16 a[178:179], v240 offset:53248
v_mfma_f32_16x16x32_bf16 v[148:151], a[164:167], a[84:87], v[148:151]
v_mfma_f32_16x16x32_bf16 v[144:147], a[160:163], a[84:87], v[144:147]
v_mfma_f32_16x16x32_bf16 v[176:179], a[160:163], a[88:91], v[176:179]
ds_read_b64_tr_b16 a[180:181], v241 offset:49152
v_mfma_f32_16x16x32_bf16 v[180:183], a[164:167], a[88:91], v[180:183]
ds_read_b64_tr_b16 a[182:183], v241 offset:53248
v_mfma_f32_16x16x32_bf16 v[212:215], a[164:167], a[92:95], v[212:215]
buffer_load_dwordx4 a[40:43], v2, s[12:15], s38 offen offset:0 sc1
v_mfma_f32_16x16x32_bf16 v[208:211], a[160:163], a[92:95], v[208:211]
s_waitcnt lgkmcnt(4)
v_mfma_f32_16x16x32_bf16 v[216:219], a[168:171], a[92:95], v[216:219]
ds_read_b64_tr_b16 a[160:161], v242 offset:49152
v_mfma_f32_16x16x32_bf16 v[220:223], a[172:175], a[92:95], v[220:223]
ds_read_b64_tr_b16 a[162:163], v242 offset:53248
v_mfma_f32_16x16x32_bf16 v[188:191], a[172:175], a[88:91], v[188:191]
buffer_load_dwordx4 a[44:47], v2, s[12:15], s39 offen offset:0 sc1
v_mfma_f32_16x16x32_bf16 v[184:187], a[168:171], a[88:91], v[184:187]
v_mfma_f32_16x16x32_bf16 v[152:155], a[168:171], a[84:87], v[152:155]
ds_read_b64_tr_b16 a[164:165], v243 offset:49152
v_mfma_f32_16x16x32_bf16 v[156:159], a[172:175], a[84:87], v[156:159]
ds_read_b64_tr_b16 a[166:167], v243 offset:53248
v_mfma_f32_16x16x32_bf16 v[124:127], a[172:175], a[80:83], v[124:127]
buffer_load_dwordx4 a[48:51], v2, s[12:15], s36 offen offset:1024 sc1
v_mfma_f32_16x16x32_bf16 v[120:123], a[168:171], a[80:83], v[120:123]
s_waitcnt vmcnt(34) lgkmcnt(4)
v_mfma_f32_16x16x32_bf16 v[96:99], a[176:179], a[96:99], v[96:99]
ds_read_b64_tr_b16 a[168:169], v244 offset:49152
v_mfma_f32_16x16x32_bf16 v[100:103], a[180:183], a[96:99], v[100:103]
ds_read_b64_tr_b16 a[170:171], v244 offset:53248
v_mfma_f32_16x16x32_bf16 v[132:135], a[180:183], a[100:103], v[132:135]
buffer_load_dwordx4 a[52:55], v2, s[12:15], s37 offen offset:1024 sc1
v_mfma_f32_16x16x32_bf16 v[128:131], a[176:179], a[100:103], v[128:131]
v_mfma_f32_16x16x32_bf16 v[160:163], a[176:179], a[104:107], v[160:163]
ds_read_b64_tr_b16 a[172:173], v245 offset:49152
v_mfma_f32_16x16x32_bf16 v[164:167], a[180:183], a[104:107], v[164:167]
ds_read_b64_tr_b16 a[174:175], v245 offset:53248
v_mfma_f32_16x16x32_bf16 v[196:199], a[180:183], a[108:111], v[196:199]
v_mfma_f32_16x16x32_bf16 v[192:195], a[176:179], a[108:111], v[192:195]
s_waitcnt lgkmcnt(4)
v_mfma_f32_16x16x32_bf16 v[200:203], a[160:163], a[108:111], v[200:203]
ds_read_b64_tr_b16 a[176:177], v246 offset:49152
v_mfma_f32_16x16x32_bf16 v[204:207], a[164:167], a[108:111], v[204:207]
ds_read_b64_tr_b16 a[178:179], v246 offset:53248
v_mfma_f32_16x16x32_bf16 v[172:175], a[164:167], a[104:107], v[172:175]
buffer_load_dwordx4 a[56:59], v2, s[12:15], s38 offen offset:1024 sc1
v_mfma_f32_16x16x32_bf16 v[168:171], a[160:163], a[104:107], v[168:171]
v_mfma_f32_16x16x32_bf16 v[136:139], a[160:163], a[100:103], v[136:139]
ds_read_b64_tr_b16 a[180:181], v247 offset:49152
v_mfma_f32_16x16x32_bf16 v[140:143], a[164:167], a[100:103], v[140:143]
ds_read_b64_tr_b16 a[182:183], v247 offset:53248
v_mfma_f32_16x16x32_bf16 v[108:111], a[164:167], a[96:99], v[108:111]
buffer_load_dwordx4 a[60:63], v2, s[12:15], s39 offen offset:1024 sc1
v_mfma_f32_16x16x32_bf16 v[104:107], a[160:163], a[96:99], v[104:107]
s_waitcnt lgkmcnt(4)
v_mfma_f32_16x16x32_bf16 v[112:115], a[168:171], a[96:99], v[112:115]
ds_read_b64_tr_b16 a[160:161], v240 offset:57344
v_mfma_f32_16x16x32_bf16 v[116:119], a[172:175], a[96:99], v[116:119]
ds_read_b64_tr_b16 a[162:163], v240 offset:61440
v_mfma_f32_16x16x32_bf16 v[148:151], a[172:175], a[100:103], v[148:151]
buffer_load_dwordx4 a[64:67], v2, s[12:15], s36 offen offset:2048 sc1
v_mfma_f32_16x16x32_bf16 v[144:147], a[168:171], a[100:103], v[144:147]
v_mfma_f32_16x16x32_bf16 v[176:179], a[168:171], a[104:107], v[176:179]
ds_read_b64_tr_b16 a[164:165], v241 offset:57344
v_mfma_f32_16x16x32_bf16 v[180:183], a[172:175], a[104:107], v[180:183]
ds_read_b64_tr_b16 a[166:167], v241 offset:61440
v_mfma_f32_16x16x32_bf16 v[212:215], a[172:175], a[108:111], v[212:215]
buffer_load_dwordx4 a[68:71], v2, s[12:15], s37 offen offset:2048 sc1
v_mfma_f32_16x16x32_bf16 v[208:211], a[168:171], a[108:111], v[208:211]
s_waitcnt lgkmcnt(4)
v_mfma_f32_16x16x32_bf16 v[216:219], a[176:179], a[108:111], v[216:219]
ds_read_b64_tr_b16 a[168:169], v242 offset:57344
v_mfma_f32_16x16x32_bf16 v[220:223], a[180:183], a[108:111], v[220:223]
ds_read_b64_tr_b16 a[170:171], v242 offset:61440
v_mfma_f32_16x16x32_bf16 v[188:191], a[180:183], a[104:107], v[188:191]
v_mfma_f32_16x16x32_bf16 v[184:187], a[176:179], a[104:107], v[184:187]
v_mfma_f32_16x16x32_bf16 v[152:155], a[176:179], a[100:103], v[152:155]
ds_read_b64_tr_b16 a[172:173], v243 offset:57344
v_mfma_f32_16x16x32_bf16 v[156:159], a[180:183], a[100:103], v[156:159]
ds_read_b64_tr_b16 a[174:175], v243 offset:61440
v_mfma_f32_16x16x32_bf16 v[124:127], a[180:183], a[96:99], v[124:127]
buffer_load_dwordx4 a[72:75], v2, s[12:15], s38 offen offset:2048 sc1
v_mfma_f32_16x16x32_bf16 v[120:123], a[176:179], a[96:99], v[120:123]
s_waitcnt vmcnt(28) lgkmcnt(4)
v_mfma_f32_16x16x32_bf16 v[96:99], a[160:163], a[112:115], v[96:99]
ds_read_b64_tr_b16 a[176:177], v244 offset:57344
v_mfma_f32_16x16x32_bf16 v[100:103], a[164:167], a[112:115], v[100:103]
ds_read_b64_tr_b16 a[178:179], v244 offset:61440
v_mfma_f32_16x16x32_bf16 v[132:135], a[164:167], a[116:119], v[132:135]
buffer_load_dwordx4 a[76:79], v2, s[12:15], s39 offen offset:2048 sc1
v_mfma_f32_16x16x32_bf16 v[128:131], a[160:163], a[116:119], v[128:131]
v_mfma_f32_16x16x32_bf16 v[160:163], a[160:163], a[120:123], v[160:163]
ds_read_b64_tr_b16 a[180:181], v245 offset:57344
v_mfma_f32_16x16x32_bf16 v[164:167], a[164:167], a[120:123], v[164:167]
ds_read_b64_tr_b16 a[182:183], v245 offset:61440
v_mfma_f32_16x16x32_bf16 v[196:199], a[164:167], a[124:127], v[196:199]
buffer_load_dwordx4 a[80:83], v2, s[12:15], s36 offen offset:3072 sc1
v_mfma_f32_16x16x32_bf16 v[192:195], a[160:163], a[124:127], v[192:195]
s_waitcnt lgkmcnt(4)
v_mfma_f32_16x16x32_bf16 v[200:203], a[168:171], a[124:127], v[200:203]
ds_read_b64_tr_b16 a[160:161], v246 offset:57344
v_mfma_f32_16x16x32_bf16 v[204:207], a[172:175], a[124:127], v[204:207]
ds_read_b64_tr_b16 a[162:163], v246 offset:61440
v_mfma_f32_16x16x32_bf16 v[172:175], a[172:175], a[120:123], v[172:175]
buffer_load_dwordx4 a[84:87], v2, s[12:15], s37 offen offset:3072 sc1
v_mfma_f32_16x16x32_bf16 v[168:171], a[168:171], a[120:123], v[168:171]
v_mfma_f32_16x16x32_bf16 v[136:139], a[168:171], a[116:119], v[136:139]
ds_read_b64_tr_b16 a[164:165], v247 offset:57344
v_mfma_f32_16x16x32_bf16 v[140:143], a[172:175], a[116:119], v[140:143]
ds_read_b64_tr_b16 a[166:167], v247 offset:61440
v_mfma_f32_16x16x32_bf16 v[108:111], a[172:175], a[112:115], v[108:111]
v_mfma_f32_16x16x32_bf16 v[104:107], a[168:171], a[112:115], v[104:107]
s_waitcnt lgkmcnt(4)
v_mfma_f32_16x16x32_bf16 v[112:115], a[176:179], a[112:115], v[112:115]
s_waitcnt vmcnt(42)
s_barrier
v_xor_b32 v246, 0x10000, v246
ds_read_b64_tr_b16 a[168:169], v246 offset:0
v_mfma_f32_16x16x32_bf16 v[116:119], a[180:183], a[112:115], v[116:119]
ds_read_b64_tr_b16 a[170:171], v246 offset:4096
v_mfma_f32_16x16x32_bf16 v[148:151], a[180:183], a[116:119], v[148:151]
buffer_load_dwordx4 a[88:91], v2, s[12:15], s38 offen offset:3072 sc1
v_mfma_f32_16x16x32_bf16 v[144:147], a[176:179], a[116:119], v[144:147]
v_mfma_f32_16x16x32_bf16 v[176:179], a[176:179], a[120:123], v[176:179]
v_xor_b32 v247, 0x10000, v247
ds_read_b64_tr_b16 a[172:173], v247 offset:0
v_mfma_f32_16x16x32_bf16 v[180:183], a[180:183], a[120:123], v[180:183]
ds_read_b64_tr_b16 a[174:175], v247 offset:4096
v_mfma_f32_16x16x32_bf16 v[212:215], a[180:183], a[124:127], v[212:215]
buffer_load_dwordx4 a[92:95], v2, s[12:15], s39 offen offset:3072 sc1
v_mfma_f32_16x16x32_bf16 v[208:211], a[176:179], a[124:127], v[208:211]
s_waitcnt lgkmcnt(4)
v_mfma_f32_16x16x32_bf16 v[216:219], a[160:163], a[124:127], v[216:219]
ds_read_b64_tr_b16 a[176:177], v246 offset:8192
v_mfma_f32_16x16x32_bf16 v[220:223], a[164:167], a[124:127], v[220:223]
ds_read_b64_tr_b16 a[178:179], v246 offset:12288
v_mfma_f32_16x16x32_bf16 v[188:191], a[164:167], a[120:123], v[188:191]
v_mfma_f32_16x16x32_bf16 v[184:187], a[160:163], a[120:123], v[184:187]
v_mfma_f32_16x16x32_bf16 v[152:155], a[160:163], a[116:119], v[152:155]
ds_read_b64_tr_b16 a[180:181], v247 offset:8192
v_mfma_f32_16x16x32_bf16 v[156:159], a[164:167], a[116:119], v[156:159]
ds_read_b64_tr_b16 a[182:183], v247 offset:12288
v_mfma_f32_16x16x32_bf16 v[124:127], a[164:167], a[112:115], v[124:127]
v_mfma_f32_16x16x32_bf16 v[120:123], a[160:163], a[112:115], v[120:123]
s_waitcnt vmcnt(28) lgkmcnt(4)
v_mfma_f32_16x16x32_bf16 v[120:123], a[168:171], a[128:131], v[120:123]
ds_read_b64_tr_b16 a[160:161], v246 offset:16384
v_mfma_f32_16x16x32_bf16 v[124:127], a[172:175], a[128:131], v[124:127]
ds_read_b64_tr_b16 a[162:163], v246 offset:20480
v_mfma_f32_16x16x32_bf16 v[156:159], a[172:175], a[132:135], v[156:159]
v_mfma_f32_16x16x32_bf16 v[152:155], a[168:171], a[132:135], v[152:155]
v_mfma_f32_16x16x32_bf16 v[184:187], a[168:171], a[136:139], v[184:187]
ds_read_b64_tr_b16 a[164:165], v247 offset:16384
v_mfma_f32_16x16x32_bf16 v[188:191], a[172:175], a[136:139], v[188:191]
ds_read_b64_tr_b16 a[166:167], v247 offset:20480
v_mfma_f32_16x16x32_bf16 v[220:223], a[172:175], a[140:143], v[220:223]
v_mfma_f32_16x16x32_bf16 v[216:219], a[168:171], a[140:143], v[216:219]
s_waitcnt vmcnt(24) lgkmcnt(4)
v_mfma_f32_16x16x32_bf16 v[216:219], a[176:179], a[156:159], v[216:219]
ds_read_b64_tr_b16 a[168:169], v246 offset:24576
buffer_load_dwordx4 v[32:35], v89, s[16:19], s40 offen
v_mfma_f32_16x16x32_bf16 v[220:223], a[180:183], a[156:159], v[220:223]
ds_read_b64_tr_b16 a[170:171], v246 offset:28672
v_mfma_f32_16x16x32_bf16 v[188:191], a[180:183], a[152:155], v[188:191]
v_mfma_f32_16x16x32_bf16 v[184:187], a[176:179], a[152:155], v[184:187]
v_mfma_f32_16x16x32_bf16 v[152:155], a[176:179], a[148:151], v[152:155]
ds_read_b64_tr_b16 a[172:173], v247 offset:24576
v_mfma_f32_16x16x32_bf16 v[156:159], a[180:183], a[148:151], v[156:159]
ds_read_b64_tr_b16 a[174:175], v247 offset:28672
v_mfma_f32_16x16x32_bf16 v[124:127], a[180:183], a[144:147], v[124:127]
v_mfma_f32_16x16x32_bf16 v[120:123], a[176:179], a[144:147], v[120:123]
s_waitcnt vmcnt(21) lgkmcnt(4)
v_mfma_f32_16x16x32_bf16 v[120:123], a[160:163], a[0:3], v[120:123]
s_waitcnt vmcnt(33)
s_barrier
ds_read_b64_tr_b16 a[176:177], v246 offset:32768
buffer_load_dwordx4 v[36:39], v89, s[16:19], s41 offen
v_mfma_f32_16x16x32_bf16 v[124:127], a[164:167], a[0:3], v[124:127]
ds_read_b64_tr_b16 a[178:179], v246 offset:36864
v_mfma_f32_16x16x32_bf16 v[156:159], a[164:167], a[4:7], v[156:159]
v_mfma_f32_16x16x32_bf16 v[152:155], a[160:163], a[4:7], v[152:155]
v_mfma_f32_16x16x32_bf16 v[184:187], a[160:163], a[8:11], v[184:187]
ds_read_b64_tr_b16 a[180:181], v247 offset:32768
v_mfma_f32_16x16x32_bf16 v[188:191], a[164:167], a[8:11], v[188:191]
ds_read_b64_tr_b16 a[182:183], v247 offset:36864
v_mfma_f32_16x16x32_bf16 v[220:223], a[164:167], a[12:15], v[220:223]
v_mfma_f32_16x16x32_bf16 v[216:219], a[160:163], a[12:15], v[216:219]
s_waitcnt vmcnt(18) lgkmcnt(4)
v_mfma_f32_16x16x32_bf16 v[216:219], a[168:171], a[28:31], v[216:219]
ds_read_b64_tr_b16 a[160:161], v246 offset:40960
buffer_load_dwordx4 v[40:43], v89, s[16:19], s42 offen
v_mfma_f32_16x16x32_bf16 v[220:223], a[172:175], a[28:31], v[220:223]
ds_read_b64_tr_b16 a[162:163], v246 offset:45056
v_mfma_f32_16x16x32_bf16 v[188:191], a[172:175], a[24:27], v[188:191]
v_mfma_f32_16x16x32_bf16 v[184:187], a[168:171], a[24:27], v[184:187]
v_mfma_f32_16x16x32_bf16 v[152:155], a[168:171], a[20:23], v[152:155]
ds_read_b64_tr_b16 a[164:165], v247 offset:40960
v_mfma_f32_16x16x32_bf16 v[156:159], a[172:175], a[20:23], v[156:159]
ds_read_b64_tr_b16 a[166:167], v247 offset:45056
v_mfma_f32_16x16x32_bf16 v[124:127], a[172:175], a[16:19], v[124:127]
v_mfma_f32_16x16x32_bf16 v[120:123], a[168:171], a[16:19], v[120:123]
s_waitcnt vmcnt(15) lgkmcnt(4)
v_mfma_f32_16x16x32_bf16 v[120:123], a[176:179], a[32:35], v[120:123]
ds_read_b64_tr_b16 a[168:169], v246 offset:49152
buffer_load_dwordx4 v[44:47], v89, s[16:19], s43 offen
v_mfma_f32_16x16x32_bf16 v[124:127], a[180:183], a[32:35], v[124:127]
ds_read_b64_tr_b16 a[170:171], v246 offset:53248
v_mfma_f32_16x16x32_bf16 v[156:159], a[180:183], a[36:39], v[156:159]
v_mfma_f32_16x16x32_bf16 v[152:155], a[176:179], a[36:39], v[152:155]
v_mfma_f32_16x16x32_bf16 v[184:187], a[176:179], a[40:43], v[184:187]
ds_read_b64_tr_b16 a[172:173], v247 offset:49152
v_mfma_f32_16x16x32_bf16 v[188:191], a[180:183], a[40:43], v[188:191]
ds_read_b64_tr_b16 a[174:175], v247 offset:53248
v_mfma_f32_16x16x32_bf16 v[220:223], a[180:183], a[44:47], v[220:223]
v_mfma_f32_16x16x32_bf16 v[216:219], a[176:179], a[44:47], v[216:219]
s_waitcnt vmcnt(12) lgkmcnt(4)
v_mfma_f32_16x16x32_bf16 v[216:219], a[160:163], a[60:63], v[216:219]
ds_read_b64_tr_b16 a[176:177], v246 offset:57344
v_mfma_f32_16x16x32_bf16 v[220:223], a[164:167], a[60:63], v[220:223]
ds_read_b64_tr_b16 a[178:179], v246 offset:61440
v_mfma_f32_16x16x32_bf16 v[188:191], a[164:167], a[56:59], v[188:191]
v_mfma_f32_16x16x32_bf16 v[184:187], a[160:163], a[56:59], v[184:187]
v_mfma_f32_16x16x32_bf16 v[152:155], a[160:163], a[52:55], v[152:155]
ds_read_b64_tr_b16 a[180:181], v247 offset:57344
v_mfma_f32_16x16x32_bf16 v[156:159], a[164:167], a[52:55], v[156:159]
ds_read_b64_tr_b16 a[182:183], v247 offset:61440
v_mfma_f32_16x16x32_bf16 v[124:127], a[164:167], a[48:51], v[124:127]
v_mfma_f32_16x16x32_bf16 v[120:123], a[160:163], a[48:51], v[120:123]
s_waitcnt vmcnt(8) lgkmcnt(4)
v_mfma_f32_16x16x32_bf16 v[120:123], a[168:171], a[64:67], v[120:123]
v_xor_b32 v244, 0x10000, v244
ds_read_b64_tr_b16 a[160:161], v244 offset:0
v_mfma_f32_16x16x32_bf16 v[124:127], a[172:175], a[64:67], v[124:127]
ds_read_b64_tr_b16 a[162:163], v244 offset:4096
v_mfma_f32_16x16x32_bf16 v[156:159], a[172:175], a[68:71], v[156:159]
v_mfma_f32_16x16x32_bf16 v[152:155], a[168:171], a[68:71], v[152:155]
v_mfma_f32_16x16x32_bf16 v[184:187], a[168:171], a[72:75], v[184:187]
v_xor_b32 v245, 0x10000, v245
ds_read_b64_tr_b16 a[164:165], v245 offset:0
v_mfma_f32_16x16x32_bf16 v[188:191], a[172:175], a[72:75], v[188:191]
ds_read_b64_tr_b16 a[166:167], v245 offset:4096
v_mfma_f32_16x16x32_bf16 v[220:223], a[172:175], a[76:79], v[220:223]
v_mfma_f32_16x16x32_bf16 v[216:219], a[168:171], a[76:79], v[216:219]
s_waitcnt vmcnt(4) lgkmcnt(4)
v_mfma_f32_16x16x32_bf16 v[216:219], a[176:179], a[92:95], v[216:219]
ds_read_b64_tr_b16 a[168:169], v244 offset:8192
v_mfma_f32_16x16x32_bf16 v[220:223], a[180:183], a[92:95], v[220:223]
ds_read_b64_tr_b16 a[170:171], v244 offset:12288
v_mfma_f32_16x16x32_bf16 v[188:191], a[180:183], a[88:91], v[188:191]
v_mfma_f32_16x16x32_bf16 v[184:187], a[176:179], a[88:91], v[184:187]
v_mfma_f32_16x16x32_bf16 v[152:155], a[176:179], a[84:87], v[152:155]
ds_read_b64_tr_b16 a[172:173], v245 offset:8192
v_mfma_f32_16x16x32_bf16 v[156:159], a[180:183], a[84:87], v[156:159]
ds_read_b64_tr_b16 a[174:175], v245 offset:12288
v_mfma_f32_16x16x32_bf16 v[124:127], a[180:183], a[80:83], v[124:127]
v_mfma_f32_16x16x32_bf16 v[120:123], a[176:179], a[80:83], v[120:123]
s_waitcnt lgkmcnt(4)
v_mfma_f32_16x16x32_bf16 v[112:115], a[160:163], a[128:131], v[112:115]
ds_read_b64_tr_b16 a[176:177], v244 offset:16384
v_mfma_f32_16x16x32_bf16 v[116:119], a[164:167], a[128:131], v[116:119]
ds_read_b64_tr_b16 a[178:179], v244 offset:20480
v_mfma_f32_16x16x32_bf16 v[148:151], a[164:167], a[132:135], v[148:151]
v_mfma_f32_16x16x32_bf16 v[144:147], a[160:163], a[132:135], v[144:147]
v_mfma_f32_16x16x32_bf16 v[176:179], a[160:163], a[136:139], v[176:179]
ds_read_b64_tr_b16 a[180:181], v245 offset:16384
v_cvt_pk_bf16_f32 v48, v120, v121
v_mfma_f32_16x16x32_bf16 v[180:183], a[164:167], a[136:139], v[180:183]
ds_read_b64_tr_b16 a[182:183], v245 offset:20480
v_cvt_pk_bf16_f32 v49, v122, v123
v_mfma_f32_16x16x32_bf16 v[212:215], a[164:167], a[140:143], v[212:215]
v_cvt_pk_bf16_f32 v50, v124, v125
v_mfma_f32_16x16x32_bf16 v[208:211], a[160:163], a[140:143], v[208:211]
s_waitcnt lgkmcnt(4)
v_mfma_f32_16x16x32_bf16 v[208:211], a[168:171], a[156:159], v[208:211]
ds_read_b64_tr_b16 a[160:161], v244 offset:24576
v_cvt_pk_bf16_f32 v51, v126, v127
v_mfma_f32_16x16x32_bf16 v[212:215], a[172:175], a[156:159], v[212:215]
ds_read_b64_tr_b16 a[162:163], v244 offset:28672
buffer_store_dwordx4 v[48:51], v2, s[28:31], s10 offen offset:0 sc1
v_mfma_f32_16x16x32_bf16 v[180:183], a[172:175], a[152:155], v[180:183]
v_cvt_pk_bf16_f32 v52, v152, v153
v_mfma_f32_16x16x32_bf16 v[176:179], a[168:171], a[152:155], v[176:179]
v_mfma_f32_16x16x32_bf16 v[144:147], a[168:171], a[148:151], v[144:147]
ds_read_b64_tr_b16 a[164:165], v245 offset:24576
v_cvt_pk_bf16_f32 v53, v154, v155
v_mfma_f32_16x16x32_bf16 v[148:151], a[172:175], a[148:151], v[148:151]
ds_read_b64_tr_b16 a[166:167], v245 offset:28672
v_cvt_pk_bf16_f32 v54, v156, v157
v_mfma_f32_16x16x32_bf16 v[116:119], a[172:175], a[144:147], v[116:119]
v_cvt_pk_bf16_f32 v55, v158, v159
v_mfma_f32_16x16x32_bf16 v[112:115], a[168:171], a[144:147], v[112:115]
s_waitcnt lgkmcnt(4)
v_mfma_f32_16x16x32_bf16 v[112:115], a[176:179], a[0:3], v[112:115]
ds_read_b64_tr_b16 a[168:169], v244 offset:32768
buffer_store_dwordx4 v[52:55], v2, s[28:31], s10 offen offset:1024 sc1
v_mfma_f32_16x16x32_bf16 v[116:119], a[180:183], a[0:3], v[116:119]
ds_read_b64_tr_b16 a[170:171], v244 offset:36864
v_cvt_pk_bf16_f32 v56, v184, v185
v_mfma_f32_16x16x32_bf16 v[148:151], a[180:183], a[4:7], v[148:151]
v_cvt_pk_bf16_f32 v57, v186, v187
v_mfma_f32_16x16x32_bf16 v[144:147], a[176:179], a[4:7], v[144:147]
v_mfma_f32_16x16x32_bf16 v[176:179], a[176:179], a[8:11], v[176:179]
ds_read_b64_tr_b16 a[172:173], v245 offset:32768
v_cvt_pk_bf16_f32 v58, v188, v189
v_mfma_f32_16x16x32_bf16 v[180:183], a[180:183], a[8:11], v[180:183]
ds_read_b64_tr_b16 a[174:175], v245 offset:36864
v_cvt_pk_bf16_f32 v59, v190, v191
v_mfma_f32_16x16x32_bf16 v[212:215], a[180:183], a[12:15], v[212:215]
buffer_store_dwordx4 v[56:59], v2, s[28:31], s10 offen offset:2048 sc1
v_mfma_f32_16x16x32_bf16 v[208:211], a[176:179], a[12:15], v[208:211]
s_waitcnt lgkmcnt(4)
v_mfma_f32_16x16x32_bf16 v[208:211], a[160:163], a[28:31], v[208:211]
ds_read_b64_tr_b16 a[176:177], v244 offset:40960
v_cvt_pk_bf16_f32 v60, v216, v217
v_mfma_f32_16x16x32_bf16 v[212:215], a[164:167], a[28:31], v[212:215]
ds_read_b64_tr_b16 a[178:179], v244 offset:45056
v_cvt_pk_bf16_f32 v61, v218, v219
v_mfma_f32_16x16x32_bf16 v[180:183], a[164:167], a[24:27], v[180:183]
v_cvt_pk_bf16_f32 v62, v220, v221
v_mfma_f32_16x16x32_bf16 v[176:179], a[160:163], a[24:27], v[176:179]
v_mfma_f32_16x16x32_bf16 v[144:147], a[160:163], a[20:23], v[144:147]
ds_read_b64_tr_b16 a[180:181], v245 offset:40960
v_cvt_pk_bf16_f32 v63, v222, v223
v_mfma_f32_16x16x32_bf16 v[148:151], a[164:167], a[20:23], v[148:151]
ds_read_b64_tr_b16 a[182:183], v245 offset:45056
buffer_store_dwordx4 v[60:63], v2, s[28:31], s10 offen offset:3072 sc1
v_mfma_f32_16x16x32_bf16 v[116:119], a[164:167], a[16:19], v[116:119]
v_mfma_f32_16x16x32_bf16 v[112:115], a[160:163], a[16:19], v[112:115]
s_waitcnt lgkmcnt(4)
v_mfma_f32_16x16x32_bf16 v[112:115], a[168:171], a[32:35], v[112:115]
ds_read_b64_tr_b16 a[160:161], v244 offset:49152
v_mfma_f32_16x16x32_bf16 v[116:119], a[172:175], a[32:35], v[116:119]
ds_read_b64_tr_b16 a[162:163], v244 offset:53248
v_mfma_f32_16x16x32_bf16 v[148:151], a[172:175], a[36:39], v[148:151]
v_mfma_f32_16x16x32_bf16 v[144:147], a[168:171], a[36:39], v[144:147]
v_mfma_f32_16x16x32_bf16 v[176:179], a[168:171], a[40:43], v[176:179]
ds_read_b64_tr_b16 a[164:165], v245 offset:49152
v_mfma_f32_16x16x32_bf16 v[180:183], a[172:175], a[40:43], v[180:183]
ds_read_b64_tr_b16 a[166:167], v245 offset:53248
v_mfma_f32_16x16x32_bf16 v[212:215], a[172:175], a[44:47], v[212:215]
v_mfma_f32_16x16x32_bf16 v[208:211], a[168:171], a[44:47], v[208:211]
s_waitcnt lgkmcnt(4)
v_mfma_f32_16x16x32_bf16 v[208:211], a[176:179], a[60:63], v[208:211]
ds_read_b64_tr_b16 a[168:169], v244 offset:57344
v_mfma_f32_16x16x32_bf16 v[212:215], a[180:183], a[60:63], v[212:215]
ds_read_b64_tr_b16 a[170:171], v244 offset:61440
v_mfma_f32_16x16x32_bf16 v[180:183], a[180:183], a[56:59], v[180:183]
v_mfma_f32_16x16x32_bf16 v[176:179], a[176:179], a[56:59], v[176:179]
v_mfma_f32_16x16x32_bf16 v[144:147], a[176:179], a[52:55], v[144:147]
ds_read_b64_tr_b16 a[172:173], v245 offset:57344
v_mfma_f32_16x16x32_bf16 v[148:151], a[180:183], a[52:55], v[148:151]
ds_read_b64_tr_b16 a[174:175], v245 offset:61440
v_mfma_f32_16x16x32_bf16 v[116:119], a[180:183], a[48:51], v[116:119]
v_mfma_f32_16x16x32_bf16 v[112:115], a[176:179], a[48:51], v[112:115]
s_waitcnt lgkmcnt(4)
v_mfma_f32_16x16x32_bf16 v[112:115], a[160:163], a[64:67], v[112:115]
v_xor_b32 v242, 0x10000, v242
ds_read_b64_tr_b16 a[176:177], v242 offset:0
v_mfma_f32_16x16x32_bf16 v[116:119], a[164:167], a[64:67], v[116:119]
ds_read_b64_tr_b16 a[178:179], v242 offset:4096
v_mfma_f32_16x16x32_bf16 v[148:151], a[164:167], a[68:71], v[148:151]
v_mfma_f32_16x16x32_bf16 v[144:147], a[160:163], a[68:71], v[144:147]
v_mfma_f32_16x16x32_bf16 v[176:179], a[160:163], a[72:75], v[176:179]
v_xor_b32 v243, 0x10000, v243
ds_read_b64_tr_b16 a[180:181], v243 offset:0
v_mfma_f32_16x16x32_bf16 v[180:183], a[164:167], a[72:75], v[180:183]
ds_read_b64_tr_b16 a[182:183], v243 offset:4096
v_mfma_f32_16x16x32_bf16 v[212:215], a[164:167], a[76:79], v[212:215]
v_mfma_f32_16x16x32_bf16 v[208:211], a[160:163], a[76:79], v[208:211]
s_waitcnt lgkmcnt(4)
v_mfma_f32_16x16x32_bf16 v[208:211], a[168:171], a[92:95], v[208:211]
ds_read_b64_tr_b16 a[160:161], v242 offset:8192
v_mfma_f32_16x16x32_bf16 v[212:215], a[172:175], a[92:95], v[212:215]
ds_read_b64_tr_b16 a[162:163], v242 offset:12288
v_mfma_f32_16x16x32_bf16 v[180:183], a[172:175], a[88:91], v[180:183]
v_mfma_f32_16x16x32_bf16 v[176:179], a[168:171], a[88:91], v[176:179]
v_mfma_f32_16x16x32_bf16 v[144:147], a[168:171], a[84:87], v[144:147]
ds_read_b64_tr_b16 a[164:165], v243 offset:8192
v_mfma_f32_16x16x32_bf16 v[148:151], a[172:175], a[84:87], v[148:151]
ds_read_b64_tr_b16 a[166:167], v243 offset:12288
v_mfma_f32_16x16x32_bf16 v[116:119], a[172:175], a[80:83], v[116:119]
v_mfma_f32_16x16x32_bf16 v[112:115], a[168:171], a[80:83], v[112:115]
s_waitcnt lgkmcnt(4)
v_mfma_f32_16x16x32_bf16 v[104:107], a[176:179], a[128:131], v[104:107]
ds_read_b64_tr_b16 a[168:169], v242 offset:16384
v_mfma_f32_16x16x32_bf16 v[108:111], a[180:183], a[128:131], v[108:111]
ds_read_b64_tr_b16 a[170:171], v242 offset:20480
v_mfma_f32_16x16x32_bf16 v[140:143], a[180:183], a[132:135], v[140:143]
v_mfma_f32_16x16x32_bf16 v[136:139], a[176:179], a[132:135], v[136:139]
v_mfma_f32_16x16x32_bf16 v[168:171], a[176:179], a[136:139], v[168:171]
ds_read_b64_tr_b16 a[172:173], v243 offset:16384
v_cvt_pk_bf16_f32 v56, v112, v113
v_mfma_f32_16x16x32_bf16 v[172:175], a[180:183], a[136:139], v[172:175]
ds_read_b64_tr_b16 a[174:175], v243 offset:20480
v_cvt_pk_bf16_f32 v57, v114, v115
v_mfma_f32_16x16x32_bf16 v[204:207], a[180:183], a[140:143], v[204:207]
v_cvt_pk_bf16_f32 v58, v116, v117
v_mfma_f32_16x16x32_bf16 v[200:203], a[176:179], a[140:143], v[200:203]
s_waitcnt lgkmcnt(4)
v_mfma_f32_16x16x32_bf16 v[200:203], a[160:163], a[156:159], v[200:203]
ds_read_b64_tr_b16 a[176:177], v242 offset:24576
v_cvt_pk_bf16_f32 v59, v118, v119
v_mfma_f32_16x16x32_bf16 v[204:207], a[164:167], a[156:159], v[204:207]
ds_read_b64_tr_b16 a[178:179], v242 offset:28672
buffer_store_dwordx4 v[56:59], v2, s[28:31], s9 offen offset:0 sc1
v_mfma_f32_16x16x32_bf16 v[172:175], a[164:167], a[152:155], v[172:175]
v_cvt_pk_bf16_f32 v60, v144, v145
v_mfma_f32_16x16x32_bf16 v[168:171], a[160:163], a[152:155], v[168:171]
v_mfma_f32_16x16x32_bf16 v[136:139], a[160:163], a[148:151], v[136:139]
ds_read_b64_tr_b16 a[180:181], v243 offset:24576
v_cvt_pk_bf16_f32 v61, v146, v147
v_mfma_f32_16x16x32_bf16 v[140:143], a[164:167], a[148:151], v[140:143]
ds_read_b64_tr_b16 a[182:183], v243 offset:28672
v_cvt_pk_bf16_f32 v62, v148, v149
v_mfma_f32_16x16x32_bf16 v[108:111], a[164:167], a[144:147], v[108:111]
v_cvt_pk_bf16_f32 v63, v150, v151
v_mfma_f32_16x16x32_bf16 v[104:107], a[160:163], a[144:147], v[104:107]
s_waitcnt lgkmcnt(4)
v_mfma_f32_16x16x32_bf16 v[104:107], a[168:171], a[0:3], v[104:107]
ds_read_b64_tr_b16 a[160:161], v242 offset:32768
buffer_store_dwordx4 v[60:63], v2, s[28:31], s9 offen offset:1024 sc1
v_mfma_f32_16x16x32_bf16 v[108:111], a[172:175], a[0:3], v[108:111]
ds_read_b64_tr_b16 a[162:163], v242 offset:36864
v_cvt_pk_bf16_f32 v64, v176, v177
v_mfma_f32_16x16x32_bf16 v[140:143], a[172:175], a[4:7], v[140:143]
v_cvt_pk_bf16_f32 v65, v178, v179
v_mfma_f32_16x16x32_bf16 v[136:139], a[168:171], a[4:7], v[136:139]
v_mfma_f32_16x16x32_bf16 v[168:171], a[168:171], a[8:11], v[168:171]
ds_read_b64_tr_b16 a[164:165], v243 offset:32768
v_cvt_pk_bf16_f32 v66, v180, v181
v_mfma_f32_16x16x32_bf16 v[172:175], a[172:175], a[8:11], v[172:175]
ds_read_b64_tr_b16 a[166:167], v243 offset:36864
v_cvt_pk_bf16_f32 v67, v182, v183
v_mfma_f32_16x16x32_bf16 v[204:207], a[172:175], a[12:15], v[204:207]
buffer_store_dwordx4 v[64:67], v2, s[28:31], s9 offen offset:2048 sc1
v_mfma_f32_16x16x32_bf16 v[200:203], a[168:171], a[12:15], v[200:203]
s_waitcnt lgkmcnt(4)
v_mfma_f32_16x16x32_bf16 v[200:203], a[176:179], a[28:31], v[200:203]
ds_read_b64_tr_b16 a[168:169], v242 offset:40960
v_cvt_pk_bf16_f32 v68, v208, v209
v_mfma_f32_16x16x32_bf16 v[204:207], a[180:183], a[28:31], v[204:207]
ds_read_b64_tr_b16 a[170:171], v242 offset:45056
v_cvt_pk_bf16_f32 v69, v210, v211
v_mfma_f32_16x16x32_bf16 v[172:175], a[180:183], a[24:27], v[172:175]
v_cvt_pk_bf16_f32 v70, v212, v213
v_mfma_f32_16x16x32_bf16 v[168:171], a[176:179], a[24:27], v[168:171]
v_mfma_f32_16x16x32_bf16 v[136:139], a[176:179], a[20:23], v[136:139]
ds_read_b64_tr_b16 a[172:173], v243 offset:40960
v_cvt_pk_bf16_f32 v71, v214, v215
v_mfma_f32_16x16x32_bf16 v[140:143], a[180:183], a[20:23], v[140:143]
ds_read_b64_tr_b16 a[174:175], v243 offset:45056
buffer_store_dwordx4 v[68:71], v2, s[28:31], s9 offen offset:3072 sc1
v_mfma_f32_16x16x32_bf16 v[108:111], a[180:183], a[16:19], v[108:111]
v_mfma_f32_16x16x32_bf16 v[104:107], a[176:179], a[16:19], v[104:107]
s_waitcnt lgkmcnt(4)
v_mfma_f32_16x16x32_bf16 v[104:107], a[160:163], a[32:35], v[104:107]
ds_read_b64_tr_b16 a[176:177], v242 offset:49152
v_mfma_f32_16x16x32_bf16 v[108:111], a[164:167], a[32:35], v[108:111]
ds_read_b64_tr_b16 a[178:179], v242 offset:53248
v_mfma_f32_16x16x32_bf16 v[140:143], a[164:167], a[36:39], v[140:143]
v_mfma_f32_16x16x32_bf16 v[136:139], a[160:163], a[36:39], v[136:139]
v_mfma_f32_16x16x32_bf16 v[168:171], a[160:163], a[40:43], v[168:171]
ds_read_b64_tr_b16 a[180:181], v243 offset:49152
v_mfma_f32_16x16x32_bf16 v[172:175], a[164:167], a[40:43], v[172:175]
ds_read_b64_tr_b16 a[182:183], v243 offset:53248
v_mfma_f32_16x16x32_bf16 v[204:207], a[164:167], a[44:47], v[204:207]
v_mfma_f32_16x16x32_bf16 v[200:203], a[160:163], a[44:47], v[200:203]
s_waitcnt lgkmcnt(4)
v_mfma_f32_16x16x32_bf16 v[200:203], a[168:171], a[60:63], v[200:203]
ds_read_b64_tr_b16 a[160:161], v242 offset:57344
s_waitcnt vmcnt(4)
v_mfma_f32_16x16x32_bf16 v[204:207], a[172:175], a[60:63], v[204:207]
ds_read_b64_tr_b16 a[162:163], v242 offset:61440
buffer_store_dword v28, v29, s[32:35], s22 offen sc1
v_mfma_f32_16x16x32_bf16 v[172:175], a[172:175], a[56:59], v[172:175]
v_mfma_f32_16x16x32_bf16 v[168:171], a[168:171], a[56:59], v[168:171]
v_mfma_f32_16x16x32_bf16 v[136:139], a[168:171], a[52:55], v[136:139]
ds_read_b64_tr_b16 a[164:165], v243 offset:57344
v_mfma_f32_16x16x32_bf16 v[140:143], a[172:175], a[52:55], v[140:143]
ds_read_b64_tr_b16 a[166:167], v243 offset:61440
v_mfma_f32_16x16x32_bf16 v[108:111], a[172:175], a[48:51], v[108:111]
v_mfma_f32_16x16x32_bf16 v[104:107], a[168:171], a[48:51], v[104:107]
s_waitcnt lgkmcnt(4)
v_mfma_f32_16x16x32_bf16 v[104:107], a[176:179], a[64:67], v[104:107]
v_xor_b32 v240, 0x10000, v240
ds_read_b64_tr_b16 a[168:169], v240 offset:0
v_mfma_f32_16x16x32_bf16 v[108:111], a[180:183], a[64:67], v[108:111]
ds_read_b64_tr_b16 a[170:171], v240 offset:4096
v_mfma_f32_16x16x32_bf16 v[140:143], a[180:183], a[68:71], v[140:143]
v_mfma_f32_16x16x32_bf16 v[136:139], a[176:179], a[68:71], v[136:139]
v_mfma_f32_16x16x32_bf16 v[168:171], a[176:179], a[72:75], v[168:171]
v_xor_b32 v241, 0x10000, v241
ds_read_b64_tr_b16 a[172:173], v241 offset:0
v_mfma_f32_16x16x32_bf16 v[172:175], a[180:183], a[72:75], v[172:175]
ds_read_b64_tr_b16 a[174:175], v241 offset:4096
v_mfma_f32_16x16x32_bf16 v[204:207], a[180:183], a[76:79], v[204:207]
v_mfma_f32_16x16x32_bf16 v[200:203], a[176:179], a[76:79], v[200:203]
s_waitcnt lgkmcnt(4)
v_mfma_f32_16x16x32_bf16 v[200:203], a[160:163], a[92:95], v[200:203]
ds_read_b64_tr_b16 a[176:177], v240 offset:8192
v_mfma_f32_16x16x32_bf16 v[204:207], a[164:167], a[92:95], v[204:207]
ds_read_b64_tr_b16 a[178:179], v240 offset:12288
v_mfma_f32_16x16x32_bf16 v[172:175], a[164:167], a[88:91], v[172:175]
v_mfma_f32_16x16x32_bf16 v[168:171], a[160:163], a[88:91], v[168:171]
v_mfma_f32_16x16x32_bf16 v[136:139], a[160:163], a[84:87], v[136:139]
ds_read_b64_tr_b16 a[180:181], v241 offset:8192
v_mfma_f32_16x16x32_bf16 v[140:143], a[164:167], a[84:87], v[140:143]
ds_read_b64_tr_b16 a[182:183], v241 offset:12288
v_mfma_f32_16x16x32_bf16 v[108:111], a[164:167], a[80:83], v[108:111]
v_mfma_f32_16x16x32_bf16 v[104:107], a[160:163], a[80:83], v[104:107]
s_waitcnt lgkmcnt(4)
v_mfma_f32_16x16x32_bf16 v[96:99], a[168:171], a[128:131], v[96:99]
ds_read_b64_tr_b16 a[160:161], v240 offset:16384
v_mfma_f32_16x16x32_bf16 v[100:103], a[172:175], a[128:131], v[100:103]
ds_read_b64_tr_b16 a[162:163], v240 offset:20480
v_mfma_f32_16x16x32_bf16 v[132:135], a[172:175], a[132:135], v[132:135]
v_mfma_f32_16x16x32_bf16 v[128:131], a[168:171], a[132:135], v[128:131]
v_mfma_f32_16x16x32_bf16 v[160:163], a[168:171], a[136:139], v[160:163]
ds_read_b64_tr_b16 a[164:165], v241 offset:16384
v_cvt_pk_bf16_f32 v64, v104, v105
v_mfma_f32_16x16x32_bf16 v[164:167], a[172:175], a[136:139], v[164:167]
ds_read_b64_tr_b16 a[166:167], v241 offset:20480
v_cvt_pk_bf16_f32 v65, v106, v107
v_mfma_f32_16x16x32_bf16 v[196:199], a[172:175], a[140:143], v[196:199]
v_cvt_pk_bf16_f32 v66, v108, v109
v_mfma_f32_16x16x32_bf16 v[192:195], a[168:171], a[140:143], v[192:195]
s_waitcnt lgkmcnt(4)
v_mfma_f32_16x16x32_bf16 v[192:195], a[176:179], a[156:159], v[192:195]
ds_read_b64_tr_b16 a[168:169], v240 offset:24576
v_cvt_pk_bf16_f32 v67, v110, v111
v_mfma_f32_16x16x32_bf16 v[196:199], a[180:183], a[156:159], v[196:199]
ds_read_b64_tr_b16 a[170:171], v240 offset:28672
buffer_store_dwordx4 v[64:67], v2, s[28:31], s8 offen offset:0 sc1
v_mfma_f32_16x16x32_bf16 v[164:167], a[180:183], a[152:155], v[164:167]
v_cvt_pk_bf16_f32 v68, v136, v137
v_mfma_f32_16x16x32_bf16 v[160:163], a[176:179], a[152:155], v[160:163]
v_mfma_f32_16x16x32_bf16 v[128:131], a[176:179], a[148:151], v[128:131]
ds_read_b64_tr_b16 a[172:173], v241 offset:24576
v_cvt_pk_bf16_f32 v69, v138, v139
v_mfma_f32_16x16x32_bf16 v[132:135], a[180:183], a[148:151], v[132:135]
ds_read_b64_tr_b16 a[174:175], v241 offset:28672
v_cvt_pk_bf16_f32 v70, v140, v141
v_mfma_f32_16x16x32_bf16 v[100:103], a[180:183], a[144:147], v[100:103]
v_cvt_pk_bf16_f32 v71, v142, v143
v_mfma_f32_16x16x32_bf16 v[96:99], a[176:179], a[144:147], v[96:99]
s_waitcnt lgkmcnt(4)
v_mfma_f32_16x16x32_bf16 v[96:99], a[160:163], a[0:3], v[96:99]
ds_read_b64_tr_b16 a[176:177], v240 offset:32768
buffer_store_dwordx4 v[68:71], v2, s[28:31], s8 offen offset:1024 sc1
v_mfma_f32_16x16x32_bf16 v[100:103], a[164:167], a[0:3], v[100:103]
ds_read_b64_tr_b16 a[178:179], v240 offset:36864
v_cvt_pk_bf16_f32 v48, v168, v169
v_mfma_f32_16x16x32_bf16 v[132:135], a[164:167], a[4:7], v[132:135]
v_cvt_pk_bf16_f32 v49, v170, v171
v_mfma_f32_16x16x32_bf16 v[128:131], a[160:163], a[4:7], v[128:131]
v_mfma_f32_16x16x32_bf16 v[160:163], a[160:163], a[8:11], v[160:163]
ds_read_b64_tr_b16 a[180:181], v241 offset:32768
v_cvt_pk_bf16_f32 v50, v172, v173
v_mfma_f32_16x16x32_bf16 v[164:167], a[164:167], a[8:11], v[164:167]
ds_read_b64_tr_b16 a[182:183], v241 offset:36864
v_cvt_pk_bf16_f32 v51, v174, v175
v_mfma_f32_16x16x32_bf16 v[196:199], a[164:167], a[12:15], v[196:199]
buffer_store_dwordx4 v[48:51], v2, s[28:31], s8 offen offset:2048 sc1
v_mfma_f32_16x16x32_bf16 v[192:195], a[160:163], a[12:15], v[192:195]
s_waitcnt lgkmcnt(4)
v_mfma_f32_16x16x32_bf16 v[192:195], a[168:171], a[28:31], v[192:195]
ds_read_b64_tr_b16 a[160:161], v240 offset:40960
v_cvt_pk_bf16_f32 v52, v200, v201
v_mfma_f32_16x16x32_bf16 v[196:199], a[172:175], a[28:31], v[196:199]
ds_read_b64_tr_b16 a[162:163], v240 offset:45056
v_cvt_pk_bf16_f32 v53, v202, v203
v_mfma_f32_16x16x32_bf16 v[164:167], a[172:175], a[24:27], v[164:167]
v_cvt_pk_bf16_f32 v54, v204, v205
buffer_load_dword v22, v31, s[32:35], s71 offen offset:32 sc1
v_mfma_f32_16x16x32_bf16 v[160:163], a[168:171], a[24:27], v[160:163]
v_mfma_f32_16x16x32_bf16 v[128:131], a[168:171], a[20:23], v[128:131]
ds_read_b64_tr_b16 a[164:165], v241 offset:40960
v_cvt_pk_bf16_f32 v55, v206, v207
v_mfma_f32_16x16x32_bf16 v[132:135], a[172:175], a[20:23], v[132:135]
ds_read_b64_tr_b16 a[166:167], v241 offset:45056
buffer_store_dwordx4 v[52:55], v2, s[28:31], s8 offen offset:3072 sc1
v_mfma_f32_16x16x32_bf16 v[100:103], a[172:175], a[16:19], v[100:103]
v_mfma_f32_16x16x32_bf16 v[96:99], a[168:171], a[16:19], v[96:99]
s_waitcnt lgkmcnt(4)
v_mfma_f32_16x16x32_bf16 v[96:99], a[176:179], a[32:35], v[96:99]
ds_read_b64_tr_b16 a[168:169], v240 offset:49152
v_mfma_f32_16x16x32_bf16 v[100:103], a[180:183], a[32:35], v[100:103]
ds_read_b64_tr_b16 a[170:171], v240 offset:53248
v_mfma_f32_16x16x32_bf16 v[132:135], a[180:183], a[36:39], v[132:135]
v_mfma_f32_16x16x32_bf16 v[128:131], a[176:179], a[36:39], v[128:131]
v_mfma_f32_16x16x32_bf16 v[160:163], a[176:179], a[40:43], v[160:163]
ds_read_b64_tr_b16 a[172:173], v241 offset:49152
v_mfma_f32_16x16x32_bf16 v[164:167], a[180:183], a[40:43], v[164:167]
ds_read_b64_tr_b16 a[174:175], v241 offset:53248
v_mfma_f32_16x16x32_bf16 v[196:199], a[180:183], a[44:47], v[196:199]
v_mfma_f32_16x16x32_bf16 v[192:195], a[176:179], a[44:47], v[192:195]
s_waitcnt lgkmcnt(4)
v_mfma_f32_16x16x32_bf16 v[192:195], a[160:163], a[60:63], v[192:195]
ds_read_b64_tr_b16 a[176:177], v240 offset:57344
s_waitcnt vmcnt(6)
v_mfma_f32_16x16x32_bf16 v[196:199], a[164:167], a[60:63], v[196:199]
ds_read_b64_tr_b16 a[178:179], v240 offset:61440
buffer_store_dword v28, v29, s[32:35], s21 offen sc1
v_mfma_f32_16x16x32_bf16 v[164:167], a[164:167], a[56:59], v[164:167]
v_mfma_f32_16x16x32_bf16 v[160:163], a[160:163], a[56:59], v[160:163]
v_mfma_f32_16x16x32_bf16 v[128:131], a[160:163], a[52:55], v[128:131]
ds_read_b64_tr_b16 a[180:181], v241 offset:57344
v_mfma_f32_16x16x32_bf16 v[132:135], a[164:167], a[52:55], v[132:135]
ds_read_b64_tr_b16 a[182:183], v241 offset:61440
v_mfma_f32_16x16x32_bf16 v[100:103], a[164:167], a[48:51], v[100:103]
v_mfma_f32_16x16x32_bf16 v[96:99], a[160:163], a[48:51], v[96:99]
s_waitcnt lgkmcnt(4)
v_mfma_f32_16x16x32_bf16 v[96:99], a[168:171], a[64:67], v[96:99]
v_mfma_f32_16x16x32_bf16 v[100:103], a[172:175], a[64:67], v[100:103]
v_mfma_f32_16x16x32_bf16 v[132:135], a[172:175], a[68:71], v[132:135]
v_mfma_f32_16x16x32_bf16 v[128:131], a[168:171], a[68:71], v[128:131]
v_mfma_f32_16x16x32_bf16 v[160:163], a[168:171], a[72:75], v[160:163]
v_mfma_f32_16x16x32_bf16 v[164:167], a[172:175], a[72:75], v[164:167]
v_mfma_f32_16x16x32_bf16 v[196:199], a[172:175], a[76:79], v[196:199]
v_mfma_f32_16x16x32_bf16 v[192:195], a[168:171], a[76:79], v[192:195]
s_waitcnt lgkmcnt(0)
v_mfma_f32_16x16x32_bf16 v[192:195], a[176:179], a[92:95], v[192:195]
v_mfma_f32_16x16x32_bf16 v[196:199], a[180:183], a[92:95], v[196:199]
v_mfma_f32_16x16x32_bf16 v[164:167], a[180:183], a[88:91], v[164:167]
v_mfma_f32_16x16x32_bf16 v[160:163], a[176:179], a[88:91], v[160:163]
v_mfma_f32_16x16x32_bf16 v[128:131], a[176:179], a[84:87], v[128:131]
v_mfma_f32_16x16x32_bf16 v[132:135], a[180:183], a[84:87], v[132:135]
v_mfma_f32_16x16x32_bf16 v[100:103], a[180:183], a[80:83], v[100:103]
v_mfma_f32_16x16x32_bf16 v[96:99], a[176:179], a[80:83], v[96:99]
s_mov_b32 s7, 0xffff0000
s_add_u32 s46, s69, 4096
s_add_u32 s47, s69, 8192
s_add_u32 s5, s71, 32
s_add_u32 s4, s71, 16
s_waitcnt vmcnt(2)
v_cmp_ne_u32 vcc, s68, v22
s_nop 4
s_cbranch_vccz L_px3_ok
s_mov_b32 s6, 0
L_px3_chk:
buffer_load_dword v0, v31, s[32:35], s5 offen sc1
s_add_u32 s6, s6, 1
s_waitcnt vmcnt(0)
v_cmp_ne_u32 vcc, s68, v0
s_nop 4
s_cbranch_vccz L_px3_ok
s_cmp_lt_u32 s6, 0x20000
s_cbranch_scc1 L_px3_chk
L_px3_ok:
buffer_load_dwordx4 v[120:123], v2, s[28:31], s47 offen offset:0 sc1
buffer_load_dwordx4 v[152:155], v2, s[28:31], s47 offen offset:1024 sc1
buffer_load_dwordx4 v[184:187], v2, s[28:31], s47 offen offset:2048 sc1
buffer_load_dwordx4 v[216:219], v2, s[28:31], s47 offen offset:3072 sc1
buffer_load_dword v22, v31, s[32:35], s4 offen sc1
s_waitcnt vmcnt(20)
v_permlane16_swap_b32 v32, v34
v_permlane16_swap_b32 v33, v35
v_permlane16_swap_b32 v36, v38
v_permlane16_swap_b32 v37, v39
v_permlane16_swap_b32 v40, v42
v_permlane16_swap_b32 v41, v43
v_permlane16_swap_b32 v44, v46
v_permlane16_swap_b32 v45, v47
s_waitcnt vmcnt(6)
buffer_store_dword v28, v29, s[32:35], s20 offen sc1
v_lshlrev_b32 v14, 16, v32
v_and_b32 v15, s7, v32
v_pk_add_f32 v[96:97], v[96:97], v[14:15]
v_lshlrev_b32 v16, 16, v33
v_and_b32 v17, s7, v33
v_pk_add_f32 v[98:99], v[98:99], v[16:17]
v_lshlrev_b32 v14, 16, v34
v_and_b32 v15, s7, v34
v_pk_add_f32 v[100:101], v[100:101], v[14:15]
v_lshlrev_b32 v16, 16, v35
v_and_b32 v17, s7, v35
v_pk_add_f32 v[102:103], v[102:103], v[16:17]
v_lshlrev_b32 v14, 16, v36
v_and_b32 v15, s7, v36
v_pk_add_f32 v[128:129], v[128:129], v[14:15]
v_lshlrev_b32 v16, 16, v37
v_and_b32 v17, s7, v37
v_pk_add_f32 v[130:131], v[130:131], v[16:17]
v_lshlrev_b32 v14, 16, v38
v_and_b32 v15, s7, v38
v_pk_add_f32 v[132:133], v[132:133], v[14:15]
v_lshlrev_b32 v16, 16, v39
v_and_b32 v17, s7, v39
v_pk_add_f32 v[134:135], v[134:135], v[16:17]
v_lshlrev_b32 v14, 16, v40
v_and_b32 v15, s7, v40
v_pk_add_f32 v[160:161], v[160:161], v[14:15]
v_lshlrev_b32 v16, 16, v41
v_and_b32 v17, s7, v41
v_pk_add_f32 v[162:163], v[162:163], v[16:17]
v_lshlrev_b32 v14, 16, v42
v_and_b32 v15, s7, v42
v_pk_add_f32 v[164:165], v[164:165], v[14:15]
v_lshlrev_b32 v16, 16, v43
v_and_b32 v17, s7, v43
v_pk_add_f32 v[166:167], v[166:167], v[16:17]
v_lshlrev_b32 v14, 16, v44
v_and_b32 v15, s7, v44
v_pk_add_f32 v[192:193], v[192:193], v[14:15]
v_lshlrev_b32 v16, 16, v45
v_and_b32 v17, s7, v45
v_pk_add_f32 v[194:195], v[194:195], v[16:17]
v_lshlrev_b32 v14, 16, v46
v_and_b32 v15, s7, v46
v_pk_add_f32 v[196:197], v[196:197], v[14:15]
v_lshlrev_b32 v16, 16, v47
v_and_b32 v17, s7, v47
v_pk_add_f32 v[198:199], v[198:199], v[16:17]
s_waitcnt vmcnt(1)
v_cmp_ne_u32 vcc, s68, v22
s_nop 4
s_cbranch_vccz L_px2_ok
s_mov_b32 s6, 0
L_px2_chk:
buffer_load_dword v0, v31, s[32:35], s4 offen sc1
s_add_u32 s6, s6, 1
s_waitcnt vmcnt(0)
v_cmp_ne_u32 vcc, s68, v0
s_nop 4
s_cbranch_vccz L_px2_ok
s_cmp_lt_u32 s6, 0x20000
s_cbranch_scc1 L_px2_chk
L_px2_ok:
buffer_load_dwordx4 v[112:115], v2, s[28:31], s46 offen offset:0 sc1
buffer_load_dwordx4 v[144:147], v2, s[28:31], s46 offen offset:1024 sc1
buffer_load_dwordx4 v[176:179], v2, s[28:31], s46 offen offset:2048 sc1
buffer_load_dwordx4 v[208:211], v2, s[28:31], s46 offen offset:3072 sc1
buffer_load_dword v23, v31, s[32:35], s71 offen sc1
s_waitcnt vmcnt(10)
v_lshlrev_b32 v14, 16, v120
v_and_b32_e64 v15, s7, v120
v_pk_add_f32 v[96:97], v[96:97], v[14:15]
v_lshlrev_b32 v16, 16, v121
v_and_b32 v17, s7, v121
v_pk_add_f32 v[98:99], v[98:99], v[16:17]
v_lshlrev_b32 v14, 16, v122
v_and_b32 v15, s7, v122
v_pk_add_f32 v[100:101], v[100:101], v[14:15]
v_lshlrev_b32 v16, 16, v123
v_and_b32 v17, s7, v123
v_pk_add_f32 v[102:103], v[102:103], v[16:17]
s_waitcnt vmcnt(9)
v_lshlrev_b32 v14, 16, v152
v_and_b32 v15, s7, v152
v_pk_add_f32 v[128:129], v[128:129], v[14:15]
v_lshlrev_b32 v16, 16, v153
v_and_b32 v17, s7, v153
v_pk_add_f32 v[130:131], v[130:131], v[16:17]
v_lshlrev_b32 v14, 16, v154
v_and_b32 v15, s7, v154
v_pk_add_f32 v[132:133], v[132:133], v[14:15]
v_lshlrev_b32 v16, 16, v155
v_and_b32 v17, s7, v155
v_pk_add_f32 v[134:135], v[134:135], v[16:17]
s_waitcnt vmcnt(8)
v_lshlrev_b32 v14, 16, v184
v_and_b32 v15, s7, v184
v_pk_add_f32 v[160:161], v[160:161], v[14:15]
v_lshlrev_b32 v16, 16, v185
v_and_b32 v17, s7, v185
v_pk_add_f32 v[162:163], v[162:163], v[16:17]
v_lshlrev_b32 v14, 16, v186
v_and_b32 v15, s7, v186
v_pk_add_f32 v[164:165], v[164:165], v[14:15]
v_lshlrev_b32 v16, 16, v187
v_and_b32 v17, s7, v187
v_pk_add_f32 v[166:167], v[166:167], v[16:17]
s_waitcnt vmcnt(7)
v_lshlrev_b32 v14, 16, v216
v_and_b32 v15, s7, v216
v_pk_add_f32 v[192:193], v[192:193], v[14:15]
v_lshlrev_b32 v16, 16, v217
v_and_b32_e64 v17, s7, v217
v_pk_add_f32 v[194:195], v[194:195], v[16:17]
v_lshlrev_b32 v14, 16, v218
v_and_b32 v15, s7, v218
v_pk_add_f32 v[196:197], v[196:197], v[14:15]
v_lshlrev_b32 v16, 16, v219
v_and_b32 v17, s7, v219
v_pk_add_f32 v[198:199], v[198:199], v[16:17]
s_waitcnt vmcnt(0)
v_cmp_ne_u32 vcc, s68, v23
s_nop 4
s_cbranch_vccz L_px1_ok
s_mov_b32 s6, 0
L_px1_chk:
buffer_load_dword v0, v31, s[32:35], s71 offen sc1
s_add_u32 s6, s6, 1
s_waitcnt vmcnt(0)
v_cmp_ne_u32 vcc, s68, v0
s_nop 4
s_cbranch_vccz L_px1_ok
s_cmp_lt_u32 s6, 0x20000
s_cbranch_scc1 L_px1_chk
L_px1_ok:
buffer_load_dwordx4 v[104:107], v2, s[28:31], s69 offen offset:0 sc1
buffer_load_dwordx4 v[136:139], v2, s[28:31], s69 offen offset:1024 sc1
buffer_load_dwordx4 v[168:171], v2, s[28:31], s69 offen offset:2048 sc1
buffer_load_dwordx4 v[200:203], v2, s[28:31], s69 offen offset:3072 sc1
v_lshlrev_b32 v14, 16, v112
v_and_b32 v15, s7, v112
v_pk_add_f32 v[96:97], v[96:97], v[14:15]
v_lshlrev_b32 v16, 16, v113
v_and_b32_e64 v17, s7, v113
v_pk_add_f32 v[98:99], v[98:99], v[16:17]
v_lshlrev_b32 v14, 16, v114
v_and_b32 v15, s7, v114
v_pk_add_f32 v[100:101], v[100:101], v[14:15]
v_lshlrev_b32 v16, 16, v115
v_and_b32 v17, s7, v115
v_pk_add_f32 v[102:103], v[102:103], v[16:17]
v_lshlrev_b32 v14, 16, v144
v_and_b32 v15, s7, v144
v_pk_add_f32 v[128:129], v[128:129], v[14:15]
v_lshlrev_b32 v16, 16, v145
v_and_b32 v17, s7, v145
v_pk_add_f32 v[130:131], v[130:131], v[16:17]
v_lshlrev_b32 v14, 16, v146
v_and_b32 v15, s7, v146
v_pk_add_f32 v[132:133], v[132:133], v[14:15]
v_lshlrev_b32 v16, 16, v147
v_and_b32 v17, s7, v147
v_pk_add_f32 v[134:135], v[134:135], v[16:17]
v_lshlrev_b32 v14, 16, v176
v_and_b32 v15, s7, v176
v_pk_add_f32 v[160:161], v[160:161], v[14:15]
v_lshlrev_b32 v16, 16, v177
v_and_b32 v17, s7, v177
v_pk_add_f32 v[162:163], v[162:163], v[16:17]
v_lshlrev_b32 v14, 16, v178
v_and_b32 v15, s7, v178
v_pk_add_f32 v[164:165], v[164:165], v[14:15]
v_lshlrev_b32 v16, 16, v179
v_and_b32 v17, s7, v179
v_pk_add_f32 v[166:167], v[166:167], v[16:17]
v_lshlrev_b32 v14, 16, v208
v_and_b32 v15, s7, v208
v_pk_add_f32 v[192:193], v[192:193], v[14:15]
v_lshlrev_b32 v16, 16, v209
v_and_b32 v17, s7, v209
v_pk_add_f32 v[194:195], v[194:195], v[16:17]
v_lshlrev_b32 v14, 16, v210
v_and_b32 v15, s7, v210
v_pk_add_f32 v[196:197], v[196:197], v[14:15]
v_lshlrev_b32 v16, 16, v211
v_and_b32 v17, s7, v211
v_pk_add_f32 v[198:199], v[198:199], v[16:17]
s_waitcnt vmcnt(3)
v_lshlrev_b32 v14, 16, v104
v_and_b32 v15, s7, v104
v_pk_add_f32 v[96:97], v[96:97], v[14:15]
v_lshlrev_b32 v16, 16, v105
v_and_b32 v17, s7, v105
v_pk_add_f32 v[98:99], v[98:99], v[16:17]
v_lshlrev_b32 v14, 16, v106
v_and_b32 v15, s7, v106
v_pk_add_f32 v[100:101], v[100:101], v[14:15]
v_lshlrev_b32 v16, 16, v107
v_and_b32_e64 v17, s7, v107
v_pk_add_f32 v[102:103], v[102:103], v[16:17]
v_cvt_pk_bf16_f32 v96, v96, v97
v_cvt_pk_bf16_f32 v97, v98, v99
v_cvt_pk_bf16_f32 v98, v100, v101
v_cvt_pk_bf16_f32 v99, v102, v103
s_nop 0
v_permlane16_swap_b32 v96, v98
v_permlane16_swap_b32 v97, v99
buffer_store_dwordx4 v[96:99], v89, s[24:27], s40 offen nt
s_waitcnt vmcnt(3)
v_lshlrev_b32 v14, 16, v136
v_and_b32 v15, s7, v136
v_pk_add_f32 v[128:129], v[128:129], v[14:15]
v_lshlrev_b32 v16, 16, v137
v_and_b32 v17, s7, v137
v_pk_add_f32 v[130:131], v[130:131], v[16:17]
v_lshlrev_b32 v14, 16, v138
v_and_b32 v15, s7, v138
v_pk_add_f32 v[132:133], v[132:133], v[14:15]
v_lshlrev_b32 v16, 16, v139
v_and_b32 v17, s7, v139
v_pk_add_f32 v[134:135], v[134:135], v[16:17]
v_cvt_pk_bf16_f32 v128, v128, v129
v_cvt_pk_bf16_f32 v129, v130, v131
v_cvt_pk_bf16_f32 v130, v132, v133
v_cvt_pk_bf16_f32 v131, v134, v135
s_nop 0
v_permlane16_swap_b32 v128, v130
v_permlane16_swap_b32 v129, v131
buffer_store_dwordx4 v[128:131], v89, s[24:27], s41 offen nt
s_waitcnt vmcnt(3)
v_lshlrev_b32 v14, 16, v168
v_and_b32 v15, s7, v168
v_pk_add_f32 v[160:161], v[160:161], v[14:15]
v_lshlrev_b32 v16, 16, v169
v_and_b32 v17, s7, v169
v_pk_add_f32 v[162:163], v[162:163], v[16:17]
v_lshlrev_b32 v14, 16, v170
v_and_b32 v15, s7, v170
v_pk_add_f32 v[164:165], v[164:165], v[14:15]
v_lshlrev_b32 v16, 16, v171
v_and_b32 v17, s7, v171
v_pk_add_f32 v[166:167], v[166:167], v[16:17]
v_cvt_pk_bf16_f32 v160, v160, v161
v_cvt_pk_bf16_f32 v161, v162, v163
v_cvt_pk_bf16_f32 v162, v164, v165
v_cvt_pk_bf16_f32 v163, v166, v167
s_nop 0
v_permlane16_swap_b32 v160, v162
v_permlane16_swap_b32 v161, v163
buffer_store_dwordx4 v[160:163], v89, s[24:27], s42 offen nt
s_waitcnt vmcnt(3)
v_lshlrev_b32 v14, 16, v200
v_and_b32 v15, s7, v200
v_pk_add_f32 v[192:193], v[192:193], v[14:15]
v_lshlrev_b32 v16, 16, v201
v_and_b32 v17, s7, v201
v_pk_add_f32 v[194:195], v[194:195], v[16:17]
v_lshlrev_b32 v14, 16, v202
v_and_b32 v15, s7, v202
v_pk_add_f32 v[196:197], v[196:197], v[14:15]
v_lshlrev_b32 v16, 16, v203
v_and_b32 v17, s7, v203
v_pk_add_f32 v[198:199], v[198:199], v[16:17]
v_cvt_pk_bf16_f32 v192, v192, v193
v_cvt_pk_bf16_f32 v193, v194, v195
v_cvt_pk_bf16_f32 v194, v196, v197
v_cvt_pk_bf16_f32 v195, v198, v199
s_nop 0
v_permlane16_swap_b32 v192, v194
v_permlane16_swap_b32 v193, v195
buffer_store_dwordx4 v[192:195], v89, s[24:27], s43 offen nt
L_fin:
L_end:
s_endpgm
.section .rodata,"a"
.p2align 6
.amdhsa_kernel parallel_sum__sliding_block__glu_gated_geglu__prompt_kernel
  .amdhsa_next_free_vgpr 512
  .amdhsa_next_free_sgpr 80
  .amdhsa_accum_offset 256
  .amdhsa_group_segment_fixed_size 0
  .amdhsa_kernarg_size 80
  .amdhsa_user_sgpr_count 2
  .amdhsa_user_sgpr_kernarg_segment_ptr 1
  .amdhsa_system_sgpr_workgroup_id_x 1
.end_amdhsa_kernel
```
